```python
import torch

def _softmax(x, axis=-1):
    return torch.softmax(x, dim=axis)

def _gelu(x):
    return torch.nn.functional.gelu(x, approximate='tanh')

def _silu(x):
    return torch.nn.functional.silu(x)

def _sigmoid(x):
    return torch.sigmoid(x)

def _layernorm(x, axis=-1, eps=1e-05):
    m = x.mean(dim=axis, keepdim=True)
    v = x.var(dim=axis, keepdim=True, unbiased=False)
    return (x - m) / torch.sqrt(v + eps)

def _scatter_add(tgt, idx, src, axis=0):
    return tgt.clone().index_add_(axis, idx, src)

def _segment_sum(src, seg, n):
    out = torch.zeros((n,) + src.shape[1:], dtype=src.dtype)
    return out.index_add_(0, seg, src)

def _pad(x, pw):
    flat = tuple((v for pair in reversed(pw) for v in pair))
    return torch.nn.functional.pad(x, flat)
kernel_name = 'recurrent_scan__memory_aug_recurrent_mem_tr__dense_activation_silu__prompt'

def setup_inputs():

    _w = lambda a: (lambda t: t.to(torch.bfloat16) if t.is_floating_point() else t)(torch.as_tensor(a))

    def _A_setup():
        B, S, Dm = (1, 2048, 576)
        H, Dh = (32, 128)
        M, seg = (8, 32)
        seg = min(seg, S)
        S = S // seg * seg
        return {'x': _w((lambda *s: torch.randn(*s, dtype=torch.bfloat16) * 0.05)(B, S, Dm)), 'mem0': _w((lambda *s: torch.randn(*s, dtype=torch.bfloat16) * 0.8)(B, M, Dm)), 'Wq': _w((lambda *s: torch.randn(*s, dtype=torch.bfloat16) * 1.6)(Dm, H, Dh) * Dm ** (-0.5)), 'Wk': _w((lambda *s: torch.randn(*s, dtype=torch.bfloat16) * 1.6)(Dm, H, Dh) * Dm ** (-0.5)), 'Wv': _w((lambda *s: torch.randn(*s, dtype=torch.bfloat16) * 0.8)(Dm, H, Dh) * Dm ** (-0.5)), 'Wo': _w((lambda *s: torch.randn(*s, dtype=torch.bfloat16) * 0.8)(H, Dh, Dm) * (H * Dh) ** (-0.5)), 'seg_len': seg}
    _A_in = _A_setup()

    def _B_setup():
        B, S, D, F = (1, 2048, 576, 4608)
        return {'x': _w((lambda *s: torch.randn(*s, dtype=torch.bfloat16) * 0.05)(B, S, D)), 'w1': _w((lambda *s: torch.randn(*s, dtype=torch.bfloat16) * 0.8)(D, F) * D ** (-0.5)), 'w2': _w((lambda *s: torch.randn(*s, dtype=torch.bfloat16) * 0.2)(F, D) * F ** (-0.5))}
    _B_in = _B_setup()
    return {'A_x': _A_in['x'], 'A_mem0': _A_in['mem0'], 'A_Wq': _A_in['Wq'], 'A_Wk': _A_in['Wk'], 'A_Wv': _A_in['Wv'], 'A_Wo': _A_in['Wo'], 'A_seg_len': _A_in['seg_len'], 'B_x': _B_in['x'], 'B_w1': _B_in['w1'], 'B_w2': _B_in['w2']}

def reference(A_x, A_mem0, A_Wq, A_Wk, A_Wv, A_Wo, A_seg_len, B_x, B_w1, B_w2):

    def _A_ref(x, mem0, Wq, Wk, Wv, Wo, seg_len):
        B, S, Dm = x.shape
        H, Dh = (Wq.shape[1], Wq.shape[2])
        M = mem0.shape[1]
        scale = Dh ** (-0.5)
        n_seg = S // seg_len
        L = M + seg_len
        idx = torch.arange(L)
        mask = (idx[:, None] < M) | (idx[:, None] >= idx[None, :])
        mem = mem0
        outs = []
        for s in range(n_seg):
            xs = x[:, s * seg_len:(s + 1) * seg_len, :].clone()
            h = torch.concatenate([mem, xs], axis=1)
            q = torch.einsum('btd,dhe->bhte', h, Wq)
            k = torch.einsum('btd,dhe->bhte', h, Wk)
            v = torch.einsum('btd,dhe->bhte', h, Wv)
            scores = torch.einsum('bhqe,bhke->bhqk', q, k) * scale
            scores = torch.where(mask[None, None], scores, -1000000000.0)
            p = _softmax(scores, axis=-1)
            o = torch.einsum('bhqk,bhke->bhqe', p, v)
            o = torch.einsum('bhte,hed->btd', o, Wo)
            mem = o[:, :M, :].clone()
            outs.append(o[:, M:, :])
        return torch.concatenate(outs, axis=1)

    def _B_ref(x, w1, w2):
        h = torch.einsum('bsd,df->bsf', x, w1)
        h = _silu(h)
        out = torch.einsum('bsf,fd->bsd', h, w2)
        return out
    x = A_x
    xn = _layernorm(x, axis=-1)
    s = _A_ref(xn, A_mem0, A_Wq, A_Wk, A_Wv, A_Wo, A_seg_len)
    g = _silu(_B_ref(xn, B_w1, B_w2))
    return x + s * g
```

```asm
; @launch grid=(256,1,1) block=(256,1,1) lds=163840
.amdgcn_target "amdgcn-amd-amdhsa--gfx950"
.text
.globl recurrent_scan__memory_aug_recurrent_mem_tr__dense_activation_silu__prompt_kernel
.p2align 8
.type recurrent_scan__memory_aug_recurrent_mem_tr__dense_activation_silu__prompt_kernel,@function
recurrent_scan__memory_aug_recurrent_mem_tr__dense_activation_silu__prompt_kernel:
    s_cmp_ge_u32 s2, 256
    s_cbranch_scc1 Lexit0
    s_load_dwordx2 s[6:7], s[0:1], 88
    s_load_dwordx2 s[8:9], s[0:1], 96
    s_getreg_b32 s3, hwreg(HW_REG_XCC_ID)
    s_and_b32 s3, s3, 15
    s_mov_b32 s10, 0x10000000
    s_mov_b32 s11, 0x20000
    s_load_dwordx8 s[72:79], s[0:1], 16
    s_load_dwordx2 s[80:81], s[0:1], 8
    v_mov_b32 v1, 0
    s_waitcnt lgkmcnt(0)
    v_cmp_eq_u32 vcc, 0, v0
    s_nop 0
    s_and_saveexec_b64 s[28:29], vcc
    s_cbranch_execz Lslot_done
    s_lshl_b32 s4, s3, 2
    s_cmp_eq_u32 s3, 0
    s_cselect_b32 s4, 192, s4
    v_mov_b32 v2, s4
    v_mov_b32 v3, 1
    global_atomic_add v4, v2, v3, s[6:7] sc0
    s_waitcnt vmcnt(0)
    v_readfirstlane_b32 s5, v4
    s_lshl_b32 s4, s3, 5
    s_add_u32 s4, s4, s5
    s_cmp_ge_u32 s5, 32
    s_cbranch_scc1 Labn
    s_cmp_lt_u32 s3, 8
    s_cbranch_scc1 Lslot_ok
Labn:
    global_atomic_add v4, v1, v3, s[6:7] offset:64 sc0
    s_waitcnt vmcnt(0)
    v_readfirstlane_b32 s5, v4
    s_mov_b32 s39, 0x20000
Labn_w:
    s_load_dwordx16 s[40:55], s[6:7], 0 glc
    s_load_dword s59, s[6:7], 192 glc
    s_sub_u32 s39, s39, 1
    s_cbranch_scc1 Lexit0
    s_waitcnt lgkmcnt(0)
    s_mov_b32 s40, s59
    s_mov_b32 s4, s40
    s_add_u32 s4, s4, s41
    s_add_u32 s4, s4, s42
    s_add_u32 s4, s4, s43
    s_add_u32 s4, s4, s44
    s_add_u32 s4, s4, s45
    s_add_u32 s4, s4, s46
    s_add_u32 s4, s4, s47
    s_add_u32 s4, s4, s48
    s_add_u32 s4, s4, s49
    s_add_u32 s4, s4, s50
    s_add_u32 s4, s4, s51
    s_add_u32 s4, s4, s52
    s_add_u32 s4, s4, s53
    s_add_u32 s4, s4, s54
    s_add_u32 s4, s4, s55
    s_cmp_lt_u32 s4, 256
    s_cbranch_scc1 Labn_w
    s_mov_b32 s4, 0x20000
    s_min_u32 s56, s40, 32
    s_sub_u32 s57, 32, s56
    s_add_u32 s58, s56, 65536
    s_add_u32 s58, s58, s5
    s_cmp_lt_u32 s5, s57
    s_cselect_b32 s4, s58, s4
    s_cselect_b32 s5, 0x7fffffff, s5
    s_sub_u32 s5, s5, s57
    s_min_u32 s56, s41, 32
    s_sub_u32 s57, 32, s56
    s_add_u32 s58, s56, 65568
    s_add_u32 s58, s58, s5
    s_cmp_lt_u32 s5, s57
    s_cselect_b32 s4, s58, s4
    s_cselect_b32 s5, 0x7fffffff, s5
    s_sub_u32 s5, s5, s57
    s_min_u32 s56, s42, 32
    s_sub_u32 s57, 32, s56
    s_add_u32 s58, s56, 65600
    s_add_u32 s58, s58, s5
    s_cmp_lt_u32 s5, s57
    s_cselect_b32 s4, s58, s4
    s_cselect_b32 s5, 0x7fffffff, s5
    s_sub_u32 s5, s5, s57
    s_min_u32 s56, s43, 32
    s_sub_u32 s57, 32, s56
    s_add_u32 s58, s56, 65632
    s_add_u32 s58, s58, s5
    s_cmp_lt_u32 s5, s57
    s_cselect_b32 s4, s58, s4
    s_cselect_b32 s5, 0x7fffffff, s5
    s_sub_u32 s5, s5, s57
    s_min_u32 s56, s44, 32
    s_sub_u32 s57, 32, s56
    s_add_u32 s58, s56, 65664
    s_add_u32 s58, s58, s5
    s_cmp_lt_u32 s5, s57
    s_cselect_b32 s4, s58, s4
    s_cselect_b32 s5, 0x7fffffff, s5
    s_sub_u32 s5, s5, s57
    s_min_u32 s56, s45, 32
    s_sub_u32 s57, 32, s56
    s_add_u32 s58, s56, 65696
    s_add_u32 s58, s58, s5
    s_cmp_lt_u32 s5, s57
    s_cselect_b32 s4, s58, s4
    s_cselect_b32 s5, 0x7fffffff, s5
    s_sub_u32 s5, s5, s57
    s_min_u32 s56, s46, 32
    s_sub_u32 s57, 32, s56
    s_add_u32 s58, s56, 65728
    s_add_u32 s58, s58, s5
    s_cmp_lt_u32 s5, s57
    s_cselect_b32 s4, s58, s4
    s_cselect_b32 s5, 0x7fffffff, s5
    s_sub_u32 s5, s5, s57
    s_min_u32 s56, s47, 32
    s_sub_u32 s57, 32, s56
    s_add_u32 s58, s56, 65760
    s_add_u32 s58, s58, s5
    s_cmp_lt_u32 s5, s57
    s_cselect_b32 s4, s58, s4
    s_cselect_b32 s5, 0x7fffffff, s5
    s_sub_u32 s5, s5, s57
Lslot_ok:
    v_mov_b32 v4, s4
    ds_write_b32 v1, v4
    s_waitcnt lgkmcnt(0)
Lslot_done:
    s_mov_b64 exec, s[28:29]
    s_barrier
    ds_read_b32 v4, v1
    s_waitcnt lgkmcnt(0)
    v_readfirstlane_b32 s5, v4
    s_barrier
    s_cmp_ge_u32 s5, 0x20000
    s_cbranch_scc1 Lexit0
    s_and_b32 s4, s5, 0x10000
    s_and_b32 s28, s5, 0xff
    s_mov_b32 s2, 0
    s_cmp_lt_u32 s28, 32
    s_cbranch_scc1 Lchain
    s_lshr_b32 s30, s28, 5
    s_sub_u32 s30, s30, 1
    s_and_b32 s31, s28, 31
    s_mul_i32 s97, s30, 27
    s_add_u32 s97, s97, s31
    s_cmp_lt_u32 s31, 27
    s_cbranch_scc1 Lworker
    s_mul_i32 s28, s30, 5
    s_add_u32 s28, s28, s31
    s_sub_u32 s28, s28, 27
    s_add_u32 s97, s28, 198
    s_add_u32 s30, s28, 163
    s_cmp_lt_u32 s28, 26
    s_cselect_b32 s97, s97, s30
    s_branch Lworker
    s_cmp_ge_u32 s28, 32
    s_cbranch_scc1 Lworker
    s_mov_b32 s2, 524288
Lchain:
    v_lshrrev_b32 v20, 6, v0
    s_nop 0
    v_readfirstlane_b32 s29, v20
    v_and_b32 v21, 63, v0
    v_lshlrev_b32 v0, 4, v21
    s_mov_b32 s24, s78
    s_mov_b32 s25, s79
    s_mov_b32 s26, 4718592
    s_mov_b32 s27, 0x20000
    s_mov_b32 s12, s72
    s_mov_b32 s13, s73
    s_mov_b32 s14, 4718592
    s_mov_b32 s15, 0x20000
    s_mov_b32 s16, s74
    s_mov_b32 s17, s75
    s_mov_b32 s18, 4718592
    s_mov_b32 s19, 0x20000
    s_mov_b32 s20, s76
    s_mov_b32 s21, s77
    s_mov_b32 s22, 4718592
    s_mov_b32 s23, 0x20000
    s_mul_i32 s63, s29, 18432
    s_mul_i32 s62, s28, 147456
    s_add_u32 s62, s62, s63
    s_add_u32 m0, s63, 0
    s_add_u32 s35, s62, 73728
    buffer_load_dwordx4 v0, s[24:27], s35 offen offset:0 lds
    buffer_load_dwordx4 v0, s[24:27], s35 offen offset:1024 lds
    buffer_load_dwordx4 v0, s[24:27], s35 offen offset:2048 lds
    buffer_load_dwordx4 v0, s[24:27], s35 offen offset:3072 lds
    s_add_u32 m0, s63, 4096
    s_add_u32 s35, s62, 77824
    buffer_load_dwordx4 v0, s[24:27], s35 offen offset:0 lds
    buffer_load_dwordx4 v0, s[24:27], s35 offen offset:1024 lds
    buffer_load_dwordx4 v0, s[24:27], s35 offen offset:2048 lds
    buffer_load_dwordx4 v0, s[24:27], s35 offen offset:3072 lds
    s_add_u32 m0, s63, 8192
    s_add_u32 s35, s62, 81920
    buffer_load_dwordx4 v0, s[24:27], s35 offen offset:0 lds
    buffer_load_dwordx4 v0, s[24:27], s35 offen offset:1024 lds
    buffer_load_dwordx4 v0, s[24:27], s35 offen offset:2048 lds
    buffer_load_dwordx4 v0, s[24:27], s35 offen offset:3072 lds
    s_add_u32 m0, s63, 12288
    s_add_u32 s35, s62, 86016
    buffer_load_dwordx4 v0, s[24:27], s35 offen offset:0 lds
    buffer_load_dwordx4 v0, s[24:27], s35 offen offset:1024 lds
    buffer_load_dwordx4 v0, s[24:27], s35 offen offset:2048 lds
    buffer_load_dwordx4 v0, s[24:27], s35 offen offset:3072 lds
    s_add_u32 m0, s63, 16384
    s_add_u32 s35, s62, 90112
    buffer_load_dwordx4 v0, s[24:27], s35 offen offset:0 lds
    buffer_load_dwordx4 v0, s[24:27], s35 offen offset:1024 lds
    v_bfe_u32 v22, v21, 2, 2
    v_lshlrev_b32 v17, 1, v22
    v_bfe_u32 v22, v21, 0, 1
    v_lshl_add_u32 v17, v22, 0, v17
    v_mul_u32_u24 v17, 1152, v17
    v_lshrrev_b32 v22, 4, v21
    v_mul_u32_u24 v22, 288, v22
    v_add_u32 v17, v17, v22
    v_bfe_u32 v22, v21, 1, 1
    v_lshl_add_u32 v17, v22, 4, v17
    s_min_u32 s35, s28, 8
    s_lshl_b32 s35, s35, 5
    v_add_u32 v17, s35, v17
    global_load_dwordx4 v[28:31], v17, s[80:81]
    v_and_b32 v22, 15, v21
    v_cmp_le_u32 s[40:41], 8, v22
    v_bfe_u32 v22, v21, 1, 1
    v_mul_u32_u24 v22, 0xaaaa, v22
    v_add_u32 v1, 0x4444, v22
    s_lshl_b32 s3, s29, 12
    s_add_u32 s3, s3, 32768
    s_lshl_b32 s47, s29, 11
    s_lshl_b32 s36, s29, 9
    v_bfe_u32 v22, v21, 0, 4
    v_lshlrev_b32 v3, 4, v22
    v_bfe_u32 v22, v21, 4, 2
    v_lshl_add_u32 v3, v22, 2, v3
    s_add_u32 s35, s36, 25600
    v_add_u32 v3, s35, v3
    v_lshlrev_b32 v4, 3, v21
    s_add_u32 s35, s36, 27648
    v_add_u32 v4, s35, v4
    v_bfe_u32 v22, v21, 3, 1
    v_lshlrev_b32 v5, 8, v22
    v_bfe_u32 v22, v21, 4, 2
    v_lshl_add_u32 v5, v22, 6, v5
    v_bfe_u32 v22, v21, 2, 1
    v_lshl_add_u32 v5, v22, 4, v5
    v_bfe_u32 v22, v21, 0, 1
    v_lshl_add_u32 v5, v22, 3, v5
    v_bfe_u32 v22, v21, 3, 1
    v_lshlrev_b32 v22, 7, v22
    v_xor_b32 v5, v5, v22
    v_bfe_u32 v22, v21, 5, 1
    v_lshlrev_b32 v6, 9, v22
    v_bfe_u32 v22, v21, 4, 1
    v_lshl_add_u32 v6, v22, 6, v6
    v_bfe_u32 v22, v21, 0, 2
    v_lshl_add_u32 v6, v22, 7, v6
    v_bfe_u32 v22, v21, 2, 2
    v_lshl_add_u32 v6, v22, 3, v6
    v_bfe_u32 v22, v21, 5, 1
    v_lshlrev_b32 v11, 8, v22
    v_bfe_u32 v22, v21, 1, 2
    v_lshl_add_u32 v11, v22, 6, v11
    v_bfe_u32 v22, v21, 3, 1
    v_lshl_add_u32 v11, v22, 5, v11
    v_bfe_u32 v22, v21, 0, 1
    v_lshl_add_u32 v11, v22, 4, v11
    v_bfe_u32 v22, v21, 4, 1
    v_lshl_add_u32 v11, v22, 3, v11
    s_add_u32 s35, s36, 29696
    v_add_u32 v11, s35, v11
    v_bfe_u32 v22, v21, 4, 2
    v_lshlrev_b32 v12, 9, v22
    v_bfe_u32 v22, v21, 0, 4
    v_lshl_add_u32 v12, v22, 4, v12
    v_add_u32 v7, s47, v12
    v_bfe_u32 v22, v21, 5, 1
    v_lshlrev_b32 v13, 24, v22
    v_bfe_u32 v22, v21, 0, 5
    v_lshl_add_u32 v13, v22, 6, v13
    v_lshrrev_b32 v22, 3, v21
    v_mul_u32_u24 v8, 9344, v22
    v_and_b32 v22, 7, v21
    v_lshl_add_u32 v8, v22, 4, v8
    s_mul_i32 s35, s28, 9344
    s_add_u32 s35, s35, 100663296
    s_add_u32 s35, s35, s2
    s_lshl_b32 s37, s29, 8
    s_add_u32 s34, s35, s37
    s_add_u32 s68, s34, 4096
    s_add_u32 s69, s34, 8192
    v_bfe_u32 v22, v21, 1, 1
    v_lshlrev_b32 v9, 5, v22
    v_bfe_u32 v22, v21, 0, 1
    v_lshl_add_u32 v9, v22, 3, v9
    v_bfe_u32 v22, v21, 5, 1
    v_lshl_add_u32 v9, v22, 2, v9
    v_bfe_u32 v22, v21, 4, 1
    v_lshl_add_u32 v9, v22, 4, v9
    v_bfe_u32 v22, v21, 2, 1
    v_lshl_add_u32 v9, v22, 6, v9
    s_lshl_b32 s35, s29, 5
    s_add_u32 s35, s35, s28
    s_sub_u32 s35, s35, 32
    s_cmp_lt_u32 s35, 72
    s_cselect_b32 s70, 1, 0
    s_lshl_b32 s43, s35, 7
    s_add_u32 s42, s43, 100663296
    s_add_u32 s42, s42, s2
    s_lshl_b32 s73, s29, 10
    s_mov_b32 s44, 0x3e0293ee
    v_mov_b32 v24, -1
    v_mov_b32 v25, -1
    v_mov_b32 v26, -1
    v_mov_b32 v27, -1
    v_lshrrev_b32 v20, 2, v0
    buffer_store_dword v24, v20, s[8:11], s34 offen offset:0 sc0 sc1
    buffer_store_dword v24, v20, s[8:11], s34 offen offset:1024 sc0 sc1
    buffer_store_dword v24, v20, s[8:11], s34 offen offset:2048 sc0 sc1
    buffer_store_dword v24, v20, s[8:11], s34 offen offset:3072 sc0 sc1
    buffer_store_dword v24, v20, s[8:11], s68 offen offset:0 sc0 sc1
    buffer_store_dword v24, v20, s[8:11], s68 offen offset:1024 sc0 sc1
    buffer_store_dword v24, v20, s[8:11], s68 offen offset:2048 sc0 sc1
    buffer_store_dword v24, v20, s[8:11], s68 offen offset:3072 sc0 sc1
    buffer_store_dword v24, v20, s[8:11], s69 offen offset:0 sc0 sc1
    s_lshl_b32 s35, s28, 12
    s_add_u32 s35, s35, s73
    s_add_u32 s35, s35, 99876864
    s_cmp_eq_u32 s2, 0
    s_cselect_b32 s35, s35, 268435456
    buffer_store_dwordx4 v[24:27], v0, s[8:11], s35 offen sc0 sc1
    s_add_u32 s35, s35, 131072
    buffer_store_dwordx4 v[24:27], v0, s[8:11], s35 offen sc0 sc1
    s_add_u32 s35, s35, 131072
    buffer_store_dwordx4 v[24:27], v0, s[8:11], s35 offen sc0 sc1
    s_add_u32 s35, s35, 131072
    buffer_store_dwordx4 v[24:27], v0, s[8:11], s35 offen sc0 sc1
    s_add_u32 s35, s35, 131072
    buffer_store_dwordx4 v[24:27], v0, s[8:11], s35 offen sc0 sc1
    s_add_u32 s35, s35, 131072
    buffer_store_dwordx4 v[24:27], v0, s[8:11], s35 offen sc0 sc1
    s_add_u32 s35, s35, 131072
    s_lshl_b32 s55, s28, 10
    s_add_u32 s55, s55, 101711872
    s_add_u32 s55, s55, s2
    s_cmp_lt_u32 s28, 27
    s_cselect_b32 s55, s55, 268435456
    s_cmp_eq_u32 s29, 0
    s_cselect_b32 s55, s55, 268435456
    buffer_store_dwordx4 v[24:27], v0, s[8:11], s55 offen sc0 sc1
    s_add_u32 m0, s63, 73728
    s_add_u32 s35, s62, 0
    buffer_load_dwordx4 v0, s[24:27], s35 offen offset:0 lds
    buffer_load_dwordx4 v0, s[24:27], s35 offen offset:1024 lds
    buffer_load_dwordx4 v0, s[24:27], s35 offen offset:2048 lds
    buffer_load_dwordx4 v0, s[24:27], s35 offen offset:3072 lds
    s_add_u32 m0, s63, 77824
    s_add_u32 s35, s62, 4096
    buffer_load_dwordx4 v0, s[24:27], s35 offen offset:0 lds
    buffer_load_dwordx4 v0, s[24:27], s35 offen offset:1024 lds
    buffer_load_dwordx4 v0, s[24:27], s35 offen offset:2048 lds
    buffer_load_dwordx4 v0, s[24:27], s35 offen offset:3072 lds
    s_add_u32 m0, s63, 81920
    s_add_u32 s35, s62, 8192
    buffer_load_dwordx4 v0, s[24:27], s35 offen offset:0 lds
    buffer_load_dwordx4 v0, s[24:27], s35 offen offset:1024 lds
    buffer_load_dwordx4 v0, s[24:27], s35 offen offset:2048 lds
    buffer_load_dwordx4 v0, s[24:27], s35 offen offset:3072 lds
    s_add_u32 m0, s63, 86016
    s_add_u32 s35, s62, 12288
    buffer_load_dwordx4 v0, s[24:27], s35 offen offset:0 lds
    buffer_load_dwordx4 v0, s[24:27], s35 offen offset:1024 lds
    buffer_load_dwordx4 v0, s[24:27], s35 offen offset:2048 lds
    buffer_load_dwordx4 v0, s[24:27], s35 offen offset:3072 lds
    s_add_u32 m0, s63, 90112
    s_add_u32 s35, s62, 16384
    buffer_load_dwordx4 v0, s[24:27], s35 offen offset:0 lds
    buffer_load_dwordx4 v0, s[24:27], s35 offen offset:1024 lds
    s_cmp_eq_u32 s2, 0
    s_cselect_b32 s30, 0, 0
    s_mov_b32 s39, 0x20000
    v_lshrrev_b32 v20, 4, v0
    v_bfe_u32 v21, v20, 4, 2
    v_lshlrev_b32 v16, 13, v21
    v_bfe_u32 v21, v20, 0, 4
    v_lshl_add_u32 v16, v21, 4, v16
    v_bfe_u32 v21, v20, 5, 1
    v_lshlrev_b32 v17, 12, v21
    v_bfe_u32 v21, v20, 4, 1
    v_lshl_add_u32 v17, v21, 10, v17
    v_bfe_u32 v21, v20, 3, 1
    v_lshl_add_u32 v17, v21, 11, v17
    v_bfe_u32 v21, v20, 2, 1
    v_lshl_add_u32 v17, v21, 8, v17
    v_bfe_u32 v21, v20, 0, 2
    v_lshl_add_u32 v17, v21, 3, v17
    s_lshl_b32 s35, s29, 6
    v_add_u32 v17, s35, v17
    v_add_u32 v19, 49152, v17
    v_xor_b32 v14, 16, v17
    v_xor_b32 v15, 16, v19
    v_bfe_u32 v21, v20, 5, 1
    v_lshlrev_b32 v18, 3, v21
    v_bfe_u32 v21, v20, 4, 1
    v_lshl_add_u32 v18, v21, 2, v18
    v_bfe_u32 v21, v20, 3, 1
    v_lshl_add_u32 v18, v21, 4, v18
    v_bfe_u32 v21, v20, 2, 1
    v_lshl_add_u32 v18, v21, 0, v18
    v_mul_u32_u24 v18, 1152, v18
    v_and_b32 v21, 3, v20
    v_lshl_add_u32 v18, v21, 3, v18
    s_mul_i32 s35, s29, 288
    v_add_u32 v18, s35, v18
    v_bfe_u32 v21, v20, 3, 1
    v_mul_u32_u24 v21, 18400, v21
    v_sub_u32 v23, v18, v21
    s_lshl_b32 s53, s28, 8
    s_mul_i32 s35, s29, 1179648
    s_add_u32 s53, s53, s35
    s_lshl_b32 s52, s29, 12
    v_bfe_u32 v21, v20, 2, 1
    v_lshlrev_b32 v40, 5, v21
    v_bfe_u32 v21, v20, 4, 1
    v_lshl_add_u32 v40, v21, 6, v40
    v_bfe_u32 v21, v20, 3, 1
    v_lshl_add_u32 v40, v21, 7, v40
    v_xor_b32 v40, v40, v17
    v_xor_b32 v41, 32, v40
    v_xor_b32 v42, 48, v40
    v_bfe_u32 v21, v20, 4, 1
    v_lshlrev_b32 v21, 5, v21
    v_xor_b32 v52, v21, v0
    v_add_u32 v52, s52, v52
    v_xor_b32 v53, 64, v52
    v_xor_b32 v54, 128, v52
    v_xor_b32 v55, 192, v52
    v_xor_b32 v44, v21, v16
    v_xor_b32 v45, 64, v44
    v_xor_b32 v46, 128, v44
    v_xor_b32 v47, 192, v44
    v_add_u32 v17, 32768, v40
    v_add_u32 v19, 32768, v41
    v_add_u32 v14, 32768, v42
    v_mov_b32 v58, 0x02030200
    s_waitcnt vmcnt(49)
    s_waitcnt vmcnt(45)
    s_waitcnt vmcnt(41)
    s_waitcnt vmcnt(37)
    s_waitcnt vmcnt(33)
    s_waitcnt vmcnt(29)
    s_waitcnt vmcnt(25)
    s_add_u32 s35, s53, 0
    buffer_load_dwordx4 v[112:115], v16, s[20:23], s35 offen nt
    s_add_u32 s35, s53, 32768
    buffer_load_dwordx4 v[116:119], v16, s[20:23], s35 offen nt
    s_add_u32 s35, s53, 65536
    buffer_load_dwordx4 v[120:123], v16, s[20:23], s35 offen nt
    s_add_u32 s35, s53, 98304
    buffer_load_dwordx4 v[124:127], v16, s[20:23], s35 offen nt
    s_waitcnt vmcnt(25)
    s_add_u32 s35, s53, 131072
    buffer_load_dwordx4 v[128:131], v16, s[20:23], s35 offen nt
    s_add_u32 s35, s53, 163840
    buffer_load_dwordx4 v[132:135], v16, s[20:23], s35 offen nt
    s_add_u32 s35, s53, 196608
    buffer_load_dwordx4 v[136:139], v16, s[20:23], s35 offen nt
    s_add_u32 s35, s53, 229376
    buffer_load_dwordx4 v[140:143], v16, s[20:23], s35 offen nt
    s_waitcnt vmcnt(26)
    s_add_u32 s35, s53, 262144
    buffer_load_dwordx4 v[144:147], v16, s[20:23], s35 offen nt
    s_add_u32 s35, s53, 294912
    buffer_load_dwordx4 v[148:151], v16, s[20:23], s35 offen nt
    s_add_u32 s35, s53, 327680
    buffer_load_dwordx4 v[152:155], v16, s[20:23], s35 offen nt
    s_add_u32 s35, s53, 360448
    buffer_load_dwordx4 v[156:159], v16, s[20:23], s35 offen nt
    s_barrier
    s_cmp_lg_u32 s29, 0
    s_cbranch_scc1 Lch_reg_done
    s_add_u32 s4, s4, 1
    v_mov_b32 v24, s4
    v_mov_b32 v25, 0
    s_mov_b64 exec, 1
    global_atomic_add v25, v24, s[6:7] offset:128
    s_mov_b64 exec, -1
Lch_reg_done:
    v_min_u32 v28, -2, v28
    v_min_u32 v29, -2, v29
    v_min_u32 v30, -2, v30
    v_min_u32 v31, -2, v31
    s_cmp_lt_u32 s28, 9
    s_cselect_b32 s55, s55, 268435456
    buffer_store_dwordx4 v[28:31], v0, s[8:11], s55 offen sc0 sc1
    s_barrier
    ds_read_b64_tr_b16 a[0:1], v23 offset:0
    ds_read_b64_tr_b16 a[2:3], v23 offset:2304
    ds_read_b64_tr_b16 a[4:5], v23 offset:36864
    ds_read_b64_tr_b16 a[6:7], v23 offset:39168
    ds_read_b64_tr_b16 a[8:9], v23 offset:18432
    ds_read_b64_tr_b16 a[10:11], v23 offset:20736
    ds_read_b64_tr_b16 a[12:13], v23 offset:55296
    ds_read_b64_tr_b16 a[14:15], v23 offset:57600
    ds_read_b64_tr_b16 a[16:17], v23 offset:64
    ds_read_b64_tr_b16 a[18:19], v23 offset:2368
    ds_read_b64_tr_b16 a[20:21], v23 offset:36928
    ds_read_b64_tr_b16 a[22:23], v23 offset:39232
    ds_read_b64_tr_b16 a[24:25], v23 offset:18496
    ds_read_b64_tr_b16 a[26:27], v23 offset:20800
    ds_read_b64_tr_b16 a[28:29], v23 offset:55360
    ds_read_b64_tr_b16 a[30:31], v23 offset:57664
    ds_read_b64_tr_b16 a[32:33], v23 offset:128
    ds_read_b64_tr_b16 a[34:35], v23 offset:2432
    ds_read_b64_tr_b16 a[36:37], v23 offset:36992
    ds_read_b64_tr_b16 a[38:39], v23 offset:39296
    ds_read_b64_tr_b16 a[40:41], v23 offset:18560
    ds_read_b64_tr_b16 a[42:43], v23 offset:20864
    ds_read_b64_tr_b16 a[44:45], v23 offset:55424
    ds_read_b64_tr_b16 a[46:47], v23 offset:57728
    ds_read_b64_tr_b16 a[48:49], v23 offset:192
    ds_read_b64_tr_b16 a[50:51], v23 offset:2496
    ds_read_b64_tr_b16 a[52:53], v23 offset:37056
    ds_read_b64_tr_b16 a[54:55], v23 offset:39360
    ds_read_b64_tr_b16 a[56:57], v23 offset:18624
    ds_read_b64_tr_b16 a[58:59], v23 offset:20928
    ds_read_b64_tr_b16 a[60:61], v23 offset:55488
    ds_read_b64_tr_b16 a[62:63], v23 offset:57792
    ds_read_b64_tr_b16 a[64:65], v18 offset:256
    ds_read_b64_tr_b16 a[66:67], v18 offset:2560
    ds_read_b64_tr_b16 a[68:69], v18 offset:37120
    ds_read_b64_tr_b16 a[70:71], v18 offset:39424
    v_add_u32 v18, 73728, v18
    v_add_u32 v23, 73728, v23
    s_waitcnt vmcnt(27)
    s_add_u32 s35, s53, 393216
    buffer_load_dwordx4 v[160:163], v16, s[20:23], s35 offen nt
    s_add_u32 s35, s53, 425984
    buffer_load_dwordx4 v[164:167], v16, s[20:23], s35 offen nt
    s_add_u32 s35, s53, 458752
    buffer_load_dwordx4 v[168:171], v16, s[20:23], s35 offen nt
    s_add_u32 s35, s53, 491520
    buffer_load_dwordx4 v[172:175], v16, s[20:23], s35 offen nt
    s_waitcnt vmcnt(27)
    s_add_u32 s35, s53, 524288
    buffer_load_dwordx4 v[176:179], v16, s[20:23], s35 offen nt
    s_add_u32 s35, s53, 557056
    buffer_load_dwordx4 v[180:183], v16, s[20:23], s35 offen nt
    s_add_u32 s35, s53, 589824
    buffer_load_dwordx4 v[184:187], v16, s[20:23], s35 offen nt
    s_add_u32 s35, s53, 622592
    buffer_load_dwordx4 v[188:191], v16, s[20:23], s35 offen nt
    s_waitcnt vmcnt(27)
    s_add_u32 s35, s53, 393216
    buffer_load_dwordx4 a[208:211], v16, s[16:19], s35 offen nt
    s_add_u32 s35, s53, 425984
    buffer_load_dwordx4 a[212:215], v16, s[16:19], s35 offen nt
    s_add_u32 s35, s53, 458752
    buffer_load_dwordx4 a[216:219], v16, s[16:19], s35 offen nt
    s_add_u32 s35, s53, 491520
    buffer_load_dwordx4 a[220:223], v16, s[16:19], s35 offen nt
    s_waitcnt vmcnt(27)
    s_add_u32 s35, s53, 524288
    buffer_load_dwordx4 a[224:227], v16, s[16:19], s35 offen nt
    s_add_u32 s35, s53, 557056
    buffer_load_dwordx4 a[228:231], v16, s[16:19], s35 offen nt
    s_add_u32 s35, s53, 589824
    buffer_load_dwordx4 a[232:235], v16, s[16:19], s35 offen nt
    s_add_u32 s35, s53, 622592
    buffer_load_dwordx4 a[236:239], v16, s[16:19], s35 offen nt
    s_waitcnt vmcnt(29)
    s_barrier
    ds_read_b64_tr_b16 v[192:193], v23 offset:0
    ds_read_b64_tr_b16 v[194:195], v23 offset:2304
    ds_read_b64_tr_b16 v[196:197], v23 offset:36864
    ds_read_b64_tr_b16 v[198:199], v23 offset:39168
    ds_read_b64_tr_b16 v[200:201], v23 offset:18432
    ds_read_b64_tr_b16 v[202:203], v23 offset:20736
    ds_read_b64_tr_b16 v[204:205], v23 offset:55296
    ds_read_b64_tr_b16 v[206:207], v23 offset:57600
    ds_read_b64_tr_b16 v[208:209], v23 offset:64
    ds_read_b64_tr_b16 v[210:211], v23 offset:2368
    ds_read_b64_tr_b16 v[212:213], v23 offset:36928
    ds_read_b64_tr_b16 v[214:215], v23 offset:39232
    ds_read_b64_tr_b16 v[216:217], v23 offset:18496
    ds_read_b64_tr_b16 v[218:219], v23 offset:20800
    ds_read_b64_tr_b16 v[220:221], v23 offset:55360
    ds_read_b64_tr_b16 v[222:223], v23 offset:57664
    ds_read_b64_tr_b16 v[224:225], v23 offset:128
    ds_read_b64_tr_b16 v[226:227], v23 offset:2432
    ds_read_b64_tr_b16 v[228:229], v23 offset:36992
    ds_read_b64_tr_b16 v[230:231], v23 offset:39296
    ds_read_b64_tr_b16 v[232:233], v23 offset:18560
    ds_read_b64_tr_b16 v[234:235], v23 offset:20864
    ds_read_b64_tr_b16 v[236:237], v23 offset:55424
    ds_read_b64_tr_b16 v[238:239], v23 offset:57728
    ds_read_b64_tr_b16 v[240:241], v23 offset:192
    ds_read_b64_tr_b16 v[242:243], v23 offset:2496
    ds_read_b64_tr_b16 v[244:245], v23 offset:37056
    ds_read_b64_tr_b16 v[246:247], v23 offset:39360
    ds_read_b64_tr_b16 v[248:249], v23 offset:18624
    ds_read_b64_tr_b16 v[250:251], v23 offset:20928
    ds_read_b64_tr_b16 v[252:253], v23 offset:55488
    ds_read_b64_tr_b16 v[254:255], v23 offset:57792
    ds_read_b64_tr_b16 a[72:73], v18 offset:256
    ds_read_b64_tr_b16 a[74:75], v18 offset:2560
    ds_read_b64_tr_b16 a[76:77], v18 offset:37120
    ds_read_b64_tr_b16 a[78:79], v18 offset:39424
    s_waitcnt lgkmcnt(0)
    s_barrier
    s_add_u32 s35, s3, 65536
    v_add_u32 v2, s35, v0
    ds_write_b128 v2, v[192:195] offset:0
    ds_write_b128 v2, v[196:199] offset:1024
    ds_write_b128 v2, v[200:203] offset:2048
    ds_write_b128 v2, v[204:207] offset:3072
    ds_write_b128 v2, v[208:211] offset:16384
    ds_write_b128 v2, v[212:215] offset:17408
    ds_write_b128 v2, v[216:219] offset:18432
    ds_write_b128 v2, v[220:223] offset:19456
    ds_write_b128 v2, v[224:227] offset:32768
    ds_write_b128 v2, v[228:231] offset:33792
    ds_write_b128 v2, v[232:235] offset:34816
    ds_write_b128 v2, v[236:239] offset:35840
    ds_write_b128 v2, v[240:243] offset:49152
    ds_write_b128 v2, v[244:247] offset:50176
    ds_write_b128 v2, v[248:251] offset:51200
    ds_write_b128 v2, v[252:255] offset:52224
    v_add_u32 v2, s3, v0
    s_waitcnt lgkmcnt(0)
    s_waitcnt vmcnt(25)
    s_add_u32 s35, s53, 655360
    buffer_load_dwordx4 a[240:243], v16, s[16:19], s35 offen nt
    s_add_u32 s35, s53, 688128
    buffer_load_dwordx4 a[244:247], v16, s[16:19], s35 offen nt
    s_add_u32 s35, s53, 720896
    buffer_load_dwordx4 a[248:251], v16, s[16:19], s35 offen nt
    s_add_u32 s35, s53, 753664
    buffer_load_dwordx4 a[252:255], v16, s[16:19], s35 offen nt
    ds_write_b128 v52, v[112:115] offset:0
    ds_write_b128 v53, v[116:119] offset:1024
    ds_write_b128 v54, v[120:123] offset:2048
    ds_write_b128 v55, v[124:127] offset:3072
    s_waitcnt lgkmcnt(0)
    s_barrier
    ds_read_b64_tr_b16 v[112:113], v40 offset:0
    ds_read_b64_tr_b16 v[114:115], v40 offset:512
    ds_read_b64_tr_b16 v[116:117], v40 offset:8192
    ds_read_b64_tr_b16 v[118:119], v40 offset:8704
    ds_read_b64_tr_b16 v[120:121], v41 offset:0
    ds_read_b64_tr_b16 v[122:123], v41 offset:512
    ds_read_b64_tr_b16 v[124:125], v41 offset:8192
    ds_read_b64_tr_b16 v[126:127], v41 offset:8704
    s_waitcnt vmcnt(25)
    s_add_u32 s35, s53, 786432
    buffer_load_dwordx4 v[64:67], v16, s[16:19], s35 offen nt
    s_add_u32 s35, s53, 819200
    buffer_load_dwordx4 v[68:71], v16, s[16:19], s35 offen nt
    s_add_u32 s35, s53, 851968
    buffer_load_dwordx4 v[72:75], v16, s[16:19], s35 offen nt
    s_add_u32 s35, s53, 884736
    buffer_load_dwordx4 v[76:79], v16, s[16:19], s35 offen nt
    ds_write_b128 v52, v[128:131] offset:16384
    ds_write_b128 v53, v[132:135] offset:17408
    ds_write_b128 v54, v[136:139] offset:18432
    ds_write_b128 v55, v[140:143] offset:19456
    s_waitcnt lgkmcnt(0)
    s_barrier
    ds_read_b64_tr_b16 v[128:129], v40 offset:16384
    ds_read_b64_tr_b16 v[130:131], v40 offset:16896
    ds_read_b64_tr_b16 v[132:133], v40 offset:24576
    ds_read_b64_tr_b16 v[134:135], v40 offset:25088
    ds_read_b64_tr_b16 v[136:137], v41 offset:16384
    ds_read_b64_tr_b16 v[138:139], v41 offset:16896
    ds_read_b64_tr_b16 v[140:141], v41 offset:24576
    ds_read_b64_tr_b16 v[142:143], v41 offset:25088
    s_waitcnt vmcnt(25)
    s_add_u32 s35, s53, 917504
    buffer_load_dwordx4 v[80:83], v16, s[16:19], s35 offen nt
    s_add_u32 s35, s53, 950272
    buffer_load_dwordx4 v[84:87], v16, s[16:19], s35 offen nt
    s_add_u32 s35, s53, 983040
    buffer_load_dwordx4 v[88:91], v16, s[16:19], s35 offen nt
    s_add_u32 s35, s53, 1015808
    buffer_load_dwordx4 v[92:95], v16, s[16:19], s35 offen nt
    ds_write_b128 v52, v[144:147] offset:0
    ds_write_b128 v53, v[148:151] offset:1024
    ds_write_b128 v54, v[152:155] offset:2048
    ds_write_b128 v55, v[156:159] offset:3072
    s_waitcnt lgkmcnt(0)
    s_barrier
    ds_read_b64_tr_b16 v[144:145], v40 offset:0
    ds_read_b64_tr_b16 v[146:147], v40 offset:512
    ds_read_b64_tr_b16 v[148:149], v40 offset:8192
    ds_read_b64_tr_b16 v[150:151], v40 offset:8704
    ds_read_b64_tr_b16 v[152:153], v41 offset:0
    ds_read_b64_tr_b16 v[154:155], v41 offset:512
    ds_read_b64_tr_b16 v[156:157], v41 offset:8192
    ds_read_b64_tr_b16 v[158:159], v41 offset:8704
    s_waitcnt vmcnt(25)
    s_add_u32 s35, s53, 1048576
    buffer_load_dwordx4 v[96:99], v16, s[16:19], s35 offen nt
    s_add_u32 s35, s53, 1081344
    buffer_load_dwordx4 v[100:103], v16, s[16:19], s35 offen nt
    s_add_u32 s35, s53, 1114112
    buffer_load_dwordx4 v[104:107], v16, s[16:19], s35 offen nt
    s_add_u32 s35, s53, 1146880
    buffer_load_dwordx4 v[108:111], v16, s[16:19], s35 offen nt
    s_waitcnt vmcnt(28)
    s_add_u32 s35, s53, 0
    buffer_load_dwordx4 a[80:83], v16, s[12:15], s35 offen nt
    s_add_u32 s35, s53, 32768
    buffer_load_dwordx4 a[84:87], v16, s[12:15], s35 offen nt
    s_add_u32 s35, s53, 65536
    buffer_load_dwordx4 a[88:91], v16, s[12:15], s35 offen nt
    s_add_u32 s35, s53, 98304
    buffer_load_dwordx4 a[92:95], v16, s[12:15], s35 offen nt
    ds_write_b128 v52, v[160:163] offset:16384
    ds_write_b128 v53, v[164:167] offset:17408
    ds_write_b128 v54, v[168:171] offset:18432
    ds_write_b128 v55, v[172:175] offset:19456
    s_waitcnt lgkmcnt(0)
    s_barrier
    ds_read_b64_tr_b16 v[160:161], v40 offset:16384
    ds_read_b64_tr_b16 v[162:163], v40 offset:16896
    ds_read_b64_tr_b16 v[164:165], v40 offset:24576
    ds_read_b64_tr_b16 v[166:167], v40 offset:25088
    ds_read_b64_tr_b16 v[168:169], v41 offset:16384
    ds_read_b64_tr_b16 v[170:171], v41 offset:16896
    ds_read_b64_tr_b16 v[172:173], v41 offset:24576
    ds_read_b64_tr_b16 v[174:175], v41 offset:25088
    s_waitcnt vmcnt(28)
    s_add_u32 s35, s53, 0
    s_add_u32 m0, s52, 32768
    s_nop 0
    buffer_load_dwordx4 v44, s[16:19], s35 offen nt lds
    s_add_u32 s35, s53, 32768
    s_add_u32 m0, s52, 33792
    s_nop 0
    buffer_load_dwordx4 v45, s[16:19], s35 offen nt lds
    s_add_u32 s35, s53, 65536
    s_add_u32 m0, s52, 34816
    s_nop 0
    buffer_load_dwordx4 v46, s[16:19], s35 offen nt lds
    s_add_u32 s35, s53, 98304
    s_add_u32 m0, s52, 35840
    s_nop 0
    buffer_load_dwordx4 v47, s[16:19], s35 offen nt lds
    ds_write_b128 v52, v[176:179] offset:0
    ds_write_b128 v53, v[180:183] offset:1024
    ds_write_b128 v54, v[184:187] offset:2048
    ds_write_b128 v55, v[188:191] offset:3072
    s_waitcnt lgkmcnt(0)
    s_barrier
    ds_read_b64_tr_b16 v[176:177], v40 offset:0
    ds_read_b64_tr_b16 v[178:179], v40 offset:512
    ds_read_b64_tr_b16 v[180:181], v40 offset:8192
    ds_read_b64_tr_b16 v[182:183], v40 offset:8704
    ds_read_b64_tr_b16 v[184:185], v41 offset:0
    ds_read_b64_tr_b16 v[186:187], v41 offset:512
    ds_read_b64_tr_b16 v[188:189], v41 offset:8192
    ds_read_b64_tr_b16 v[190:191], v41 offset:8704
    s_waitcnt vmcnt(28)
    s_add_u32 s35, s53, 131072
    s_add_u32 m0, s52, 49152
    s_nop 0
    buffer_load_dwordx4 v44, s[16:19], s35 offen nt lds
    s_add_u32 s35, s53, 163840
    s_add_u32 m0, s52, 50176
    s_nop 0
    buffer_load_dwordx4 v45, s[16:19], s35 offen nt lds
    s_add_u32 s35, s53, 196608
    s_add_u32 m0, s52, 51200
    s_nop 0
    buffer_load_dwordx4 v46, s[16:19], s35 offen nt lds
    s_add_u32 s35, s53, 229376
    s_add_u32 m0, s52, 52224
    s_nop 0
    buffer_load_dwordx4 v47, s[16:19], s35 offen nt lds
    ds_write_b128 v52, a[208:211] offset:16384
    ds_write_b128 v53, a[212:215] offset:17408
    ds_write_b128 v54, a[216:219] offset:18432
    ds_write_b128 v55, a[220:223] offset:19456
    s_waitcnt lgkmcnt(0)
    s_barrier
    ds_read_b64_tr_b16 a[208:209], v40 offset:16384
    ds_read_b64_tr_b16 a[210:211], v40 offset:16896
    ds_read_b64_tr_b16 a[212:213], v40 offset:24576
    ds_read_b64_tr_b16 a[214:215], v40 offset:25088
    ds_read_b64_tr_b16 a[216:217], v41 offset:16384
    ds_read_b64_tr_b16 a[218:219], v41 offset:16896
    ds_read_b64_tr_b16 a[220:221], v41 offset:24576
    ds_read_b64_tr_b16 a[222:223], v41 offset:25088
    s_waitcnt vmcnt(28)
    s_add_u32 s35, s53, 262144
    s_add_u32 m0, s52, 65536
    s_nop 0
    buffer_load_dwordx4 v44, s[16:19], s35 offen nt lds
    s_add_u32 s35, s53, 294912
    s_add_u32 m0, s52, 66560
    s_nop 0
    buffer_load_dwordx4 v45, s[16:19], s35 offen nt lds
    s_add_u32 s35, s53, 327680
    s_add_u32 m0, s52, 67584
    s_nop 0
    buffer_load_dwordx4 v46, s[16:19], s35 offen nt lds
    s_add_u32 s35, s53, 360448
    s_add_u32 m0, s52, 68608
    s_nop 0
    buffer_load_dwordx4 v47, s[16:19], s35 offen nt lds
    ds_write_b128 v52, a[224:227] offset:0
    ds_write_b128 v53, a[228:231] offset:1024
    ds_write_b128 v54, a[232:235] offset:2048
    ds_write_b128 v55, a[236:239] offset:3072
    s_waitcnt lgkmcnt(0)
    s_barrier
    v_mov_b32 v56, 0
    global_load_dwordx2 v[56:57], v56, s[6:7] offset:128 sc1
    ds_read_b64_tr_b16 a[224:225], v40 offset:0
    ds_read_b64_tr_b16 a[226:227], v40 offset:512
    ds_read_b64_tr_b16 a[228:229], v40 offset:8192
    ds_read_b64_tr_b16 a[230:231], v40 offset:8704
    ds_read_b64_tr_b16 a[232:233], v41 offset:0
    ds_read_b64_tr_b16 a[234:235], v41 offset:512
    ds_read_b64_tr_b16 a[236:237], v41 offset:8192
    ds_read_b64_tr_b16 a[238:239], v41 offset:8704
    s_waitcnt vmcnt(29)
    ds_write_b128 v52, a[240:243] offset:16384
    ds_write_b128 v53, a[244:247] offset:17408
    ds_write_b128 v54, a[248:251] offset:18432
    ds_write_b128 v55, a[252:255] offset:19456
    s_waitcnt lgkmcnt(0)
    s_barrier
    ds_read_b64_tr_b16 a[240:241], v40 offset:16384
    ds_read_b64_tr_b16 a[242:243], v40 offset:16896
    ds_read_b64_tr_b16 a[244:245], v40 offset:24576
    ds_read_b64_tr_b16 a[246:247], v40 offset:25088
    ds_read_b64_tr_b16 a[248:249], v41 offset:16384
    ds_read_b64_tr_b16 a[250:251], v41 offset:16896
    ds_read_b64_tr_b16 a[252:253], v41 offset:24576
    ds_read_b64_tr_b16 a[254:255], v41 offset:25088
    s_waitcnt vmcnt(25)
    s_add_u32 s35, s53, 393216
    s_add_u32 m0, s52, 81920
    s_nop 0
    buffer_load_dwordx4 v44, s[12:15], s35 offen nt lds
    s_add_u32 s35, s53, 425984
    s_add_u32 m0, s52, 82944
    s_nop 0
    buffer_load_dwordx4 v45, s[12:15], s35 offen nt lds
    s_add_u32 s35, s53, 458752
    s_add_u32 m0, s52, 83968
    s_nop 0
    buffer_load_dwordx4 v46, s[12:15], s35 offen nt lds
    s_add_u32 s35, s53, 491520
    s_add_u32 m0, s52, 84992
    s_nop 0
    buffer_load_dwordx4 v47, s[12:15], s35 offen nt lds
    ds_write_b128 v52, v[64:67] offset:0
    ds_write_b128 v53, v[68:71] offset:1024
    ds_write_b128 v54, v[72:75] offset:2048
    ds_write_b128 v55, v[76:79] offset:3072
    s_waitcnt lgkmcnt(0)
    s_barrier
    ds_read_b64_tr_b16 v[64:65], v40 offset:0
    ds_read_b64_tr_b16 v[66:67], v40 offset:512
    ds_read_b64_tr_b16 v[68:69], v40 offset:8192
    ds_read_b64_tr_b16 v[70:71], v40 offset:8704
    ds_read_b64_tr_b16 v[72:73], v41 offset:0
    ds_read_b64_tr_b16 v[74:75], v41 offset:512
    ds_read_b64_tr_b16 v[76:77], v41 offset:8192
    ds_read_b64_tr_b16 v[78:79], v41 offset:8704
    s_waitcnt vmcnt(25)
    s_add_u32 s35, s53, 655360
    buffer_load_dwordx4 v[192:195], v16, s[20:23], s35 offen nt
    s_add_u32 s35, s53, 688128
    buffer_load_dwordx4 v[196:199], v16, s[20:23], s35 offen nt
    s_add_u32 s35, s53, 720896
    buffer_load_dwordx4 v[200:203], v16, s[20:23], s35 offen nt
    s_add_u32 s35, s53, 753664
    buffer_load_dwordx4 v[204:207], v16, s[20:23], s35 offen nt
    ds_write_b128 v52, v[80:83] offset:16384
    ds_write_b128 v53, v[84:87] offset:17408
    ds_write_b128 v54, v[88:91] offset:18432
    ds_write_b128 v55, v[92:95] offset:19456
    s_waitcnt lgkmcnt(0)
    s_barrier
    ds_read_b64_tr_b16 v[80:81], v40 offset:16384
    ds_read_b64_tr_b16 v[82:83], v40 offset:16896
    ds_read_b64_tr_b16 v[84:85], v40 offset:24576
    ds_read_b64_tr_b16 v[86:87], v40 offset:25088
    ds_read_b64_tr_b16 v[88:89], v41 offset:16384
    ds_read_b64_tr_b16 v[90:91], v41 offset:16896
    ds_read_b64_tr_b16 v[92:93], v41 offset:24576
    ds_read_b64_tr_b16 v[94:95], v41 offset:25088
    s_waitcnt vmcnt(25)
    s_add_u32 s35, s53, 786432
    buffer_load_dwordx4 v[208:211], v16, s[20:23], s35 offen nt
    s_add_u32 s35, s53, 819200
    buffer_load_dwordx4 v[212:215], v16, s[20:23], s35 offen nt
    s_add_u32 s35, s53, 851968
    buffer_load_dwordx4 v[216:219], v16, s[20:23], s35 offen nt
    s_add_u32 s35, s53, 884736
    buffer_load_dwordx4 v[220:223], v16, s[20:23], s35 offen nt
    ds_write_b128 v52, v[96:99] offset:0
    ds_write_b128 v53, v[100:103] offset:1024
    ds_write_b128 v54, v[104:107] offset:2048
    ds_write_b128 v55, v[108:111] offset:3072
    s_waitcnt lgkmcnt(0)
    s_barrier
    ds_read_b64_tr_b16 v[96:97], v40 offset:0
    ds_read_b64_tr_b16 v[98:99], v40 offset:512
    ds_read_b64_tr_b16 v[100:101], v40 offset:8192
    ds_read_b64_tr_b16 v[102:103], v40 offset:8704
    ds_read_b64_tr_b16 v[104:105], v41 offset:0
    ds_read_b64_tr_b16 v[106:107], v41 offset:512
    ds_read_b64_tr_b16 v[108:109], v41 offset:8192
    ds_read_b64_tr_b16 v[110:111], v41 offset:8704
    s_waitcnt vmcnt(25)
    s_add_u32 s35, s53, 917504
    buffer_load_dwordx4 v[224:227], v16, s[20:23], s35 offen nt
    s_add_u32 s35, s53, 950272
    buffer_load_dwordx4 v[228:231], v16, s[20:23], s35 offen nt
    s_add_u32 s35, s53, 983040
    buffer_load_dwordx4 v[232:235], v16, s[20:23], s35 offen nt
    s_add_u32 s35, s53, 1015808
    buffer_load_dwordx4 v[236:239], v16, s[20:23], s35 offen nt
    ds_write_b128 v52, a[80:83] offset:16384
    ds_write_b128 v53, a[84:87] offset:17408
    ds_write_b128 v54, a[88:91] offset:18432
    ds_write_b128 v55, a[92:95] offset:19456
    s_waitcnt lgkmcnt(0)
    s_barrier
    ds_read_b64_tr_b16 a[80:81], v40 offset:16384
    ds_read_b64_tr_b16 a[82:83], v40 offset:16896
    ds_read_b64_tr_b16 a[84:85], v40 offset:24576
    ds_read_b64_tr_b16 a[86:87], v40 offset:25088
    ds_read_b64_tr_b16 a[88:89], v42 offset:16384
    ds_read_b64_tr_b16 a[90:91], v42 offset:16896
    ds_read_b64_tr_b16 a[92:93], v42 offset:24576
    ds_read_b64_tr_b16 a[94:95], v42 offset:25088
    s_waitcnt vmcnt(25)
    s_add_u32 s35, s53, 1048576
    buffer_load_dwordx4 v[240:243], v16, s[20:23], s35 offen nt
    s_add_u32 s35, s53, 1081344
    buffer_load_dwordx4 v[244:247], v16, s[20:23], s35 offen nt
    s_add_u32 s35, s53, 1114112
    buffer_load_dwordx4 v[248:251], v16, s[20:23], s35 offen nt
    s_add_u32 s35, s53, 1146880
    buffer_load_dwordx4 v[252:255], v16, s[20:23], s35 offen nt
    s_waitcnt lgkmcnt(0)
    s_barrier
    ds_read_b64_tr_b16 v[24:25], v17 offset:0
    ds_read_b64_tr_b16 v[26:27], v17 offset:512
    ds_read_b64_tr_b16 v[28:29], v17 offset:8192
    ds_read_b64_tr_b16 v[30:31], v17 offset:8704
    ds_read_b64_tr_b16 v[32:33], v19 offset:0
    ds_read_b64_tr_b16 v[34:35], v19 offset:512
    ds_read_b64_tr_b16 v[36:37], v19 offset:8192
    ds_read_b64_tr_b16 v[38:39], v19 offset:8704
    s_waitcnt lgkmcnt(0)
    s_barrier
    ds_write_b128 v2, v[24:27] offset:0
    ds_write_b128 v2, v[28:31] offset:1024
    ds_write_b128 v2, v[32:35] offset:2048
    ds_write_b128 v2, v[36:39] offset:3072
    s_waitcnt vmcnt(25)
    s_add_u32 s35, s53, 131072
    buffer_load_dwordx4 a[96:99], v16, s[12:15], s35 offen nt
    s_add_u32 s35, s53, 163840
    buffer_load_dwordx4 a[100:103], v16, s[12:15], s35 offen nt
    s_add_u32 s35, s53, 196608
    buffer_load_dwordx4 a[104:107], v16, s[12:15], s35 offen nt
    s_add_u32 s35, s53, 229376
    buffer_load_dwordx4 a[108:111], v16, s[12:15], s35 offen nt
    s_waitcnt lgkmcnt(0)
    s_barrier
    s_waitcnt vmcnt(24)
    v_readfirstlane_b32 s56, v56
    v_readfirstlane_b32 s57, v57
    s_branch Lch_reg_chk
Lch_reg_poll:
    s_sleep 2
    s_load_dwordx2 s[56:57], s[6:7], 128 glc
    s_sub_u32 s39, s39, 1
    s_cbranch_scc1 Lch_bail
    s_waitcnt lgkmcnt(0)
Lch_reg_chk:
    s_and_b32 s36, s56, 0xffff
    s_cmp_lg_u32 s36, 32
    s_cbranch_scc1 Lch_reg_poll
    s_cmp_eq_u32 s57, 0
    s_cbranch_scc1 Lch_reg_poll
    s_lshr_b32 s4, s56, 16
    s_or_b32 s4, s4, s2
    ds_read_b64_tr_b16 v[24:25], v17 offset:16384
    ds_read_b64_tr_b16 v[26:27], v17 offset:16896
    ds_read_b64_tr_b16 v[28:29], v17 offset:24576
    ds_read_b64_tr_b16 v[30:31], v17 offset:25088
    ds_read_b64_tr_b16 v[32:33], v19 offset:16384
    ds_read_b64_tr_b16 v[34:35], v19 offset:16896
    ds_read_b64_tr_b16 v[36:37], v19 offset:24576
    ds_read_b64_tr_b16 v[38:39], v19 offset:25088
    s_waitcnt lgkmcnt(0)
    s_barrier
    ds_write_b128 v2, v[24:27] offset:16384
    ds_write_b128 v2, v[28:31] offset:17408
    ds_write_b128 v2, v[32:35] offset:18432
    ds_write_b128 v2, v[36:39] offset:19456
    s_add_u32 s35, s53, 262144
    buffer_load_dwordx4 a[112:115], v16, s[12:15], s35 offen nt
    s_add_u32 s35, s53, 294912
    buffer_load_dwordx4 a[116:119], v16, s[12:15], s35 offen nt
    s_add_u32 s35, s53, 327680
    buffer_load_dwordx4 a[120:123], v16, s[12:15], s35 offen nt
    s_add_u32 s35, s53, 360448
    buffer_load_dwordx4 a[124:127], v16, s[12:15], s35 offen nt
    s_add_u32 s35, s53, 524288
    buffer_load_dwordx4 a[128:131], v16, s[12:15], s35 offen nt
    s_add_u32 s35, s53, 557056
    buffer_load_dwordx4 a[132:135], v16, s[12:15], s35 offen nt
    s_add_u32 s35, s53, 589824
    buffer_load_dwordx4 a[136:139], v16, s[12:15], s35 offen nt
    s_add_u32 s35, s53, 622592
    buffer_load_dwordx4 a[140:143], v16, s[12:15], s35 offen nt
    s_waitcnt lgkmcnt(0)
    s_barrier
    s_getpc_b64 s[56:57]
Lch_pc:
    s_add_u32 s56, s56, Lch_fast_loop-Lch_pc
    s_addc_u32 s57, s57, 0
    v_lshlrev_b32 v22, 2, v0
    s_lshl_b32 s35, s29, 12
    v_add_u32 v22, s35, v22
    global_load_dword v10, v22, s[56:57]
    s_mul_i32 s35, s28, 9344
    s_add_u32 s35, s35, 100663296
    s_add_u32 s35, s35, s2
    buffer_load_dword v10, v22, s[8:11], s35 offen sc1
    s_and_b32 s35, s28, 1
    s_lshl_b32 s35, s35, 14
    s_add_u32 s35, s35, 101711872
    s_add_u32 s35, s35, s2
    buffer_load_dword v10, v22, s[8:11], s35 offen sc1
    ds_read_b64_tr_b16 v[24:25], v17 offset:32768
    ds_read_b64_tr_b16 v[26:27], v17 offset:33280
    ds_read_b64_tr_b16 v[28:29], v17 offset:40960
    ds_read_b64_tr_b16 v[30:31], v17 offset:41472
    ds_read_b64_tr_b16 v[32:33], v19 offset:32768
    ds_read_b64_tr_b16 v[34:35], v19 offset:33280
    ds_read_b64_tr_b16 v[36:37], v19 offset:40960
    ds_read_b64_tr_b16 v[38:39], v19 offset:41472
    s_waitcnt lgkmcnt(0)
    s_barrier
    ds_write_b128 v2, v[24:27] offset:32768
    ds_write_b128 v2, v[28:31] offset:33792
    ds_write_b128 v2, v[32:35] offset:34816
    ds_write_b128 v2, v[36:39] offset:35840
    s_waitcnt vmcnt(31)
    s_waitcnt lgkmcnt(0)
    s_barrier
    ds_read_b64_tr_b16 v[24:25], v17 offset:49152
    ds_read_b64_tr_b16 v[26:27], v17 offset:49664
    ds_read_b64_tr_b16 v[28:29], v17 offset:57344
    ds_read_b64_tr_b16 v[30:31], v17 offset:57856
    ds_read_b64_tr_b16 v[32:33], v14 offset:49152
    ds_read_b64_tr_b16 v[34:35], v14 offset:49664
    ds_read_b64_tr_b16 v[36:37], v14 offset:57344
    ds_read_b64_tr_b16 v[38:39], v14 offset:57856
    s_waitcnt lgkmcnt(0)
    s_barrier
    ds_write_b128 v2, v[24:27] offset:49152
    ds_write_b128 v2, v[28:31] offset:50176
    ds_write_b128 v2, v[32:35] offset:51200
    ds_write_b128 v2, v[36:39] offset:52224
    s_waitcnt vmcnt(27)
    s_add_u32 s35, s53, 655360
    buffer_load_dwordx4 a[144:147], v16, s[12:15], s35 offen nt
    s_add_u32 s35, s53, 688128
    buffer_load_dwordx4 a[148:151], v16, s[12:15], s35 offen nt
    s_add_u32 s35, s53, 720896
    buffer_load_dwordx4 a[152:155], v16, s[12:15], s35 offen nt
    s_add_u32 s35, s53, 753664
    buffer_load_dwordx4 a[156:159], v16, s[12:15], s35 offen nt
    ds_write_b128 v52, v[192:195] offset:0
    ds_write_b128 v53, v[196:199] offset:1024
    ds_write_b128 v54, v[200:203] offset:2048
    ds_write_b128 v55, v[204:207] offset:3072
    s_waitcnt lgkmcnt(0)
    s_barrier
    ds_read_b64_tr_b16 v[192:193], v40 offset:0
    ds_read_b64_tr_b16 v[194:195], v40 offset:512
    ds_read_b64_tr_b16 v[196:197], v40 offset:8192
    ds_read_b64_tr_b16 v[198:199], v40 offset:8704
    ds_read_b64_tr_b16 v[200:201], v41 offset:0
    ds_read_b64_tr_b16 v[202:203], v41 offset:512
    ds_read_b64_tr_b16 v[204:205], v41 offset:8192
    ds_read_b64_tr_b16 v[206:207], v41 offset:8704
    s_waitcnt vmcnt(27)
    s_add_u32 s35, s53, 786432
    buffer_load_dwordx4 a[160:163], v16, s[12:15], s35 offen nt
    s_add_u32 s35, s53, 819200
    buffer_load_dwordx4 a[164:167], v16, s[12:15], s35 offen nt
    s_add_u32 s35, s53, 851968
    buffer_load_dwordx4 a[168:171], v16, s[12:15], s35 offen nt
    s_add_u32 s35, s53, 884736
    buffer_load_dwordx4 a[172:175], v16, s[12:15], s35 offen nt
    ds_write_b128 v52, v[208:211] offset:16384
    ds_write_b128 v53, v[212:215] offset:17408
    ds_write_b128 v54, v[216:219] offset:18432
    ds_write_b128 v55, v[220:223] offset:19456
    s_waitcnt lgkmcnt(0)
    s_barrier
    s_lshl_b32 s35, s28, 7
    s_add_u32 s35, s35, 102764544
    s_cmp_eq_u32 s29, 0
    s_cselect_b32 s27, s35, 268435456
    s_lshr_b32 s35, s28, 1
    s_lshl_b32 s35, s35, 11
    s_add_u32 s24, s35, 102776832
    s_cmp_eq_u32 s29, 0
    s_cselect_b32 s25, s24, 268435456
    s_mov_b32 s26, 0
    s_mov_b64 exec, 0x555
    buffer_load_dword v10, v13, s[8:11], s24 offen sc1
    s_mov_b64 exec, -1
    ds_read_b64_tr_b16 v[208:209], v40 offset:16384
    ds_read_b64_tr_b16 v[210:211], v40 offset:16896
    ds_read_b64_tr_b16 v[212:213], v40 offset:24576
    ds_read_b64_tr_b16 v[214:215], v40 offset:25088
    ds_read_b64_tr_b16 v[216:217], v41 offset:16384
    ds_read_b64_tr_b16 v[218:219], v41 offset:16896
    ds_read_b64_tr_b16 v[220:221], v41 offset:24576
    ds_read_b64_tr_b16 v[222:223], v41 offset:25088
    s_waitcnt vmcnt(28)
    s_add_u32 s35, s53, 917504
    buffer_load_dwordx4 a[176:179], v16, s[12:15], s35 offen nt
    s_add_u32 s35, s53, 950272
    buffer_load_dwordx4 a[180:183], v16, s[12:15], s35 offen nt
    s_add_u32 s35, s53, 983040
    buffer_load_dwordx4 a[184:187], v16, s[12:15], s35 offen nt
    s_add_u32 s35, s53, 1015808
    buffer_load_dwordx4 a[188:191], v16, s[12:15], s35 offen nt
    ds_write_b128 v52, v[224:227] offset:0
    ds_write_b128 v53, v[228:231] offset:1024
    ds_write_b128 v54, v[232:235] offset:2048
    ds_write_b128 v55, v[236:239] offset:3072
    s_waitcnt lgkmcnt(0)
    s_barrier
    ds_read_b64_tr_b16 v[224:225], v40 offset:0
    ds_read_b64_tr_b16 v[226:227], v40 offset:512
    ds_read_b64_tr_b16 v[228:229], v40 offset:8192
    ds_read_b64_tr_b16 v[230:231], v40 offset:8704
    ds_read_b64_tr_b16 v[232:233], v41 offset:0
    ds_read_b64_tr_b16 v[234:235], v41 offset:512
    ds_read_b64_tr_b16 v[236:237], v41 offset:8192
    ds_read_b64_tr_b16 v[238:239], v41 offset:8704
    s_waitcnt vmcnt(28)
    s_add_u32 s35, s53, 1048576
    buffer_load_dwordx4 a[192:195], v16, s[12:15], s35 offen nt
    s_add_u32 s35, s53, 1081344
    buffer_load_dwordx4 a[196:199], v16, s[12:15], s35 offen nt
    s_add_u32 s35, s53, 1114112
    buffer_load_dwordx4 a[200:203], v16, s[12:15], s35 offen nt
    s_add_u32 s35, s53, 1146880
    buffer_load_dwordx4 a[204:207], v16, s[12:15], s35 offen nt
    ds_write_b128 v52, v[240:243] offset:16384
    ds_write_b128 v53, v[244:247] offset:17408
    ds_write_b128 v54, v[248:251] offset:18432
    ds_write_b128 v55, v[252:255] offset:19456
    s_waitcnt lgkmcnt(0)
    s_barrier
    ds_read_b64_tr_b16 v[240:241], v40 offset:16384
    ds_read_b64_tr_b16 v[242:243], v40 offset:16896
    ds_read_b64_tr_b16 v[244:245], v40 offset:24576
    ds_read_b64_tr_b16 v[246:247], v40 offset:25088
    ds_read_b64_tr_b16 v[248:249], v41 offset:16384
    ds_read_b64_tr_b16 v[250:251], v41 offset:16896
    ds_read_b64_tr_b16 v[252:253], v41 offset:24576
    ds_read_b64_tr_b16 v[254:255], v41 offset:25088
    s_waitcnt vmcnt(28)
    ds_write_b128 v52, a[96:99] offset:0
    ds_write_b128 v53, a[100:103] offset:1024
    ds_write_b128 v54, a[104:107] offset:2048
    ds_write_b128 v55, a[108:111] offset:3072
    s_waitcnt lgkmcnt(0)
    s_barrier
    ds_read_b64_tr_b16 a[96:97], v40 offset:0
    ds_read_b64_tr_b16 a[98:99], v40 offset:512
    ds_read_b64_tr_b16 a[100:101], v40 offset:8192
    ds_read_b64_tr_b16 a[102:103], v40 offset:8704
    ds_read_b64_tr_b16 a[104:105], v42 offset:0
    ds_read_b64_tr_b16 a[106:107], v42 offset:512
    ds_read_b64_tr_b16 a[108:109], v42 offset:8192
    ds_read_b64_tr_b16 a[110:111], v42 offset:8704
    s_waitcnt vmcnt(24)
    ds_write_b128 v52, a[112:115] offset:16384
    ds_write_b128 v53, a[116:119] offset:17408
    ds_write_b128 v54, a[120:123] offset:18432
    ds_write_b128 v55, a[124:127] offset:19456
    s_waitcnt lgkmcnt(0)
    s_barrier
    ds_read_b64_tr_b16 a[112:113], v40 offset:16384
    ds_read_b64_tr_b16 a[114:115], v40 offset:16896
    ds_read_b64_tr_b16 a[116:117], v40 offset:24576
    ds_read_b64_tr_b16 a[118:119], v40 offset:25088
    ds_read_b64_tr_b16 a[120:121], v42 offset:16384
    ds_read_b64_tr_b16 a[122:123], v42 offset:16896
    ds_read_b64_tr_b16 a[124:125], v42 offset:24576
    ds_read_b64_tr_b16 a[126:127], v42 offset:25088
    s_waitcnt vmcnt(20)
    ds_write_b128 v52, a[128:131] offset:0
    ds_write_b128 v53, a[132:135] offset:1024
    ds_write_b128 v54, a[136:139] offset:2048
    ds_write_b128 v55, a[140:143] offset:3072
    s_waitcnt lgkmcnt(0)
    s_barrier
    ds_read_b64_tr_b16 a[128:129], v40 offset:0
    ds_read_b64_tr_b16 a[130:131], v40 offset:512
    ds_read_b64_tr_b16 a[132:133], v40 offset:8192
    ds_read_b64_tr_b16 a[134:135], v40 offset:8704
    ds_read_b64_tr_b16 a[136:137], v42 offset:0
    ds_read_b64_tr_b16 a[138:139], v42 offset:512
    ds_read_b64_tr_b16 a[140:141], v42 offset:8192
    ds_read_b64_tr_b16 a[142:143], v42 offset:8704
    s_waitcnt vmcnt(13)
    ds_write_b128 v52, a[144:147] offset:16384
    ds_write_b128 v53, a[148:151] offset:17408
    ds_write_b128 v54, a[152:155] offset:18432
    ds_write_b128 v55, a[156:159] offset:19456
    s_waitcnt lgkmcnt(0)
    s_barrier
    ds_read_b64_tr_b16 a[144:145], v40 offset:16384
    ds_read_b64_tr_b16 a[146:147], v40 offset:16896
    ds_read_b64_tr_b16 a[148:149], v40 offset:24576
    ds_read_b64_tr_b16 a[150:151], v40 offset:25088
    ds_read_b64_tr_b16 a[152:153], v42 offset:16384
    ds_read_b64_tr_b16 a[154:155], v42 offset:16896
    ds_read_b64_tr_b16 a[156:157], v42 offset:24576
    ds_read_b64_tr_b16 a[158:159], v42 offset:25088
    s_waitcnt vmcnt(9)
    ds_write_b128 v52, a[160:163] offset:0
    ds_write_b128 v53, a[164:167] offset:1024
    ds_write_b128 v54, a[168:171] offset:2048
    ds_write_b128 v55, a[172:175] offset:3072
    s_waitcnt lgkmcnt(0)
    s_barrier
    s_lshl_b32 s45, s30, 5
    s_add_u32 s45, s45, s28
    s_lshl_b32 s45, s45, 13
    s_add_u32 s45, s45, s47
    s_lshr_b32 s72, s45, 1
    s_add_u32 s72, s72, 92274688
    s_add_u32 s33, s2, 101711872
    s_add_u32 s32, s2, 101721088
    s_mov_b32 s31, 101730304
    s_cmp_eq_u32 s2, 0
    s_cselect_b32 s31, s31, 101711872
    s_waitcnt vmcnt(8)
    v_readlane_b32 s56, v10, 0
    v_readlane_b32 s57, v10, 6
    v_readlane_b32 s58, v10, 2
    v_readlane_b32 s59, v10, 8
    v_readlane_b32 s60, v10, 4
    v_readlane_b32 s61, v10, 10
    s_min_u32 s56, s56, s57
    s_mul_i32 s56, s56, 3
    s_add_u32 s56, s56, 0
    s_min_u32 s58, s58, s59
    s_mul_i32 s58, s58, 3
    s_add_u32 s58, s58, 1
    s_min_u32 s60, s60, s61
    s_mul_i32 s60, s60, 3
    s_add_u32 s60, s60, 2
    s_min_u32 s56, s56, s58
    s_min_u32 s56, s56, s60
    s_max_u32 s26, s26, s56
    s_cmp_ge_u32 s26, 64
    s_cselect_b32 s25, 268435456, s25
    s_add_u32 s35, s30, 2
    s_cmp_gt_u32 s26, s35
    s_cbranch_scc1 Lch_kv0d
    s_min_u32 s35, s35, 63
Lch_kv0:
    s_waitcnt lgkmcnt(0)
    s_add_u32 s56, s24, 0
    s_load_dword s56, s[8:9], s56 glc
    s_add_u32 s57, s24, 384
    s_load_dword s57, s[8:9], s57 glc
    s_add_u32 s58, s24, 128
    s_load_dword s58, s[8:9], s58 glc
    s_add_u32 s59, s24, 512
    s_load_dword s59, s[8:9], s59 glc
    s_add_u32 s60, s24, 256
    s_load_dword s60, s[8:9], s60 glc
    s_add_u32 s61, s24, 640
    s_load_dword s61, s[8:9], s61 glc
    s_sub_u32 s39, s39, 1
    s_cbranch_scc1 Lch_bail
    s_waitcnt lgkmcnt(0)
    s_min_u32 s56, s56, s57
    s_mul_i32 s56, s56, 3
    s_add_u32 s56, s56, 0
    s_min_u32 s58, s58, s59
    s_mul_i32 s58, s58, 3
    s_add_u32 s58, s58, 1
    s_min_u32 s60, s60, s61
    s_mul_i32 s60, s60, 3
    s_add_u32 s60, s60, 2
    s_min_u32 s56, s56, s58
    s_min_u32 s56, s56, s60
    s_max_u32 s26, s26, s56
    s_cmp_ge_u32 s26, 64
    s_cselect_b32 s25, 268435456, s25
    s_cmp_ge_u32 s35, s26
    s_cbranch_scc1 Lch_kv0
Lch_kv0d:
    s_add_u32 s35, s45, 20971520
    buffer_load_dword v10, v13, s[8:11], s35 offen sc1
    s_add_u32 s35, s45, 21233664
    buffer_load_dword v10, v13, s[8:11], s35 offen sc1
    s_add_u32 s12, s42, 74752
    s_add_u32 s13, s42, 149504
    s_add_u32 s14, s42, 224256
    s_mov_b32 s22, 0x00ff00ff
    s_mov_b32 s23, 0x00ff00ff
    s_cmp_eq_u32 s2, 0
    s_cselect_b32 s15, 63, 0
    s_mov_b64 exec, 0x555
    buffer_load_dword v10, v13, s[8:11], s25 offen sc1
    s_mov_b64 exec, -1
    ds_read_b64_tr_b16 a[160:161], v40 offset:0
    ds_read_b64_tr_b16 a[162:163], v40 offset:512
    ds_read_b64_tr_b16 a[164:165], v40 offset:8192
    ds_read_b64_tr_b16 a[166:167], v40 offset:8704
    ds_read_b64_tr_b16 a[168:169], v42 offset:0
    ds_read_b64_tr_b16 a[170:171], v42 offset:512
    ds_read_b64_tr_b16 a[172:173], v42 offset:8192
    ds_read_b64_tr_b16 a[174:175], v42 offset:8704
    s_waitcnt vmcnt(7)
    ds_write_b128 v52, a[176:179] offset:16384
    ds_write_b128 v53, a[180:183] offset:17408
    ds_write_b128 v54, a[184:187] offset:18432
    ds_write_b128 v55, a[188:191] offset:19456
    s_waitcnt lgkmcnt(0)
    s_barrier
    ds_read_b64_tr_b16 a[176:177], v40 offset:16384
    ds_read_b64_tr_b16 a[178:179], v40 offset:16896
    ds_read_b64_tr_b16 a[180:181], v40 offset:24576
    ds_read_b64_tr_b16 a[182:183], v40 offset:25088
    ds_read_b64_tr_b16 a[184:185], v42 offset:16384
    ds_read_b64_tr_b16 a[186:187], v42 offset:16896
    ds_read_b64_tr_b16 a[188:189], v42 offset:24576
    ds_read_b64_tr_b16 a[190:191], v42 offset:25088
    s_waitcnt vmcnt(3)
    ds_write_b128 v52, a[192:195] offset:0
    ds_write_b128 v53, a[196:199] offset:1024
    ds_write_b128 v54, a[200:203] offset:2048
    ds_write_b128 v55, a[204:207] offset:3072
    s_waitcnt lgkmcnt(0)
    s_barrier
    ds_read_b64_tr_b16 a[192:193], v40 offset:0
    ds_read_b64_tr_b16 a[194:195], v40 offset:512
    ds_read_b64_tr_b16 a[196:197], v40 offset:8192
    ds_read_b64_tr_b16 a[198:199], v40 offset:8704
    ds_read_b64_tr_b16 a[200:201], v42 offset:0
    ds_read_b64_tr_b16 a[202:203], v42 offset:512
    ds_read_b64_tr_b16 a[204:205], v42 offset:8192
    ds_read_b64_tr_b16 a[206:207], v42 offset:8704
    s_waitcnt lgkmcnt(0)
    s_barrier
    s_add_u32 s35, s33, s73
    s_add_u32 s36, s35, 4096
    s_add_u32 s37, s33, 8192
    s_mov_b32 s46, 268435456
    s_add_u32 m0, s73, 0
    s_nop 0
    buffer_load_dwordx4 v0, s[8:11], s35 offen sc1 lds
    s_add_u32 m0, s73, 4096
    s_nop 0
    buffer_load_dwordx4 v0, s[8:11], s36 offen sc1 lds
    s_mov_b32 m0, 8192
    s_nop 0
    buffer_load_dwordx4 v0, s[8:11], s37 offen sc1 lds
    s_add_u32 s38, s45, 37748736
    s_add_u32 m0, s47, 17408
    s_nop 0
    buffer_load_dwordx4 v0, s[8:11], s38 offen offset:0 sc1 lds
    buffer_load_dwordx4 v0, s[8:11], s38 offen offset:1024 sc1 lds
    s_add_u32 s38, s45, 20971520
    s_add_u32 m0, s47, 9216
    s_nop 0
    buffer_load_dwordx4 v0, s[8:11], s38 offen offset:0 sc1 lds
    buffer_load_dwordx4 v0, s[8:11], s38 offen offset:1024 sc1 lds
    s_add_u32 s45, s45, 262144
    v_lshrrev_b32 v43, 4, v0
    v_bfe_u32 v44, v43, 3, 1
    v_and_b32 v45, 3, v43
    v_lshl_add_u32 v44, v44, 1, v45
    v_cmp_gt_u32 vcc, 2, v45
    s_nop 1
    v_cndmask_b32 v44, 8, v44, vcc
    v_bfe_u32 v45, v43, 2, 1
    v_lshlrev_b32 v45, 4, v45
    v_mov_b32 v46, 0x3f80
    v_lshlrev_b32 v45, v45, v46
    v_cmp_eq_u32 vcc, 0, v44
    s_nop 1
    v_cndmask_b32 v48, 0, v45, vcc
    v_cmp_eq_u32 vcc, 1, v44
    s_nop 1
    v_cndmask_b32 v49, 0, v45, vcc
    v_cmp_eq_u32 vcc, 2, v44
    s_nop 1
    v_cndmask_b32 v50, 0, v45, vcc
    v_cmp_eq_u32 vcc, 3, v44
    s_nop 1
    v_cndmask_b32 v51, 0, v45, vcc
    ds_write_b128 v0, v[48:51] offset:31744
    s_waitcnt vmcnt(7)
    v_readlane_b32 s56, v10, 0
    v_readlane_b32 s57, v10, 6
    v_readlane_b32 s58, v10, 2
    v_readlane_b32 s59, v10, 8
    v_readlane_b32 s60, v10, 4
    v_readlane_b32 s61, v10, 10
    s_min_u32 s56, s56, s57
    s_mul_i32 s56, s56, 3
    s_add_u32 s56, s56, 0
    s_min_u32 s58, s58, s59
    s_mul_i32 s58, s58, 3
    s_add_u32 s58, s58, 1
    s_min_u32 s60, s60, s61
    s_mul_i32 s60, s60, 3
    s_add_u32 s60, s60, 2
    s_min_u32 s56, s56, s58
    s_min_u32 s56, s56, s60
    s_max_u32 s26, s26, s56
    s_cmp_ge_u32 s26, 64
    s_cselect_b32 s25, 268435456, s25
    s_cmp_lg_u32 s4, 0
    s_cbranch_scc1 Lch_slow0_rec3
    s_branch Lch_fast0_rec3
.p2align 6
Lch_fast_loop:
Lch_fast0_start:
    ds_read_b128 v[40:43], v0 offset:0
    buffer_load_dwordx4 v0, s[8:11], s38 offen sc1 lds
    s_mov_b32 m0, s36
    s_nop 0
    buffer_load_dword v14, s[8:11], s37 offen sc1 lds
    s_waitcnt lgkmcnt(0)
    v_smfmac_f32_16x16x64_bf16 v[24:27], v[40:43], v[48:55], v1
    s_waitcnt vmcnt(2)
    ds_read_b128 v[60:63], v2 offset:3072
    ds_read_b128 v[52:55], v2 offset:17408
    v_smfmac_f32_16x16x64_bf16 v[32:35], v[40:43], v[112:119], v1
    v_smfmac_f32_16x16x64_bf16 v[20:23], v[40:43], a[88:95], v1
    buffer_store_dwordx4 v[36:39], v0, s[8:11], s46 offen sc1
    ds_read_b128 v[48:51], v2 offset:16384
    ds_read_b128 v[44:47], v0 offset:1024
    s_waitcnt lgkmcnt(3)
    v_mov_b64 v[36:37], 0
    v_smfmac_f32_16x16x64_bf16 v[28:31], v[40:43], v[56:63], v1
    ds_read_b128 v[56:59], v2 offset:18432
    v_mov_b64 v[38:39], 0
    v_smfmac_f32_16x16x64_bf16 v[16:19], v[40:43], a[80:87], v1
    ds_read_b128 v[60:63], v2 offset:19456
    v_smfmac_f32_16x16x64_bf16 v[36:39], v[40:43], v[120:127], v1
    ds_read_b128 v[40:43], v0 offset:2048
    s_waitcnt lgkmcnt(3)
    v_smfmac_f32_16x16x64_bf16 v[24:27], v[44:47], v[48:55], v1
    v_smfmac_f32_16x16x64_bf16 v[32:35], v[44:47], v[128:135], v1
    ds_read_b128 v[48:51], v2 offset:32768
    ds_read_b128 v[52:55], v2 offset:33792
    v_smfmac_f32_16x16x64_bf16 v[20:23], v[44:47], a[104:111], v1
    buffer_load_dword v10, v13, s[8:11], s71 offen sc1
    v_smfmac_f32_16x16x64_bf16 v[36:39], v[44:47], v[136:143], v1
    s_waitcnt lgkmcnt(3)
    v_smfmac_f32_16x16x64_bf16 v[28:31], v[44:47], v[56:63], v1
    ds_read_b128 v[56:59], v2 offset:34816
    v_smfmac_f32_16x16x64_bf16 v[16:19], v[44:47], a[96:103], v1
    ds_read_b128 v[60:63], v2 offset:35840
    s_waitcnt lgkmcnt(2)
    v_smfmac_f32_16x16x64_bf16 v[24:27], v[40:43], v[48:55], v1
    ds_read_b128 v[48:51], v2 offset:49152
    v_smfmac_f32_16x16x64_bf16 v[20:23], v[40:43], a[120:127], v1
    ds_read_b128 v[52:55], v2 offset:50176
    ds_read_b128 v[44:47], v0 offset:3072
    v_smfmac_f32_16x16x64_bf16 v[32:35], v[40:43], v[144:151], v1
    s_mov_b64 exec, 1
    buffer_store_dword v15, v0, s[8:11], s27 offen sc0 sc1
    s_mov_b64 exec, -1
    v_smfmac_f32_16x16x64_bf16 v[16:19], v[40:43], a[112:119], v1
    s_waitcnt lgkmcnt(3)
    v_smfmac_f32_16x16x64_bf16 v[28:31], v[40:43], v[56:63], v1
    s_waitcnt lgkmcnt(0)
    v_smfmac_f32_16x16x64_bf16 v[24:27], v[44:47], a[208:215], v1
    ds_read_b128 v[60:63], v2 offset:52224
    ds_read_b128 v[56:59], v2 offset:51200
    v_smfmac_f32_16x16x64_bf16 v[16:19], v[44:47], v[48:55], v1
    s_waitcnt vmcnt(3)
    s_barrier
    v_smfmac_f32_16x16x64_bf16 v[36:39], v[40:43], v[152:159], v1
    ds_read_b128 v[40:43], v0 offset:4096
    v_add_u32 v2, 0x10000, v2
    v_smfmac_f32_16x16x64_bf16 v[28:31], v[44:47], a[216:223], v1
    ds_read_b128 v[48:51], v0 offset:5120
    v_smfmac_f32_16x16x64_bf16 v[32:35], v[44:47], v[160:167], v1
    ds_read_b128 v[52:55], v0 offset:8192
    v_smfmac_f32_16x16x64_bf16 v[36:39], v[44:47], v[168:175], v1
    s_waitcnt lgkmcnt(3)
    v_smfmac_f32_16x16x64_bf16 v[20:23], v[44:47], v[56:63], v1
    ds_read_b128 v[60:63], v0 offset:7168
    s_waitcnt lgkmcnt(3)
    v_max3_u32 v14, v40, v41, v42
    v_smfmac_f32_16x16x64_bf16 v[20:23], v[40:43], a[136:143], v1
    ds_read_b128 v[56:59], v0 offset:6144
    v_max_u32 v14, v14, v43
    v_smfmac_f32_16x16x64_bf16 v[16:19], v[40:43], a[128:135], v1
    s_waitcnt lgkmcnt(3)
    v_max3_u32 v14, v48, v49, v14
    v_smfmac_f32_16x16x64_bf16 v[20:23], v[48:51], a[152:159], v1
    s_waitcnt lgkmcnt(2)
    v_max3_u32 v14, v14, v50, v51
    v_smfmac_f32_16x16x64_bf16 v[20:23], v[52:55], a[200:207], v1
    v_smfmac_f32_16x16x64_bf16 v[16:19], v[52:55], a[192:199], v1
    s_waitcnt lgkmcnt(0)
    v_max3_u32 v14, v52, v53, v14
    v_smfmac_f32_16x16x64_bf16 v[16:19], v[56:59], a[160:167], v1
    v_max3_u32 v14, v14, v54, v55
    v_smfmac_f32_16x16x64_bf16 v[20:23], v[56:59], a[168:175], v1
    v_max3_u32 v14, v56, v57, v14
    v_smfmac_f32_16x16x64_bf16 v[16:19], v[48:51], a[144:151], v1
    v_max3_u32 v14, v14, v58, v59
    v_smfmac_f32_16x16x64_bf16 v[16:19], v[60:63], a[176:183], v1
    v_max3_u32 v14, v60, v61, v14
    v_smfmac_f32_16x16x64_bf16 v[20:23], v[60:63], a[184:191], v1
    v_max3_u32 v14, v14, v62, v63
    v_smfmac_f32_16x16x64_bf16 v[28:31], v[40:43], a[232:239], v1
    v_cmp_eq_u32 vcc, -1, v14
    v_smfmac_f32_16x16x64_bf16 v[24:27], v[40:43], a[224:231], v1
    v_add_f32 v21, v21, v23
    v_smfmac_f32_16x16x64_bf16 v[24:27], v[48:51], a[240:247], v1
    s_cbranch_vccnz Lch_fast0_rect2
    v_add_f32 v16, v16, v18
    v_add_f32 v20, v20, v22
    v_add_f32 v17, v17, v19
    v_cvt_pk_bf16_f32 v14, v16, v17
    v_cvt_pk_bf16_f32 v15, v20, v21
    v_smfmac_f32_16x16x64_bf16 v[28:31], v[48:51], a[248:255], v1
    ds_write2_b32 v3, v14, v15 offset0:0 offset1:64
    v_smfmac_f32_16x16x64_bf16 v[24:27], v[56:59], v[64:71], v1
    v_smfmac_f32_16x16x64_bf16 v[28:31], v[56:59], v[72:79], v1
    ds_read_b128 v[56:59], v12 offset:9472
    ds_read_b128 v[48:51], v12 offset:9216
    v_smfmac_f32_16x16x64_bf16 v[24:27], v[60:63], v[80:87], v1
    v_smfmac_f32_16x16x64_bf16 v[24:27], v[52:55], v[96:103], v1
    v_smfmac_f32_16x16x64_bf16 v[28:31], v[60:63], v[88:95], v1
    s_waitcnt lgkmcnt(2)
    s_barrier
    ds_read_b64_tr_b16 v[16:17], v5 offset:25600
    v_smfmac_f32_16x16x64_bf16 v[28:31], v[52:55], v[104:111], v1
    ds_read_b64_tr_b16 v[18:19], v5 offset:25632
    v_add_f32 v24, v24, v26
    v_smfmac_f32_16x16x64_bf16 v[32:35], v[60:63], v[224:231], v1
    ds_read_b64_tr_b16 v[20:21], v5 offset:26112
    v_add_f32 v25, v25, v27
    v_smfmac_f32_16x16x64_bf16 v[36:39], v[60:63], v[232:239], v1
    ds_read_b128 v[60:63], v0 offset:4096
    v_add_f32 v29, v29, v31
    v_add_f32 v28, v28, v30
    v_cvt_pk_bf16_f32 v15, v28, v29
    v_smfmac_f32_16x16x64_bf16 v[32:35], v[52:55], v[240:247], v1
    ds_read_b64_tr_b16 v[22:23], v5 offset:26144
    v_cvt_pk_bf16_f32 v14, v24, v25
    v_smfmac_f32_16x16x64_bf16 v[36:39], v[52:55], v[248:255], v1
    ds_read_b128 v[24:27], v12 offset:11264
    s_waitcnt lgkmcnt(4)
    v_mfma_f32_16x16x32_bf16 v[48:51], v[48:51], v[16:19], 0
    ds_read_b128 v[28:31], v12 offset:11520
    ds_read_b128 v[52:55], v0 offset:5120
    v_mfma_f32_16x16x32_bf16 v[56:59], v[56:59], v[16:19], 0
    ds_read_b64_tr_b16 v[42:43], v5 offset:26656
    s_waitcnt lgkmcnt(5)
    v_smfmac_f32_16x16x64_bf16 v[32:35], v[60:63], v[176:183], v1
    ds_write_b64 v4, v[14:15]
    v_smfmac_f32_16x16x64_bf16 v[36:39], v[60:63], v[184:191], v1
    ds_read_b128 v[60:63], v0 offset:6144
    s_waitcnt lgkmcnt(5)
    v_mfma_f32_16x16x32_bf16 v[48:51], v[24:27], v[20:23], v[48:51]
    ds_read_b128 v[24:27], v12 offset:13312
    s_waitcnt lgkmcnt(5)
    v_mfma_f32_16x16x32_bf16 v[56:59], v[28:31], v[20:23], v[56:59]
    ds_read_b128 v[28:31], v12 offset:13568
    s_waitcnt lgkmcnt(5)
    v_smfmac_f32_16x16x64_bf16 v[32:35], v[52:55], v[192:199], v1
    ds_read_b64_tr_b16 v[46:47], v5 offset:27168
    v_smfmac_f32_16x16x64_bf16 v[36:39], v[52:55], v[200:207], v1
    ds_read_b64_tr_b16 v[40:41], v5 offset:26624
    ds_read_b64_tr_b16 v[44:45], v5 offset:27136
    s_waitcnt lgkmcnt(5)
    v_smfmac_f32_16x16x64_bf16 v[32:35], v[60:63], v[208:215], v1
    s_barrier
    ds_read_b128 v[52:55], v12 offset:15360
    v_smfmac_f32_16x16x64_bf16 v[36:39], v[60:63], v[216:223], v1
    ds_read_b128 v[60:63], v12 offset:15616
    s_waitcnt lgkmcnt(3)
    v_mfma_f32_16x16x32_bf16 v[48:51], v[24:27], v[40:43], v[48:51]
    ds_read_b64_tr_b16 v[26:27], v6 offset:27680
    ds_read_b64_tr_b16 v[24:25], v6 offset:27648
    v_add_f32 v32, v32, v34
    v_mfma_f32_16x16x32_bf16 v[56:59], v[28:31], v[40:43], v[56:59]
    ds_read_b64_tr_b16 v[30:31], v6 offset:28704
    ds_read_b64_tr_b16 v[28:29], v6 offset:28672
    v_add_f32 v37, v37, v39
    v_add_f32 v33, v33, v35
    v_add_f32 v36, v36, v38
    v_cvt_pk_bf16_f32 v38, v32, v33
    s_waitcnt lgkmcnt(5)
    v_mfma_f32_16x16x32_bf16 v[48:51], v[52:55], v[44:47], v[48:51]
    s_waitcnt lgkmcnt(4)
    v_mov_b64 v[52:53], 0
    v_mov_b64 v[54:55], 0
    v_mfma_f32_16x16x32_bf16 v[56:59], v[60:63], v[44:47], v[56:59]
    s_add_u32 s38, s45, 37748736
    ds_read_b128 v[60:63], v7 offset:17408
    s_waitcnt lgkmcnt(3)
    v_cvt_pk_bf16_f32 v39, v36, v37
    v_mov_b64 v[36:37], v[14:15]
    v_smfmac_f32_16x16x64_bf16 v[52:55], v[24:27], v[16:23], v1
    s_waitcnt lgkmcnt(1)
    v_smfmac_f32_16x16x64_bf16 v[52:55], v[28:31], v[40:47], v1
    s_add_u32 m0, s47, 17408
    ds_read_b128 v[32:35], v7 offset:17664
    ds_read_b128 v[40:43], v2 offset:0
    v_max3_f32 v28, v48, v49, v50
    v_mov_b32 v25, 0x3f803f80
    v_max3_f32 v28, v28, v51, v56
    v_cndmask_b32 v51, v51, v59, s[40:41]
    v_mov_b32 v24, 0x3f803f80
    v_pk_add_f32 v[54:55], v[52:53], v[54:55]
    v_max3_f32 v29, v57, v58, v59
    v_max3_f32 v29, v29, v54, v55
    v_max_f32 v30, v28, v29
    v_cndmask_b32 v48, v48, v56, s[40:41]
    v_max_f32 v28, v28, v29
    v_cndmask_b32 v49, v49, v57, s[40:41]
    v_mov_b64 v[52:53], 0
    v_pk_mul_f32 v[48:49], v[48:49], s[44:45] op_sel_hi:[1,0]
    v_permlane16_swap_b32 v28, v30
    v_max_f32 v29, v28, v30
    v_cndmask_b32 v50, v50, v58, s[40:41]
    v_max_f32 v28, v28, v30
    v_pk_mul_f32 v[54:55], v[54:55], s[44:45] op_sel_hi:[1,0]
    v_mov_b32 v27, 0
    v_permlane32_swap_b32 v28, v29
    v_pk_mul_f32 v[50:51], v[50:51], s[44:45] op_sel_hi:[1,0]
    v_max_f32 v28, v28, v29
    v_mul_f32 v28, s44, v28
    v_pk_add_f32 v[48:49], v[48:49], v[28:29] op_sel_hi:[1,0] neg_lo:[0,1] neg_hi:[0,1]
    v_pk_add_f32 v[50:51], v[50:51], v[28:29] op_sel_hi:[1,0] neg_lo:[0,1] neg_hi:[0,1]
    v_exp_f32 v48, v48
    v_exp_f32 v50, v50
    v_exp_f32 v49, v49
    v_exp_f32 v51, v51
    v_cvt_pk_bf16_f32 v14, v48, v49
    v_cvt_pk_bf16_f32 v15, v50, v51
    v_pk_add_f32 v[54:55], v[54:55], v[28:29] op_sel_hi:[1,0] neg_lo:[0,1] neg_hi:[0,1]
    v_exp_f32 v54, v54
    v_exp_f32 v55, v55
    v_mov_b32_dpp v20, v14 row_shr:8 row_mask:0xf bank_mask:0xf bound_ctrl:0
    v_mov_b32_dpp v18, v14 row_shl:8 row_mask:0xf bank_mask:0xf bound_ctrl:0
    v_cvt_pk_bf16_f32 v54, v54, v55
    v_mfma_f32_16x16x16_bf16 v[28:31], v[24:25], v[14:15], 0
    v_mov_b32 v26, 0x3f803f80
    v_cndmask_b32 v17, v15, 0, s[40:41]
    v_mov_b32_dpp v19, v15 row_shl:8 row_mask:0xf bank_mask:0xf bound_ctrl:0
    v_cndmask_b32 v16, v14, 0, s[40:41]
    v_cndmask_b32 v55, 0, v54, s[40:41]
    s_waitcnt lgkmcnt(2)
    v_mfma_f32_16x16x32_bf16 v[48:51], v[60:63], v[16:19], 0
    v_cndmask_b32 v54, v54, 0, s[40:41]
    s_nop 1
    v_mfma_f32_16x16x16_bf16 v[28:31], v[26:27], v[54:55], v[28:31]
    ds_read_b128 v[44:47], v2 offset:1024
    v_mov_b32_dpp v21, v15 row_shr:8 row_mask:0xf bank_mask:0xf bound_ctrl:0
    v_cndmask_b32 v22, 0, v14, s[40:41]
    v_cndmask_b32 v23, 0, v15, s[40:41]
    v_mfma_f32_16x16x32_bf16 v[48:51], v[36:39], v[52:55], v[48:51]
    ds_read_b128 v[56:59], v2 offset:2048
    s_waitcnt lgkmcnt(3)
    v_mfma_f32_16x16x32_bf16 v[48:51], v[32:35], v[20:23], v[48:51]
    ds_read_b128 v[60:63], v2 offset:3072
    v_add_f32_dpp v16, v28, v28 row_ror:8 row_mask:0xf bank_mask:0xf
    v_mov_b64 v[54:55], 0
    v_and_b32 v32, 0xffffffdf, v0
    v_mov_b64 v[28:29], 0
    v_mov_b64 v[30:31], 0
    v_rcp_f32 v16, v16
    s_nop 0
    v_pk_mul_f32 v[48:49], v[48:49], v[16:17] op_sel_hi:[1,0]
    v_pk_mul_f32 v[50:51], v[50:51], v[16:17] op_sel_hi:[1,0]
    v_cvt_pk_bf16_f32 v14, v48, v49
    v_cvt_pk_bf16_f32 v15, v50, v51
    ds_write_b64 v11, v[14:15]
    buffer_load_dwordx4 v0, s[8:11], s38 offen offset:0 sc1 lds
    buffer_load_dwordx4 v0, s[8:11], s38 offen offset:1024 sc1 lds
    s_waitcnt lgkmcnt(0)
    s_barrier
    ds_read_b128 v[16:19], v32 offset:30720
    s_add_u32 s38, s45, 20971520
    ds_read_b128 v[20:23], v32 offset:29696
    v_mov_b64 v[50:51], 0
    v_mov_b64 v[48:49], 0
    s_add_u32 m0, s47, 9216
    s_nop 0
    buffer_load_dwordx4 v0, s[8:11], s38 offen offset:0 sc1 lds
    ds_read_b128 v[24:27], v32 offset:30752
    ds_read_b128 v[32:35], v32 offset:29728
    s_waitcnt lgkmcnt(3)
    v_smfmac_f32_16x16x64_bf16 v[28:31], v[16:19], a[0:7], v1
    buffer_load_dwordx4 v0, s[8:11], s38 offen offset:1024 sc1 lds
    s_waitcnt lgkmcnt(2)
    v_lshrrev_b32 v14, 2, v0
    v_smfmac_f32_16x16x64_bf16 v[28:31], v[20:23], v[40:47], v1
    ds_read_b128 v[44:47], v2 offset:17408
    ds_read_b128 v[40:43], v2 offset:16384
    s_waitcnt lgkmcnt(3)
    v_smfmac_f32_16x16x64_bf16 v[28:31], v[24:27], a[8:15], v1
    s_waitcnt lgkmcnt(2)
    v_smfmac_f32_16x16x64_bf16 v[28:31], v[32:35], v[56:63], v1
    ds_read_b128 v[56:59], v2 offset:18432
    ds_read_b128 v[60:63], v2 offset:19456
    v_smfmac_f32_16x16x64_bf16 v[52:55], v[16:19], a[16:23], v1
    s_nop 3
    v_cvt_pk_bf16_f32 v28, v28, v29
    s_waitcnt lgkmcnt(2)
    v_smfmac_f32_16x16x64_bf16 v[52:55], v[20:23], v[40:47], v1
    ds_read_b128 v[44:47], v2 offset:33792
    ds_read_b128 v[40:43], v2 offset:32768
    v_cvt_pk_bf16_f32 v30, v30, v31
    v_and_b32 v28, -2, v28
    v_and_b32 v30, -2, v30
    v_smfmac_f32_16x16x64_bf16 v[52:55], v[24:27], a[24:31], v1
    buffer_store_dword v28, v14, s[8:11], s34 offen offset:0
    buffer_store_dword v30, v14, s[8:11], s34 offen offset:1024
    s_waitcnt lgkmcnt(2)
    v_mov_b64 v[30:31], 0
    v_smfmac_f32_16x16x64_bf16 v[52:55], v[32:35], v[56:63], v1
    ds_read_b128 v[56:59], v2 offset:34816
    ds_read_b128 v[60:63], v2 offset:35840
    v_smfmac_f32_16x16x64_bf16 v[48:51], v[16:19], a[32:39], v1
    s_waitcnt lgkmcnt(2)
    v_mov_b64 v[28:29], 0
    v_smfmac_f32_16x16x64_bf16 v[48:51], v[20:23], v[40:47], v1
    ds_read_b128 v[44:47], v2 offset:50176
    ds_read_b128 v[40:43], v2 offset:49152
    v_cvt_pk_bf16_f32 v52, v52, v53
    v_and_b32 v52, -2, v52
    v_cvt_pk_bf16_f32 v54, v54, v55
    v_and_b32 v54, -2, v54
    v_smfmac_f32_16x16x64_bf16 v[48:51], v[24:27], a[40:47], v1
    buffer_store_dword v52, v14, s[8:11], s34 offen offset:2048
    buffer_store_dword v54, v14, s[8:11], s34 offen offset:3072
    s_waitcnt lgkmcnt(2)
    v_smfmac_f32_16x16x64_bf16 v[48:51], v[32:35], v[56:63], v1
    ds_read_b128 v[56:59], v2 offset:51200
    ds_read_b128 v[60:63], v2 offset:52224
    v_smfmac_f32_16x16x64_bf16 v[28:31], v[16:19], a[48:55], v1
    s_waitcnt lgkmcnt(2)
    v_mov_b64 v[54:55], 0
    v_smfmac_f32_16x16x64_bf16 v[28:31], v[20:23], v[40:47], v1
    ds_read_b128 v[40:43], v0 offset:29696
    ds_read_b128 v[44:47], v0 offset:30720
    v_cvt_pk_bf16_f32 v50, v50, v51
    v_mov_b64 v[52:53], 0
    v_cvt_pk_bf16_f32 v48, v48, v49
    v_and_b32 v48, -2, v48
    v_and_b32 v50, -2, v50
    v_smfmac_f32_16x16x64_bf16 v[28:31], v[24:27], a[56:63], v1
    buffer_store_dword v48, v14, s[8:11], s68 offen offset:0
    buffer_store_dword v50, v14, s[8:11], s68 offen offset:1024
    s_waitcnt lgkmcnt(2)
    v_smfmac_f32_16x16x64_bf16 v[28:31], v[32:35], v[56:63], v1
    ds_read_b128 v[56:59], v0 offset:31744
    s_waitcnt lgkmcnt(1)
    v_smfmac_f32_16x16x64_bf16 v[52:55], v[44:47], a[64:71], v1
    v_mov_b32 v15, -1
    v_smfmac_f32_16x16x64_bf16 v[52:55], v[40:43], a[72:79], v1
    s_add_u32 s18, s43, s32
    s_add_u32 s19, s43, s33
    v_cvt_pk_bf16_f32 v30, v30, v31
    v_and_b32_e64 v30, -2, v30
    v_cvt_pk_bf16_f32 v28, v28, v29
    v_and_b32_e64 v28, -2, v28
    buffer_store_dword v28, v14, s[8:11], s68 offen offset:2048
    buffer_store_dword v30, v14, s[8:11], s68 offen offset:3072
    v_add_f32_e64 v53, v53, v55
    v_add_f32_e64 v52, v52, v54
    s_add_u32 s35, s32, s47
    v_cvt_pk_bf16_f32 v52, v52, v53
    v_and_b32_e64 v52, -2, v52
    buffer_store_dword v52, v14, s[8:11], s69 offen offset:0
    s_mov_b32 s46, s72
    s_mov_b32 s38, s33
    s_mov_b32 s33, s32
    s_mov_b32 s32, s31
    s_mov_b32 s31, s38
    s_add_u32 s30, s30, 1
    s_add_u32 s45, s45, 262144
    s_add_u32 s72, s72, 131072
    s_add_u32 s38, s33, s73
    s_add_u32 s38, s38, 4096
    s_add_u32 m0, s73, 4096
    s_lshr_b32 s36, s73, 2
    s_add_u32 s36, s36, 8192
    s_cmp_lg_u32 s29, 1
    s_cbranch_scc1 Lch_fast0_n1
Lch_fast0_r0:
Lch_fast0_r:
    buffer_load_dwordx4 v[16:19], v8, s[8:11], s42 offen sc1
    buffer_load_dwordx4 v[20:23], v8, s[8:11], s12 offen sc1
    buffer_load_dwordx4 v[24:27], v8, s[8:11], s13 offen sc1
    buffer_load_dwordx4 v[28:31], v8, s[8:11], s14 offen sc1
    s_sub_u32 s39, s39, 1
    s_cbranch_scc1 Lch_bail
    s_waitcnt vmcnt(3)
    s_waitcnt lgkmcnt(0)
    v_mfma_f32_16x16x32_bf16 v[60:63], v[56:59], v[16:19], 0
    v_bitop3_b32 v32, v16, v16, v17 bitop3:0xfe
    v_bitop3_b32 v32, v32, v18, v19 bitop3:0xfe
    s_waitcnt vmcnt(2)
    v_mfma_f32_16x16x32_bf16 v[60:63], v[56:59], v[20:23], v[60:63]
    v_bitop3_b32 v32, v32, v20, v21 bitop3:0xfe
    v_bitop3_b32 v32, v32, v22, v23 bitop3:0xfe
    s_waitcnt vmcnt(1)
    v_mfma_f32_16x16x32_bf16 v[60:63], v[56:59], v[24:27], v[60:63]
    v_bitop3_b32 v32, v32, v24, v25 bitop3:0xfe
    v_bitop3_b32 v32, v32, v26, v27 bitop3:0xfe
    s_waitcnt vmcnt(0)
    v_mfma_f32_16x16x32_bf16 v[60:63], v[56:59], v[28:31], v[60:63]
    v_bitop3_b32 v32, v32, v28, v29 bitop3:0xfe
    v_bitop3_b32 v32, v32, v30, v31 bitop3:0xfe
    v_and_b32 v32, 1, v32
    v_cmp_ne_u32 vcc, 0, v32
    s_nop 3
    v_add_f32_dpp v60, v60, v60 row_ror:8 row_mask:0xf bank_mask:0xf
    v_add_f32_dpp v61, v61, v61 row_ror:8 row_mask:0xf bank_mask:0xf
    v_cvt_pk_bf16_f32 v60, v60, v61
    v_min_u32 v60, -2, v60
    s_cbranch_vccnz Lch_fast0_r
    s_mov_b64 exec, s[22:23]
    buffer_store_dword v60, v9, s[8:11], s18 offen
    buffer_store_dword v15, v9, s[8:11], s19 offen
    s_mov_b64 exec, -1
Lch_fast0_j:
    s_waitcnt lgkmcnt(0)
    s_add_u32 s37, s36, s33
    s_add_u32 s71, s45, 21233664
    v_add_u32 v2, s3, v0
    ds_read_b128 v[48:51], v2 offset:0
    s_cmp_ge_u32 s29, 2
    s_cbranch_scc1 Lch_fast0_w2
    s_nop 15
    s_nop 8
    buffer_load_dwordx4 v[44:47], v0, s[8:11], s35 offen sc1
    buffer_load_dwordx4 v[60:63], v0, s[8:11], s35 offen offset:1024 sc1
    ds_read_b128 v[52:55], v2 offset:1024
    ds_read_b128 v[56:59], v2 offset:2048
    v_mov_b64 v[24:25], 0
    v_mov_b64 v[26:27], 0
    v_mov_b64 v[28:29], 0
    v_mov_b64 v[30:31], 0
    v_mov_b64 v[32:33], 0
    v_mov_b64 v[34:35], 0
    v_mov_b64 v[16:17], 0
    v_mov_b64 v[18:19], 0
    v_mov_b64 v[20:21], 0
    v_mov_b64 v[22:23], 0
    v_lshrrev_b32 v14, 2, v0
    s_max_i32 s16, s30, 1
    s_sub_u32 s16, s16, 1
    v_mov_b32 v15, s16
    v_add_u32 v40, s47, v0
    buffer_load_dwordx4 v[44:47], v0, s[8:11], s35 offen sc1
    buffer_load_dwordx4 v[60:63], v0, s[8:11], s35 offen offset:1024 sc1
Lch_fast0_gl:
    s_waitcnt vmcnt(3)
    v_max3_u32 v10, v44, v45, v46
    v_max_u32 v10, v10, v47
    ds_write_b128 v40, v[44:47] offset:0
    s_waitcnt vmcnt(2)
    v_max3_u32 v10, v10, v60, v61
    v_max3_u32 v10, v10, v62, v63
    v_cmp_eq_u32 vcc, -1, v10
    ds_write_b128 v40, v[60:63] offset:1024
    s_cbranch_vccnz Lch_fast0_gr
Lch_fast0_b:
    s_waitcnt lgkmcnt(0)
    s_barrier
Lch_fast1_start:
    ds_read_b128 v[40:43], v0 offset:0
    buffer_load_dwordx4 v0, s[8:11], s38 offen sc1 lds
    s_mov_b32 m0, s36
    s_nop 0
    buffer_load_dword v14, s[8:11], s37 offen sc1 lds
    s_waitcnt lgkmcnt(0)
    v_smfmac_f32_16x16x64_bf16 v[24:27], v[40:43], v[48:55], v1
    s_waitcnt vmcnt(2)
    ds_read_b128 v[60:63], v2 offset:3072
    ds_read_b128 v[52:55], v2 offset:17408
    v_smfmac_f32_16x16x64_bf16 v[32:35], v[40:43], v[112:119], v1
    v_smfmac_f32_16x16x64_bf16 v[20:23], v[40:43], a[88:95], v1
    buffer_store_dwordx4 v[36:39], v0, s[8:11], s46 offen sc1
    ds_read_b128 v[48:51], v2 offset:16384
    ds_read_b128 v[44:47], v0 offset:1024
    s_waitcnt lgkmcnt(3)
    v_mov_b64 v[36:37], 0
    v_smfmac_f32_16x16x64_bf16 v[28:31], v[40:43], v[56:63], v1
    ds_read_b128 v[56:59], v2 offset:18432
    v_mov_b64 v[38:39], 0
    v_smfmac_f32_16x16x64_bf16 v[16:19], v[40:43], a[80:87], v1
    ds_read_b128 v[60:63], v2 offset:19456
    v_smfmac_f32_16x16x64_bf16 v[36:39], v[40:43], v[120:127], v1
    ds_read_b128 v[40:43], v0 offset:2048
    s_waitcnt lgkmcnt(3)
    v_smfmac_f32_16x16x64_bf16 v[24:27], v[44:47], v[48:55], v1
    v_smfmac_f32_16x16x64_bf16 v[32:35], v[44:47], v[128:135], v1
    ds_read_b128 v[48:51], v2 offset:32768
    ds_read_b128 v[52:55], v2 offset:33792
    v_smfmac_f32_16x16x64_bf16 v[20:23], v[44:47], a[104:111], v1
    buffer_load_dword v10, v13, s[8:11], s71 offen sc1
    v_smfmac_f32_16x16x64_bf16 v[36:39], v[44:47], v[136:143], v1
    s_waitcnt lgkmcnt(3)
    v_smfmac_f32_16x16x64_bf16 v[28:31], v[44:47], v[56:63], v1
    ds_read_b128 v[56:59], v2 offset:34816
    v_smfmac_f32_16x16x64_bf16 v[16:19], v[44:47], a[96:103], v1
    ds_read_b128 v[60:63], v2 offset:35840
    s_waitcnt lgkmcnt(2)
    v_smfmac_f32_16x16x64_bf16 v[24:27], v[40:43], v[48:55], v1
    ds_read_b128 v[48:51], v2 offset:49152
    v_smfmac_f32_16x16x64_bf16 v[20:23], v[40:43], a[120:127], v1
    ds_read_b128 v[52:55], v2 offset:50176
    ds_read_b128 v[44:47], v0 offset:3072
    v_smfmac_f32_16x16x64_bf16 v[32:35], v[40:43], v[144:151], v1
    s_cmp_lg_u32 s25, 268435456
    s_cbranch_scc1 Lch_fast1_fp
    s_mov_b64 exec, 1
    buffer_store_dword v15, v0, s[8:11], s27 offen sc0 sc1
    s_mov_b64 exec, -1
Lch_fast1_fb:
    v_smfmac_f32_16x16x64_bf16 v[16:19], v[40:43], a[112:119], v1
    s_waitcnt lgkmcnt(3)
    v_smfmac_f32_16x16x64_bf16 v[28:31], v[40:43], v[56:63], v1
    s_waitcnt lgkmcnt(0)
    v_smfmac_f32_16x16x64_bf16 v[24:27], v[44:47], a[208:215], v1
    ds_read_b128 v[60:63], v2 offset:52224
    ds_read_b128 v[56:59], v2 offset:51200
    v_smfmac_f32_16x16x64_bf16 v[16:19], v[44:47], v[48:55], v1
    s_waitcnt vmcnt(3)
    s_barrier
    v_smfmac_f32_16x16x64_bf16 v[36:39], v[40:43], v[152:159], v1
    ds_read_b128 v[40:43], v0 offset:4096
    v_add_u32 v2, 0x10000, v2
    v_smfmac_f32_16x16x64_bf16 v[28:31], v[44:47], a[216:223], v1
    ds_read_b128 v[48:51], v0 offset:5120
    v_smfmac_f32_16x16x64_bf16 v[32:35], v[44:47], v[160:167], v1
    ds_read_b128 v[52:55], v0 offset:8192
    v_smfmac_f32_16x16x64_bf16 v[36:39], v[44:47], v[168:175], v1
    s_waitcnt lgkmcnt(3)
    v_smfmac_f32_16x16x64_bf16 v[20:23], v[44:47], v[56:63], v1
    ds_read_b128 v[60:63], v0 offset:7168
    s_waitcnt lgkmcnt(3)
    v_max3_u32 v14, v40, v41, v42
    v_smfmac_f32_16x16x64_bf16 v[20:23], v[40:43], a[136:143], v1
    ds_read_b128 v[56:59], v0 offset:6144
    v_max_u32 v14, v14, v43
    v_smfmac_f32_16x16x64_bf16 v[16:19], v[40:43], a[128:135], v1
    s_waitcnt lgkmcnt(3)
    v_max3_u32 v14, v48, v49, v14
    v_smfmac_f32_16x16x64_bf16 v[20:23], v[48:51], a[152:159], v1
    s_waitcnt lgkmcnt(2)
    v_max3_u32 v14, v14, v50, v51
    v_smfmac_f32_16x16x64_bf16 v[20:23], v[52:55], a[200:207], v1
    v_smfmac_f32_16x16x64_bf16 v[16:19], v[52:55], a[192:199], v1
    s_waitcnt lgkmcnt(0)
    v_max3_u32 v14, v52, v53, v14
    v_smfmac_f32_16x16x64_bf16 v[16:19], v[56:59], a[160:167], v1
    v_max3_u32 v14, v14, v54, v55
    v_smfmac_f32_16x16x64_bf16 v[20:23], v[56:59], a[168:175], v1
    v_max3_u32 v14, v56, v57, v14
    v_smfmac_f32_16x16x64_bf16 v[16:19], v[48:51], a[144:151], v1
    v_max3_u32 v14, v14, v58, v59
    v_smfmac_f32_16x16x64_bf16 v[16:19], v[60:63], a[176:183], v1
    v_max3_u32 v14, v60, v61, v14
    v_smfmac_f32_16x16x64_bf16 v[20:23], v[60:63], a[184:191], v1
    v_max3_u32 v14, v14, v62, v63
    v_smfmac_f32_16x16x64_bf16 v[28:31], v[40:43], a[232:239], v1
    v_cmp_eq_u32 vcc, -1, v14
    v_smfmac_f32_16x16x64_bf16 v[24:27], v[40:43], a[224:231], v1
    v_add_f32 v21, v21, v23
    v_smfmac_f32_16x16x64_bf16 v[24:27], v[48:51], a[240:247], v1
    s_cbranch_vccnz Lch_fast1_rect2
    v_add_f32 v16, v16, v18
    v_add_f32 v20, v20, v22
    v_add_f32 v17, v17, v19
    v_cvt_pk_bf16_f32 v14, v16, v17
    v_cvt_pk_bf16_f32 v15, v20, v21
    v_smfmac_f32_16x16x64_bf16 v[28:31], v[48:51], a[248:255], v1
    ds_write2_b32 v3, v14, v15 offset0:0 offset1:64
    v_smfmac_f32_16x16x64_bf16 v[24:27], v[56:59], v[64:71], v1
    v_smfmac_f32_16x16x64_bf16 v[28:31], v[56:59], v[72:79], v1
    ds_read_b128 v[56:59], v12 offset:9472
    ds_read_b128 v[48:51], v12 offset:9216
    v_smfmac_f32_16x16x64_bf16 v[24:27], v[60:63], v[80:87], v1
    v_smfmac_f32_16x16x64_bf16 v[24:27], v[52:55], v[96:103], v1
    v_smfmac_f32_16x16x64_bf16 v[28:31], v[60:63], v[88:95], v1
    s_waitcnt lgkmcnt(2)
    s_barrier
    ds_read_b64_tr_b16 v[16:17], v5 offset:25600
    v_smfmac_f32_16x16x64_bf16 v[28:31], v[52:55], v[104:111], v1
    ds_read_b64_tr_b16 v[18:19], v5 offset:25632
    v_add_f32 v24, v24, v26
    v_smfmac_f32_16x16x64_bf16 v[32:35], v[60:63], v[224:231], v1
    ds_read_b64_tr_b16 v[20:21], v5 offset:26112
    v_add_f32 v25, v25, v27
    v_smfmac_f32_16x16x64_bf16 v[36:39], v[60:63], v[232:239], v1
    ds_read_b128 v[60:63], v0 offset:4096
    v_add_f32 v29, v29, v31
    v_add_f32 v28, v28, v30
    v_cvt_pk_bf16_f32 v15, v28, v29
    v_smfmac_f32_16x16x64_bf16 v[32:35], v[52:55], v[240:247], v1
    ds_read_b64_tr_b16 v[22:23], v5 offset:26144
    v_cvt_pk_bf16_f32 v14, v24, v25
    v_smfmac_f32_16x16x64_bf16 v[36:39], v[52:55], v[248:255], v1
    ds_read_b128 v[24:27], v12 offset:11264
    s_waitcnt lgkmcnt(4)
    v_mfma_f32_16x16x32_bf16 v[48:51], v[48:51], v[16:19], 0
    ds_read_b128 v[28:31], v12 offset:11520
    ds_read_b128 v[52:55], v0 offset:5120
    v_mfma_f32_16x16x32_bf16 v[56:59], v[56:59], v[16:19], 0
    ds_read_b64_tr_b16 v[42:43], v5 offset:26656
    s_waitcnt lgkmcnt(5)
    v_smfmac_f32_16x16x64_bf16 v[32:35], v[60:63], v[176:183], v1
    ds_write_b64 v4, v[14:15]
    v_smfmac_f32_16x16x64_bf16 v[36:39], v[60:63], v[184:191], v1
    ds_read_b128 v[60:63], v0 offset:6144
    s_waitcnt lgkmcnt(5)
    v_mfma_f32_16x16x32_bf16 v[48:51], v[24:27], v[20:23], v[48:51]
    ds_read_b128 v[24:27], v12 offset:13312
    s_waitcnt lgkmcnt(5)
    v_mfma_f32_16x16x32_bf16 v[56:59], v[28:31], v[20:23], v[56:59]
    ds_read_b128 v[28:31], v12 offset:13568
    s_waitcnt lgkmcnt(5)
    v_smfmac_f32_16x16x64_bf16 v[32:35], v[52:55], v[192:199], v1
    ds_read_b64_tr_b16 v[46:47], v5 offset:27168
    v_smfmac_f32_16x16x64_bf16 v[36:39], v[52:55], v[200:207], v1
    ds_read_b64_tr_b16 v[40:41], v5 offset:26624
    ds_read_b64_tr_b16 v[44:45], v5 offset:27136
    s_waitcnt lgkmcnt(5)
    v_smfmac_f32_16x16x64_bf16 v[32:35], v[60:63], v[208:215], v1
    s_barrier
    ds_read_b128 v[52:55], v12 offset:15360
    v_smfmac_f32_16x16x64_bf16 v[36:39], v[60:63], v[216:223], v1
    ds_read_b128 v[60:63], v12 offset:15616
    s_waitcnt lgkmcnt(3)
    v_mfma_f32_16x16x32_bf16 v[48:51], v[24:27], v[40:43], v[48:51]
    ds_read_b64_tr_b16 v[26:27], v6 offset:27680
    ds_read_b64_tr_b16 v[24:25], v6 offset:27648
    v_add_f32 v32, v32, v34
    v_mfma_f32_16x16x32_bf16 v[56:59], v[28:31], v[40:43], v[56:59]
    ds_read_b64_tr_b16 v[30:31], v6 offset:28704
    ds_read_b64_tr_b16 v[28:29], v6 offset:28672
    v_add_f32 v37, v37, v39
    v_add_f32 v33, v33, v35
    v_add_f32 v36, v36, v38
    v_cvt_pk_bf16_f32 v38, v32, v33
    s_waitcnt lgkmcnt(5)
    v_mfma_f32_16x16x32_bf16 v[48:51], v[52:55], v[44:47], v[48:51]
    s_waitcnt lgkmcnt(4)
    v_mov_b64 v[52:53], 0
    v_mov_b64 v[54:55], 0
    v_mfma_f32_16x16x32_bf16 v[56:59], v[60:63], v[44:47], v[56:59]
    s_add_u32 s38, s45, 37748736
    ds_read_b128 v[60:63], v7 offset:17408
    s_waitcnt lgkmcnt(3)
    v_cvt_pk_bf16_f32 v39, v36, v37
    v_mov_b64 v[36:37], v[14:15]
    v_smfmac_f32_16x16x64_bf16 v[52:55], v[24:27], v[16:23], v1
    s_cmp_eq_u32 s30, 63
    s_cbranch_scc1 Lch_last
    s_waitcnt lgkmcnt(1)
    v_smfmac_f32_16x16x64_bf16 v[52:55], v[28:31], v[40:47], v1
    s_add_u32 m0, s47, 17408
    ds_read_b128 v[32:35], v7 offset:17664
    ds_read_b128 v[40:43], v2 offset:0
    v_max3_f32 v28, v48, v49, v50
    v_mov_b32 v25, 0x3f803f80
    v_max3_f32 v28, v28, v51, v56
    v_cndmask_b32 v51, v51, v59, s[40:41]
    v_mov_b32 v24, 0x3f803f80
    v_pk_add_f32 v[54:55], v[52:53], v[54:55]
    v_max3_f32 v29, v57, v58, v59
    v_max3_f32 v29, v29, v54, v55
    v_max_f32 v30, v28, v29
    v_cndmask_b32 v48, v48, v56, s[40:41]
    v_max_f32 v28, v28, v29
    v_cndmask_b32 v49, v49, v57, s[40:41]
    v_mov_b64 v[52:53], 0
    v_pk_mul_f32 v[48:49], v[48:49], s[44:45] op_sel_hi:[1,0]
    v_permlane16_swap_b32 v28, v30
    v_max_f32 v29, v28, v30
    v_cndmask_b32 v50, v50, v58, s[40:41]
    v_max_f32 v28, v28, v30
    v_pk_mul_f32 v[54:55], v[54:55], s[44:45] op_sel_hi:[1,0]
    v_mov_b32 v27, 0
    v_permlane32_swap_b32 v28, v29
    v_pk_mul_f32 v[50:51], v[50:51], s[44:45] op_sel_hi:[1,0]
    v_max_f32 v28, v28, v29
    v_mul_f32 v28, s44, v28
    v_pk_add_f32 v[48:49], v[48:49], v[28:29] op_sel_hi:[1,0] neg_lo:[0,1] neg_hi:[0,1]
    v_pk_add_f32 v[50:51], v[50:51], v[28:29] op_sel_hi:[1,0] neg_lo:[0,1] neg_hi:[0,1]
    v_exp_f32 v48, v48
    v_exp_f32 v50, v50
    v_exp_f32 v49, v49
    v_exp_f32 v51, v51
    v_cvt_pk_bf16_f32 v14, v48, v49
    v_cvt_pk_bf16_f32 v15, v50, v51
    v_pk_add_f32 v[54:55], v[54:55], v[28:29] op_sel_hi:[1,0] neg_lo:[0,1] neg_hi:[0,1]
    v_exp_f32 v54, v54
    v_exp_f32 v55, v55
    v_mov_b32_dpp v20, v14 row_shr:8 row_mask:0xf bank_mask:0xf bound_ctrl:0
    v_mov_b32_dpp v18, v14 row_shl:8 row_mask:0xf bank_mask:0xf bound_ctrl:0
    v_cvt_pk_bf16_f32 v54, v54, v55
    v_mfma_f32_16x16x16_bf16 v[28:31], v[24:25], v[14:15], 0
    v_mov_b32 v26, 0x3f803f80
    v_cndmask_b32 v17, v15, 0, s[40:41]
    v_mov_b32_dpp v19, v15 row_shl:8 row_mask:0xf bank_mask:0xf bound_ctrl:0
    v_cndmask_b32 v16, v14, 0, s[40:41]
    v_cndmask_b32 v55, 0, v54, s[40:41]
    s_waitcnt lgkmcnt(2)
    v_mfma_f32_16x16x32_bf16 v[48:51], v[60:63], v[16:19], 0
    v_cndmask_b32 v54, v54, 0, s[40:41]
    s_nop 1
    v_mfma_f32_16x16x16_bf16 v[28:31], v[26:27], v[54:55], v[28:31]
    ds_read_b128 v[44:47], v2 offset:1024
    v_mov_b32_dpp v21, v15 row_shr:8 row_mask:0xf bank_mask:0xf bound_ctrl:0
    v_cndmask_b32 v22, 0, v14, s[40:41]
    v_cndmask_b32 v23, 0, v15, s[40:41]
    v_mfma_f32_16x16x32_bf16 v[48:51], v[36:39], v[52:55], v[48:51]
    ds_read_b128 v[56:59], v2 offset:2048
    s_waitcnt lgkmcnt(3)
    v_mfma_f32_16x16x32_bf16 v[48:51], v[32:35], v[20:23], v[48:51]
    ds_read_b128 v[60:63], v2 offset:3072
    v_add_f32_dpp v16, v28, v28 row_ror:8 row_mask:0xf bank_mask:0xf
    v_mov_b64 v[54:55], 0
    v_and_b32 v32, 0xffffffdf, v0
    v_mov_b64 v[28:29], 0
    v_mov_b64 v[30:31], 0
    v_rcp_f32 v16, v16
    s_nop 0
    v_pk_mul_f32 v[48:49], v[48:49], v[16:17] op_sel_hi:[1,0]
    v_pk_mul_f32 v[50:51], v[50:51], v[16:17] op_sel_hi:[1,0]
    v_cvt_pk_bf16_f32 v14, v48, v49
    v_cvt_pk_bf16_f32 v15, v50, v51
    ds_write_b64 v11, v[14:15]
    buffer_load_dwordx4 v0, s[8:11], s38 offen offset:0 sc1 lds
    buffer_load_dwordx4 v0, s[8:11], s38 offen offset:1024 sc1 lds
    s_waitcnt lgkmcnt(0)
    s_barrier
    ds_read_b128 v[16:19], v32 offset:30720
    s_add_u32 s38, s45, 20971520
    ds_read_b128 v[20:23], v32 offset:29696
    v_mov_b64 v[50:51], 0
    v_mov_b64 v[48:49], 0
    s_add_u32 m0, s47, 9216
    s_nop 0
    buffer_load_dwordx4 v0, s[8:11], s38 offen offset:0 sc1 lds
    ds_read_b128 v[24:27], v32 offset:30752
    ds_read_b128 v[32:35], v32 offset:29728
    s_waitcnt lgkmcnt(3)
    v_smfmac_f32_16x16x64_bf16 v[28:31], v[16:19], a[0:7], v1
    buffer_load_dwordx4 v0, s[8:11], s38 offen offset:1024 sc1 lds
    s_waitcnt lgkmcnt(2)
    v_lshrrev_b32 v14, 2, v0
    v_smfmac_f32_16x16x64_bf16 v[28:31], v[20:23], v[40:47], v1
    ds_read_b128 v[44:47], v2 offset:17408
    ds_read_b128 v[40:43], v2 offset:16384
    s_waitcnt lgkmcnt(3)
    v_smfmac_f32_16x16x64_bf16 v[28:31], v[24:27], a[8:15], v1
    s_waitcnt lgkmcnt(2)
    v_smfmac_f32_16x16x64_bf16 v[28:31], v[32:35], v[56:63], v1
    ds_read_b128 v[56:59], v2 offset:18432
    ds_read_b128 v[60:63], v2 offset:19456
    v_smfmac_f32_16x16x64_bf16 v[52:55], v[16:19], a[16:23], v1
    s_nop 3
    v_cvt_pk_bf16_f32 v28, v28, v29
    s_waitcnt lgkmcnt(2)
    v_smfmac_f32_16x16x64_bf16 v[52:55], v[20:23], v[40:47], v1
    ds_read_b128 v[44:47], v2 offset:33792
    ds_read_b128 v[40:43], v2 offset:32768
    v_cvt_pk_bf16_f32 v30, v30, v31
    v_or_b32 v28, 1, v28
    v_or_b32 v30, 1, v30
    v_smfmac_f32_16x16x64_bf16 v[52:55], v[24:27], a[24:31], v1
    buffer_store_dword v28, v14, s[8:11], s34 offen offset:0
    buffer_store_dword v30, v14, s[8:11], s34 offen offset:1024
    s_waitcnt lgkmcnt(2)
    v_mov_b64 v[30:31], 0
    v_smfmac_f32_16x16x64_bf16 v[52:55], v[32:35], v[56:63], v1
    ds_read_b128 v[56:59], v2 offset:34816
    ds_read_b128 v[60:63], v2 offset:35840
    v_smfmac_f32_16x16x64_bf16 v[48:51], v[16:19], a[32:39], v1
    s_waitcnt lgkmcnt(2)
    v_mov_b64 v[28:29], 0
    v_smfmac_f32_16x16x64_bf16 v[48:51], v[20:23], v[40:47], v1
    ds_read_b128 v[44:47], v2 offset:50176
    ds_read_b128 v[40:43], v2 offset:49152
    v_cvt_pk_bf16_f32 v52, v52, v53
    v_or_b32 v52, 1, v52
    v_cvt_pk_bf16_f32 v54, v54, v55
    v_or_b32 v54, 1, v54
    v_smfmac_f32_16x16x64_bf16 v[48:51], v[24:27], a[40:47], v1
    buffer_store_dword v52, v14, s[8:11], s34 offen offset:2048
    buffer_store_dword v54, v14, s[8:11], s34 offen offset:3072
    s_waitcnt lgkmcnt(2)
    v_smfmac_f32_16x16x64_bf16 v[48:51], v[32:35], v[56:63], v1
    ds_read_b128 v[56:59], v2 offset:51200
    ds_read_b128 v[60:63], v2 offset:52224
    v_smfmac_f32_16x16x64_bf16 v[28:31], v[16:19], a[48:55], v1
    s_waitcnt lgkmcnt(2)
    v_mov_b64 v[54:55], 0
    v_smfmac_f32_16x16x64_bf16 v[28:31], v[20:23], v[40:47], v1
    ds_read_b128 v[40:43], v0 offset:29696
    ds_read_b128 v[44:47], v0 offset:30720
    v_cvt_pk_bf16_f32 v50, v50, v51
    v_mov_b64 v[52:53], 0
    v_cvt_pk_bf16_f32 v48, v48, v49
    v_or_b32 v48, 1, v48
    v_or_b32 v50, 1, v50
    v_smfmac_f32_16x16x64_bf16 v[28:31], v[24:27], a[56:63], v1
    buffer_store_dword v48, v14, s[8:11], s68 offen offset:0
    buffer_store_dword v50, v14, s[8:11], s68 offen offset:1024
    s_waitcnt lgkmcnt(2)
    v_smfmac_f32_16x16x64_bf16 v[28:31], v[32:35], v[56:63], v1
    ds_read_b128 v[56:59], v0 offset:31744
    s_waitcnt lgkmcnt(1)
    v_smfmac_f32_16x16x64_bf16 v[52:55], v[44:47], a[64:71], v1
    v_mov_b32 v15, -1
    v_smfmac_f32_16x16x64_bf16 v[52:55], v[40:43], a[72:79], v1
    s_add_u32 s18, s43, s32
    s_add_u32 s19, s43, s33
    v_cvt_pk_bf16_f32 v30, v30, v31
    v_or_b32_e64 v30, 1, v30
    v_cvt_pk_bf16_f32 v28, v28, v29
    v_or_b32_e64 v28, 1, v28
    buffer_store_dword v28, v14, s[8:11], s68 offen offset:2048
    buffer_store_dword v30, v14, s[8:11], s68 offen offset:3072
    v_add_f32_e64 v53, v53, v55
    v_add_f32_e64 v52, v52, v54
    s_add_u32 s35, s32, s47
    v_cvt_pk_bf16_f32 v52, v52, v53
    v_or_b32_e64 v52, 1, v52
    buffer_store_dword v52, v14, s[8:11], s69 offen offset:0
    s_mov_b32 s46, s72
    s_mov_b32 s38, s33
    s_mov_b32 s33, s32
    s_mov_b32 s32, s31
    s_mov_b32 s31, s38
    s_add_u32 s30, s30, 1
    s_add_u32 s45, s45, 262144
    s_add_u32 s72, s72, 131072
    s_add_u32 s38, s33, s73
    s_add_u32 s38, s38, 4096
    s_add_u32 m0, s73, 4096
    s_lshr_b32 s36, s73, 2
    s_add_u32 s36, s36, 8192
    s_cmp_lg_u32 s29, 1
    s_cbranch_scc1 Lch_fast1_n1
Lch_fast1_r0:
Lch_fast1_r:
    buffer_load_dwordx4 v[16:19], v8, s[8:11], s42 offen sc1
    buffer_load_dwordx4 v[20:23], v8, s[8:11], s12 offen sc1
    buffer_load_dwordx4 v[24:27], v8, s[8:11], s13 offen sc1
    buffer_load_dwordx4 v[28:31], v8, s[8:11], s14 offen sc1
    s_sub_u32 s39, s39, 1
    s_cbranch_scc1 Lch_bail
    s_waitcnt vmcnt(3)
    s_waitcnt lgkmcnt(0)
    v_mfma_f32_16x16x32_bf16 v[60:63], v[56:59], v[16:19], 0
    v_bitop3_b32 v32, v16, v16, v17 bitop3:0x80
    v_bitop3_b32 v32, v32, v18, v19 bitop3:0x80
    s_waitcnt vmcnt(2)
    v_mfma_f32_16x16x32_bf16 v[60:63], v[56:59], v[20:23], v[60:63]
    v_bitop3_b32 v32, v32, v20, v21 bitop3:0x80
    v_bitop3_b32 v32, v32, v22, v23 bitop3:0x80
    s_waitcnt vmcnt(1)
    v_mfma_f32_16x16x32_bf16 v[60:63], v[56:59], v[24:27], v[60:63]
    v_bitop3_b32 v32, v32, v24, v25 bitop3:0x80
    v_bitop3_b32 v32, v32, v26, v27 bitop3:0x80
    s_waitcnt vmcnt(0)
    v_mfma_f32_16x16x32_bf16 v[60:63], v[56:59], v[28:31], v[60:63]
    v_bitop3_b32 v32, v32, v28, v29 bitop3:0x80
    v_bitop3_b32 v32, v32, v30, v31 bitop3:0x80
    v_and_b32 v32, 1, v32
    v_cmp_ne_u32 vcc, 1, v32
    s_nop 3
    v_add_f32_dpp v60, v60, v60 row_ror:8 row_mask:0xf bank_mask:0xf
    v_add_f32_dpp v61, v61, v61 row_ror:8 row_mask:0xf bank_mask:0xf
    v_cvt_pk_bf16_f32 v60, v60, v61
    v_min_u32 v60, -2, v60
    s_cbranch_vccnz Lch_fast1_r
    s_mov_b64 exec, s[22:23]
    buffer_store_dword v60, v9, s[8:11], s18 offen
    buffer_store_dword v15, v9, s[8:11], s19 offen
    s_mov_b64 exec, -1
Lch_fast1_j:
    s_waitcnt lgkmcnt(0)
    s_add_u32 s37, s36, s33
    s_add_u32 s71, s45, 21233664
    v_add_u32 v2, s3, v0
    ds_read_b128 v[48:51], v2 offset:0
    s_cmp_ge_u32 s29, 2
    s_cbranch_scc1 Lch_fast1_w2
    s_nop 15
    s_nop 8
    buffer_load_dwordx4 v[44:47], v0, s[8:11], s35 offen sc1
    buffer_load_dwordx4 v[60:63], v0, s[8:11], s35 offen offset:1024 sc1
    ds_read_b128 v[52:55], v2 offset:1024
    ds_read_b128 v[56:59], v2 offset:2048
    v_mov_b64 v[24:25], 0
    v_mov_b64 v[26:27], 0
    v_mov_b64 v[28:29], 0
    v_mov_b64 v[30:31], 0
    v_mov_b64 v[32:33], 0
    v_mov_b64 v[34:35], 0
    v_mov_b64 v[16:17], 0
    v_mov_b64 v[18:19], 0
    v_mov_b64 v[20:21], 0
    v_mov_b64 v[22:23], 0
    v_lshrrev_b32 v14, 2, v0
    s_max_i32 s16, s30, 1
    s_sub_u32 s16, s16, 1
    v_mov_b32 v15, s16
    v_add_u32 v40, s47, v0
    buffer_load_dwordx4 v[44:47], v0, s[8:11], s35 offen sc1
    buffer_load_dwordx4 v[60:63], v0, s[8:11], s35 offen offset:1024 sc1
Lch_fast1_gl:
    s_waitcnt vmcnt(3)
    v_max3_u32 v10, v44, v45, v46
    v_max_u32 v10, v10, v47
    ds_write_b128 v40, v[44:47] offset:0
    s_waitcnt vmcnt(2)
    v_max3_u32 v10, v10, v60, v61
    v_max3_u32 v10, v10, v62, v63
    v_cmp_eq_u32 vcc, -1, v10
    ds_write_b128 v40, v[60:63] offset:1024
    s_cbranch_vccnz Lch_fast1_gr
Lch_fast1_b:
    s_waitcnt lgkmcnt(0)
    s_barrier
    s_branch Lch_fast_loop
.p2align 6
Lch_fast0_n1:
    s_cmp_lt_u32 s70, 1
    s_cbranch_scc1 Lch_fast0_nu
    s_waitcnt vmcnt(0)
    s_branch Lch_fast0_r0
.p2align 6
Lch_fast0_nu:
    s_cmp_eq_u32 s25, 268435456
    s_cbranch_scc1 Lch_fast0_nu2
    s_add_u32 s48, s30, 2
    s_cmp_lt_u32 s48, s26
    s_cbranch_scc1 Lch_fast0_nu2
    s_min_u32 s48, s48, 63
Lch_fast0_kv:
    s_waitcnt lgkmcnt(0)
    s_add_u32 s16, s24, 0
    s_load_dword s16, s[8:9], s16 glc
    s_add_u32 s17, s24, 384
    s_load_dword s17, s[8:9], s17 glc
    s_add_u32 s18, s24, 128
    s_load_dword s18, s[8:9], s18 glc
    s_add_u32 s19, s24, 512
    s_load_dword s19, s[8:9], s19 glc
    s_add_u32 s20, s24, 256
    s_load_dword s20, s[8:9], s20 glc
    s_add_u32 s21, s24, 640
    s_load_dword s21, s[8:9], s21 glc
    s_sub_u32 s39, s39, 1
    s_cbranch_scc1 Lch_bail
    s_waitcnt lgkmcnt(0)
    s_min_u32 s16, s16, s17
    s_mul_i32 s16, s16, 3
    s_add_u32 s16, s16, 0
    s_min_u32 s18, s18, s19
    s_mul_i32 s18, s18, 3
    s_add_u32 s18, s18, 1
    s_min_u32 s20, s20, s21
    s_mul_i32 s20, s20, 3
    s_add_u32 s20, s20, 2
    s_min_u32 s16, s16, s18
    s_min_u32 s16, s16, s20
    s_max_u32 s26, s26, s16
    s_cmp_ge_u32 s26, 64
    s_cselect_b32 s25, 268435456, s25
    s_cmp_ge_u32 s48, s26
    s_cbranch_scc1 Lch_fast0_kv
Lch_fast0_nu2:
    s_waitcnt vmcnt(0)
    s_nop 15
    s_nop 15
    s_nop 15
    s_branch Lch_fast0_j
.p2align 6
Lch_fast0_w2:
    ds_read_b128 v[52:55], v2 offset:1024
    ds_read_b128 v[56:59], v2 offset:2048
    v_mov_b64 v[24:25], 0
    v_mov_b64 v[26:27], 0
    v_mov_b64 v[28:29], 0
    v_mov_b64 v[30:31], 0
    v_mov_b64 v[32:33], 0
    v_mov_b64 v[34:35], 0
    v_mov_b64 v[16:17], 0
    v_mov_b64 v[18:19], 0
    v_mov_b64 v[20:21], 0
    v_mov_b64 v[22:23], 0
    v_lshrrev_b32 v14, 2, v0
    s_max_i32 s16, s30, 1
    s_sub_u32 s16, s16, 1
    v_mov_b32 v15, s16
    v_add_u32 v40, s47, v0
    s_branch Lch_fast0_b
.p2align 6
Lch_fast0_gr:
    buffer_load_dwordx4 v[44:47], v0, s[8:11], s35 offen sc1
    buffer_load_dwordx4 v[60:63], v0, s[8:11], s35 offen offset:1024 sc1
    s_sub_u32 s39, s39, 1
    s_cbranch_scc0 Lch_fast0_gl
    s_branch Lch_bail
Lch_fast0_rect2:
Lch_fast0_rect1:
Lch_fast0_rec:
    s_nop 15
    s_nop 3
    s_waitcnt vmcnt(0) lgkmcnt(0)
Lch_fast0_rec2:
    s_barrier
    s_add_u32 s35, s33, s73
    s_add_u32 s36, s35, 4096
    s_add_u32 s37, s33, 8192
    s_mov_b32 s46, 268435456
    s_add_u32 m0, s73, 0
    s_nop 0
    buffer_load_dwordx4 v0, s[8:11], s35 offen sc1 lds
    s_add_u32 m0, s73, 4096
    s_nop 0
    buffer_load_dwordx4 v0, s[8:11], s36 offen sc1 lds
    s_mov_b32 m0, 8192
    s_nop 0
    buffer_load_dwordx4 v0, s[8:11], s37 offen sc1 lds
Lch_fast0_rec3:
    s_waitcnt vmcnt(0) lgkmcnt(0)
    s_barrier
    ds_read_b128 v[24:27], v0 offset:0
    ds_read_b128 v[28:31], v0 offset:1024
    ds_read_b128 v[32:35], v0 offset:2048
    ds_read_b128 v[36:39], v0 offset:3072
    ds_read_b128 v[40:43], v0 offset:4096
    ds_read_b128 v[44:47], v0 offset:5120
    ds_read_b128 v[48:51], v0 offset:6144
    ds_read_b128 v[52:55], v0 offset:7168
    ds_read_b128 v[56:59], v0 offset:8192
    v_mov_b32 v14, 0
    s_waitcnt lgkmcnt(8)
    v_max3_u32 v14, v14, v24, v25
    v_max3_u32 v14, v14, v26, v27
    s_waitcnt lgkmcnt(7)
    v_max3_u32 v14, v14, v28, v29
    v_max3_u32 v14, v14, v30, v31
    s_waitcnt lgkmcnt(6)
    v_max3_u32 v14, v14, v32, v33
    v_max3_u32 v14, v14, v34, v35
    s_waitcnt lgkmcnt(5)
    v_max3_u32 v14, v14, v36, v37
    v_max3_u32 v14, v14, v38, v39
    s_waitcnt lgkmcnt(4)
    v_max3_u32 v14, v14, v40, v41
    v_max3_u32 v14, v14, v42, v43
    s_waitcnt lgkmcnt(3)
    v_max3_u32 v14, v14, v44, v45
    v_max3_u32 v14, v14, v46, v47
    s_waitcnt lgkmcnt(2)
    v_max3_u32 v14, v14, v48, v49
    v_max3_u32 v14, v14, v50, v51
    s_waitcnt lgkmcnt(1)
    v_max3_u32 v14, v14, v52, v53
    v_max3_u32 v14, v14, v54, v55
    s_waitcnt lgkmcnt(0)
    v_max3_u32 v14, v14, v56, v57
    v_max3_u32 v14, v14, v58, v59
    v_cmp_eq_u32 vcc, -1, v14
    s_sub_u32 s39, s39, 1
    s_cbranch_scc1 Lch_bail
    s_cbranch_vccnz Lch_fast0_rec2
    v_add_u32 v2, s3, v0
    ds_read_b128 v[48:51], v2 offset:0
    ds_read_b128 v[52:55], v2 offset:1024
    ds_read_b128 v[56:59], v2 offset:2048
    v_mov_b64 v[24:25], 0
    v_mov_b64 v[26:27], 0
    v_mov_b64 v[28:29], 0
    v_mov_b64 v[30:31], 0
    v_mov_b64 v[32:33], 0
    v_mov_b64 v[34:35], 0
    v_mov_b64 v[16:17], 0
    v_mov_b64 v[18:19], 0
    v_mov_b64 v[20:21], 0
    v_mov_b64 v[22:23], 0
    s_add_u32 s38, s33, s73
    s_add_u32 s38, s38, 4096
    s_add_u32 m0, s73, 4096
    s_lshr_b32 s36, s73, 2
    s_add_u32 s36, s36, 8192
    s_add_u32 s37, s36, s33
    s_add_u32 s71, s45, 21233664
    v_lshrrev_b32 v14, 2, v0
    s_max_i32 s16, s30, 1
    s_sub_u32 s16, s16, 1
    v_mov_b32 v15, s16
    s_waitcnt lgkmcnt(0)
    s_barrier
    s_branch Lch_fast0_start
Lch_fast1_fp:
    s_mov_b64 exec, 0x555
    buffer_load_dword v10, v13, s[8:11], s25 offen sc1
    s_mov_b64 exec, -1
    s_branch Lch_fast1_fb
.p2align 6
Lch_fast1_n1:
    s_cmp_lt_u32 s70, 1
    s_cbranch_scc1 Lch_fast1_nu
    s_waitcnt vmcnt(0)
    s_branch Lch_fast1_r0
.p2align 6
Lch_fast1_nu:
    s_cmp_eq_u32 s25, 268435456
    s_cbranch_scc1 Lch_fast1_nu2
    s_waitcnt vmcnt(9)
    v_readlane_b32 s16, v10, 0
    v_readlane_b32 s17, v10, 6
    v_readlane_b32 s18, v10, 2
    v_readlane_b32 s19, v10, 8
    v_readlane_b32 s20, v10, 4
    v_readlane_b32 s21, v10, 10
    s_min_u32 s16, s16, s17
    s_mul_i32 s16, s16, 3
    s_add_u32 s16, s16, 0
    s_min_u32 s18, s18, s19
    s_mul_i32 s18, s18, 3
    s_add_u32 s18, s18, 1
    s_min_u32 s20, s20, s21
    s_mul_i32 s20, s20, 3
    s_add_u32 s20, s20, 2
    s_min_u32 s16, s16, s18
    s_min_u32 s16, s16, s20
    s_max_u32 s26, s26, s16
    s_cmp_ge_u32 s26, 64
    s_cselect_b32 s25, 268435456, s25
    s_add_u32 s48, s30, 2
    s_cmp_lt_u32 s48, s26
    s_cbranch_scc1 Lch_fast1_nu2
    s_min_u32 s48, s48, 63
Lch_fast1_kv:
    s_waitcnt lgkmcnt(0)
    s_add_u32 s16, s24, 0
    s_load_dword s16, s[8:9], s16 glc
    s_add_u32 s17, s24, 384
    s_load_dword s17, s[8:9], s17 glc
    s_add_u32 s18, s24, 128
    s_load_dword s18, s[8:9], s18 glc
    s_add_u32 s19, s24, 512
    s_load_dword s19, s[8:9], s19 glc
    s_add_u32 s20, s24, 256
    s_load_dword s20, s[8:9], s20 glc
    s_add_u32 s21, s24, 640
    s_load_dword s21, s[8:9], s21 glc
    s_sub_u32 s39, s39, 1
    s_cbranch_scc1 Lch_bail
    s_waitcnt lgkmcnt(0)
    s_min_u32 s16, s16, s17
    s_mul_i32 s16, s16, 3
    s_add_u32 s16, s16, 0
    s_min_u32 s18, s18, s19
    s_mul_i32 s18, s18, 3
    s_add_u32 s18, s18, 1
    s_min_u32 s20, s20, s21
    s_mul_i32 s20, s20, 3
    s_add_u32 s20, s20, 2
    s_min_u32 s16, s16, s18
    s_min_u32 s16, s16, s20
    s_max_u32 s26, s26, s16
    s_cmp_ge_u32 s26, 64
    s_cselect_b32 s25, 268435456, s25
    s_cmp_ge_u32 s48, s26
    s_cbranch_scc1 Lch_fast1_kv
Lch_fast1_nu2:
    s_waitcnt vmcnt(0)
    s_nop 15
    s_nop 15
    s_nop 15
    s_branch Lch_fast1_j
.p2align 6
Lch_fast1_w2:
    ds_read_b128 v[52:55], v2 offset:1024
    ds_read_b128 v[56:59], v2 offset:2048
    v_mov_b64 v[24:25], 0
    v_mov_b64 v[26:27], 0
    v_mov_b64 v[28:29], 0
    v_mov_b64 v[30:31], 0
    v_mov_b64 v[32:33], 0
    v_mov_b64 v[34:35], 0
    v_mov_b64 v[16:17], 0
    v_mov_b64 v[18:19], 0
    v_mov_b64 v[20:21], 0
    v_mov_b64 v[22:23], 0
    v_lshrrev_b32 v14, 2, v0
    s_max_i32 s16, s30, 1
    s_sub_u32 s16, s16, 1
    v_mov_b32 v15, s16
    v_add_u32 v40, s47, v0
    s_branch Lch_fast1_b
.p2align 6
Lch_fast1_gr:
    buffer_load_dwordx4 v[44:47], v0, s[8:11], s35 offen sc1
    buffer_load_dwordx4 v[60:63], v0, s[8:11], s35 offen offset:1024 sc1
    s_sub_u32 s39, s39, 1
    s_cbranch_scc0 Lch_fast1_gl
    s_branch Lch_bail
Lch_fast1_rect2:
Lch_fast1_rect1:
Lch_fast1_rec:
    s_nop 15
    s_nop 3
    s_waitcnt vmcnt(0) lgkmcnt(0)
Lch_fast1_rec2:
    s_barrier
    s_add_u32 s35, s33, s73
    s_add_u32 s36, s35, 4096
    s_add_u32 s37, s33, 8192
    s_mov_b32 s46, 268435456
    s_add_u32 m0, s73, 0
    s_nop 0
    buffer_load_dwordx4 v0, s[8:11], s35 offen sc1 lds
    s_add_u32 m0, s73, 4096
    s_nop 0
    buffer_load_dwordx4 v0, s[8:11], s36 offen sc1 lds
    s_mov_b32 m0, 8192
    s_nop 0
    buffer_load_dwordx4 v0, s[8:11], s37 offen sc1 lds
Lch_fast1_rec3:
    s_waitcnt vmcnt(0) lgkmcnt(0)
    s_barrier
    ds_read_b128 v[24:27], v0 offset:0
    ds_read_b128 v[28:31], v0 offset:1024
    ds_read_b128 v[32:35], v0 offset:2048
    ds_read_b128 v[36:39], v0 offset:3072
    ds_read_b128 v[40:43], v0 offset:4096
    ds_read_b128 v[44:47], v0 offset:5120
    ds_read_b128 v[48:51], v0 offset:6144
    ds_read_b128 v[52:55], v0 offset:7168
    ds_read_b128 v[56:59], v0 offset:8192
    v_mov_b32 v14, 0
    s_waitcnt lgkmcnt(8)
    v_max3_u32 v14, v14, v24, v25
    v_max3_u32 v14, v14, v26, v27
    s_waitcnt lgkmcnt(7)
    v_max3_u32 v14, v14, v28, v29
    v_max3_u32 v14, v14, v30, v31
    s_waitcnt lgkmcnt(6)
    v_max3_u32 v14, v14, v32, v33
    v_max3_u32 v14, v14, v34, v35
    s_waitcnt lgkmcnt(5)
    v_max3_u32 v14, v14, v36, v37
    v_max3_u32 v14, v14, v38, v39
    s_waitcnt lgkmcnt(4)
    v_max3_u32 v14, v14, v40, v41
    v_max3_u32 v14, v14, v42, v43
    s_waitcnt lgkmcnt(3)
    v_max3_u32 v14, v14, v44, v45
    v_max3_u32 v14, v14, v46, v47
    s_waitcnt lgkmcnt(2)
    v_max3_u32 v14, v14, v48, v49
    v_max3_u32 v14, v14, v50, v51
    s_waitcnt lgkmcnt(1)
    v_max3_u32 v14, v14, v52, v53
    v_max3_u32 v14, v14, v54, v55
    s_waitcnt lgkmcnt(0)
    v_max3_u32 v14, v14, v56, v57
    v_max3_u32 v14, v14, v58, v59
    v_cmp_eq_u32 vcc, -1, v14
    s_sub_u32 s39, s39, 1
    s_cbranch_scc1 Lch_bail
    s_cbranch_vccnz Lch_fast1_rec2
    v_add_u32 v2, s3, v0
    ds_read_b128 v[48:51], v2 offset:0
    ds_read_b128 v[52:55], v2 offset:1024
    ds_read_b128 v[56:59], v2 offset:2048
    v_mov_b64 v[24:25], 0
    v_mov_b64 v[26:27], 0
    v_mov_b64 v[28:29], 0
    v_mov_b64 v[30:31], 0
    v_mov_b64 v[32:33], 0
    v_mov_b64 v[34:35], 0
    v_mov_b64 v[16:17], 0
    v_mov_b64 v[18:19], 0
    v_mov_b64 v[20:21], 0
    v_mov_b64 v[22:23], 0
    s_add_u32 s38, s33, s73
    s_add_u32 s38, s38, 4096
    s_add_u32 m0, s73, 4096
    s_lshr_b32 s36, s73, 2
    s_add_u32 s36, s36, 8192
    s_add_u32 s37, s36, s33
    s_add_u32 s71, s45, 21233664
    v_lshrrev_b32 v14, 2, v0
    s_max_i32 s16, s30, 1
    s_sub_u32 s16, s16, 1
    v_mov_b32 v15, s16
    s_waitcnt lgkmcnt(0)
    s_barrier
    s_branch Lch_fast1_start
.p2align 6
Lch_slow_loop:
Lch_slow0_start:
    ds_read_b128 v[40:43], v0 offset:0
    buffer_load_dwordx4 v0, s[8:11], s38 offen sc1 lds
    s_mov_b32 m0, s36
    s_nop 0
    buffer_load_dword v14, s[8:11], s37 offen sc1 lds
    s_waitcnt lgkmcnt(0)
    v_smfmac_f32_16x16x64_bf16 v[24:27], v[40:43], v[48:55], v1
    s_waitcnt vmcnt(2)
    ds_read_b128 v[60:63], v2 offset:3072
    ds_read_b128 v[52:55], v2 offset:17408
    v_smfmac_f32_16x16x64_bf16 v[32:35], v[40:43], v[112:119], v1
    v_smfmac_f32_16x16x64_bf16 v[20:23], v[40:43], a[88:95], v1
    buffer_store_dwordx4 v[36:39], v0, s[8:11], s46 offen sc1
    ds_read_b128 v[48:51], v2 offset:16384
    ds_read_b128 v[44:47], v0 offset:1024
    s_waitcnt lgkmcnt(3)
    v_mov_b64 v[36:37], 0
    v_smfmac_f32_16x16x64_bf16 v[28:31], v[40:43], v[56:63], v1
    ds_read_b128 v[56:59], v2 offset:18432
    v_mov_b64 v[38:39], 0
    v_smfmac_f32_16x16x64_bf16 v[16:19], v[40:43], a[80:87], v1
    ds_read_b128 v[60:63], v2 offset:19456
    v_smfmac_f32_16x16x64_bf16 v[36:39], v[40:43], v[120:127], v1
    ds_read_b128 v[40:43], v0 offset:2048
    s_waitcnt lgkmcnt(3)
    v_smfmac_f32_16x16x64_bf16 v[24:27], v[44:47], v[48:55], v1
    v_smfmac_f32_16x16x64_bf16 v[32:35], v[44:47], v[128:135], v1
    ds_read_b128 v[48:51], v2 offset:32768
    ds_read_b128 v[52:55], v2 offset:33792
    v_smfmac_f32_16x16x64_bf16 v[20:23], v[44:47], a[104:111], v1
    buffer_load_dword v10, v13, s[8:11], s71 offen sc1
    v_smfmac_f32_16x16x64_bf16 v[36:39], v[44:47], v[136:143], v1
    s_waitcnt lgkmcnt(3)
    v_smfmac_f32_16x16x64_bf16 v[28:31], v[44:47], v[56:63], v1
    ds_read_b128 v[56:59], v2 offset:34816
    v_smfmac_f32_16x16x64_bf16 v[16:19], v[44:47], a[96:103], v1
    ds_read_b128 v[60:63], v2 offset:35840
    s_waitcnt lgkmcnt(2)
    v_smfmac_f32_16x16x64_bf16 v[24:27], v[40:43], v[48:55], v1
    ds_read_b128 v[48:51], v2 offset:49152
    v_smfmac_f32_16x16x64_bf16 v[20:23], v[40:43], a[120:127], v1
    ds_read_b128 v[52:55], v2 offset:50176
    ds_read_b128 v[44:47], v0 offset:3072
    v_smfmac_f32_16x16x64_bf16 v[32:35], v[40:43], v[144:151], v1
    s_mov_b64 exec, 1
    buffer_store_dword v15, v0, s[8:11], s27 offen sc0 sc1
    s_mov_b64 exec, -1
    v_smfmac_f32_16x16x64_bf16 v[16:19], v[40:43], a[112:119], v1
    s_waitcnt lgkmcnt(3)
    v_smfmac_f32_16x16x64_bf16 v[28:31], v[40:43], v[56:63], v1
    s_waitcnt lgkmcnt(0)
    v_smfmac_f32_16x16x64_bf16 v[24:27], v[44:47], a[208:215], v1
    ds_read_b128 v[60:63], v2 offset:52224
    ds_read_b128 v[56:59], v2 offset:51200
    v_smfmac_f32_16x16x64_bf16 v[16:19], v[44:47], v[48:55], v1
    s_waitcnt vmcnt(3)
    s_barrier
    v_smfmac_f32_16x16x64_bf16 v[36:39], v[40:43], v[152:159], v1
    ds_read_b128 v[40:43], v0 offset:4096
    v_add_u32 v2, 0x10000, v2
    v_smfmac_f32_16x16x64_bf16 v[28:31], v[44:47], a[216:223], v1
    ds_read_b128 v[48:51], v0 offset:5120
    v_smfmac_f32_16x16x64_bf16 v[32:35], v[44:47], v[160:167], v1
    ds_read_b128 v[52:55], v0 offset:8192
    v_smfmac_f32_16x16x64_bf16 v[36:39], v[44:47], v[168:175], v1
    s_waitcnt lgkmcnt(3)
    v_smfmac_f32_16x16x64_bf16 v[20:23], v[44:47], v[56:63], v1
    ds_read_b128 v[60:63], v0 offset:7168
    s_waitcnt lgkmcnt(3)
    v_max3_u32 v14, v40, v41, v42
    v_smfmac_f32_16x16x64_bf16 v[20:23], v[40:43], a[136:143], v1
    ds_read_b128 v[56:59], v0 offset:6144
    v_max_u32 v14, v14, v43
    v_smfmac_f32_16x16x64_bf16 v[16:19], v[40:43], a[128:135], v1
    s_waitcnt lgkmcnt(3)
    v_max3_u32 v14, v48, v49, v14
    v_smfmac_f32_16x16x64_bf16 v[20:23], v[48:51], a[152:159], v1
    s_waitcnt lgkmcnt(2)
    v_max3_u32 v14, v14, v50, v51
    v_smfmac_f32_16x16x64_bf16 v[20:23], v[52:55], a[200:207], v1
    v_smfmac_f32_16x16x64_bf16 v[16:19], v[52:55], a[192:199], v1
    s_waitcnt lgkmcnt(0)
    v_max3_u32 v14, v52, v53, v14
    v_smfmac_f32_16x16x64_bf16 v[16:19], v[56:59], a[160:167], v1
    v_max3_u32 v14, v14, v54, v55
    v_smfmac_f32_16x16x64_bf16 v[20:23], v[56:59], a[168:175], v1
    v_max3_u32 v14, v56, v57, v14
    v_smfmac_f32_16x16x64_bf16 v[16:19], v[48:51], a[144:151], v1
    v_max3_u32 v14, v14, v58, v59
    v_smfmac_f32_16x16x64_bf16 v[16:19], v[60:63], a[176:183], v1
    v_max3_u32 v14, v60, v61, v14
    v_smfmac_f32_16x16x64_bf16 v[20:23], v[60:63], a[184:191], v1
    v_max3_u32 v14, v14, v62, v63
    v_smfmac_f32_16x16x64_bf16 v[28:31], v[40:43], a[232:239], v1
    v_cmp_eq_u32 vcc, -1, v14
    v_smfmac_f32_16x16x64_bf16 v[24:27], v[40:43], a[224:231], v1
    v_add_f32 v21, v21, v23
    v_smfmac_f32_16x16x64_bf16 v[24:27], v[48:51], a[240:247], v1
    s_cbranch_vccnz Lch_slow0_rect2
    v_add_f32 v16, v16, v18
    v_add_f32 v20, v20, v22
    v_add_f32 v17, v17, v19
    v_cvt_pk_bf16_f32 v14, v16, v17
    v_cvt_pk_bf16_f32 v15, v20, v21
    v_smfmac_f32_16x16x64_bf16 v[28:31], v[48:51], a[248:255], v1
    ds_write2_b32 v3, v14, v15 offset0:0 offset1:64
    v_smfmac_f32_16x16x64_bf16 v[24:27], v[56:59], v[64:71], v1
    v_smfmac_f32_16x16x64_bf16 v[28:31], v[56:59], v[72:79], v1
    ds_read_b128 v[56:59], v12 offset:9472
    ds_read_b128 v[48:51], v12 offset:9216
    v_smfmac_f32_16x16x64_bf16 v[24:27], v[60:63], v[80:87], v1
    v_smfmac_f32_16x16x64_bf16 v[24:27], v[52:55], v[96:103], v1
    v_smfmac_f32_16x16x64_bf16 v[28:31], v[60:63], v[88:95], v1
    s_waitcnt lgkmcnt(2)
    s_barrier
    ds_read_b64_tr_b16 v[16:17], v5 offset:25600
    v_smfmac_f32_16x16x64_bf16 v[28:31], v[52:55], v[104:111], v1
    ds_read_b64_tr_b16 v[18:19], v5 offset:25632
    v_add_f32 v24, v24, v26
    v_smfmac_f32_16x16x64_bf16 v[32:35], v[60:63], v[224:231], v1
    ds_read_b64_tr_b16 v[20:21], v5 offset:26112
    v_add_f32 v25, v25, v27
    v_smfmac_f32_16x16x64_bf16 v[36:39], v[60:63], v[232:239], v1
    ds_read_b128 v[60:63], v0 offset:4096
    v_add_f32 v29, v29, v31
    v_add_f32 v28, v28, v30
    v_cvt_pk_bf16_f32 v15, v28, v29
    v_smfmac_f32_16x16x64_bf16 v[32:35], v[52:55], v[240:247], v1
    ds_read_b64_tr_b16 v[22:23], v5 offset:26144
    v_cvt_pk_bf16_f32 v14, v24, v25
    v_smfmac_f32_16x16x64_bf16 v[36:39], v[52:55], v[248:255], v1
    ds_read_b128 v[24:27], v12 offset:11264
    s_waitcnt lgkmcnt(4)
    v_mfma_f32_16x16x32_bf16 v[48:51], v[48:51], v[16:19], 0
    ds_read_b128 v[28:31], v12 offset:11520
    ds_read_b128 v[52:55], v0 offset:5120
    v_mfma_f32_16x16x32_bf16 v[56:59], v[56:59], v[16:19], 0
    ds_read_b64_tr_b16 v[42:43], v5 offset:26656
    s_waitcnt lgkmcnt(5)
    v_smfmac_f32_16x16x64_bf16 v[32:35], v[60:63], v[176:183], v1
    ds_write_b64 v4, v[14:15]
    v_smfmac_f32_16x16x64_bf16 v[36:39], v[60:63], v[184:191], v1
    ds_read_b128 v[60:63], v0 offset:6144
    s_waitcnt lgkmcnt(5)
    v_mfma_f32_16x16x32_bf16 v[48:51], v[24:27], v[20:23], v[48:51]
    ds_read_b128 v[24:27], v12 offset:13312
    s_waitcnt lgkmcnt(5)
    v_mfma_f32_16x16x32_bf16 v[56:59], v[28:31], v[20:23], v[56:59]
    ds_read_b128 v[28:31], v12 offset:13568
    s_waitcnt lgkmcnt(5)
    v_smfmac_f32_16x16x64_bf16 v[32:35], v[52:55], v[192:199], v1
    ds_read_b64_tr_b16 v[46:47], v5 offset:27168
    v_smfmac_f32_16x16x64_bf16 v[36:39], v[52:55], v[200:207], v1
    ds_read_b64_tr_b16 v[40:41], v5 offset:26624
    ds_read_b64_tr_b16 v[44:45], v5 offset:27136
    s_waitcnt lgkmcnt(5)
    v_smfmac_f32_16x16x64_bf16 v[32:35], v[60:63], v[208:215], v1
    s_barrier
    ds_read_b128 v[52:55], v12 offset:15360
    v_smfmac_f32_16x16x64_bf16 v[36:39], v[60:63], v[216:223], v1
    ds_read_b128 v[60:63], v12 offset:15616
    s_waitcnt lgkmcnt(3)
    v_mfma_f32_16x16x32_bf16 v[48:51], v[24:27], v[40:43], v[48:51]
    ds_read_b64_tr_b16 v[26:27], v6 offset:27680
    ds_read_b64_tr_b16 v[24:25], v6 offset:27648
    v_add_f32 v32, v32, v34
    v_mfma_f32_16x16x32_bf16 v[56:59], v[28:31], v[40:43], v[56:59]
    ds_read_b64_tr_b16 v[30:31], v6 offset:28704
    ds_read_b64_tr_b16 v[28:29], v6 offset:28672
    v_add_f32 v37, v37, v39
    v_add_f32 v33, v33, v35
    v_add_f32 v36, v36, v38
    v_cvt_pk_bf16_f32 v38, v32, v33
    s_waitcnt lgkmcnt(5)
    v_mfma_f32_16x16x32_bf16 v[48:51], v[52:55], v[44:47], v[48:51]
    s_waitcnt lgkmcnt(4)
    v_mov_b64 v[52:53], 0
    v_mov_b64 v[54:55], 0
    v_mfma_f32_16x16x32_bf16 v[56:59], v[60:63], v[44:47], v[56:59]
    s_add_u32 s38, s45, 37748736
    ds_read_b128 v[60:63], v7 offset:17408
    s_waitcnt lgkmcnt(3)
    v_cvt_pk_bf16_f32 v39, v36, v37
    v_mov_b64 v[36:37], v[14:15]
    v_smfmac_f32_16x16x64_bf16 v[52:55], v[24:27], v[16:23], v1
    s_waitcnt lgkmcnt(1)
    v_smfmac_f32_16x16x64_bf16 v[52:55], v[28:31], v[40:47], v1
    s_add_u32 m0, s47, 17408
    ds_read_b128 v[32:35], v7 offset:17664
    ds_read_b128 v[40:43], v2 offset:0
    v_max3_f32 v28, v48, v49, v50
    v_mov_b32 v25, 0x3f803f80
    v_max3_f32 v28, v28, v51, v56
    v_cndmask_b32 v51, v51, v59, s[40:41]
    v_mov_b32 v24, 0x3f803f80
    v_pk_add_f32 v[54:55], v[52:53], v[54:55]
    v_max3_f32 v29, v57, v58, v59
    v_max3_f32 v29, v29, v54, v55
    v_max_f32 v30, v28, v29
    v_cndmask_b32 v48, v48, v56, s[40:41]
    v_max_f32 v28, v28, v29
    v_cndmask_b32 v49, v49, v57, s[40:41]
    v_mov_b64 v[52:53], 0
    v_pk_mul_f32 v[48:49], v[48:49], s[44:45] op_sel_hi:[1,0]
    v_permlane16_swap_b32 v28, v30
    v_max_f32 v29, v28, v30
    v_cndmask_b32 v50, v50, v58, s[40:41]
    v_max_f32 v28, v28, v30
    v_pk_mul_f32 v[54:55], v[54:55], s[44:45] op_sel_hi:[1,0]
    v_mov_b32 v27, 0
    v_permlane32_swap_b32 v28, v29
    v_pk_mul_f32 v[50:51], v[50:51], s[44:45] op_sel_hi:[1,0]
    v_max_f32 v28, v28, v29
    v_mul_f32 v28, s44, v28
    v_pk_add_f32 v[48:49], v[48:49], v[28:29] op_sel_hi:[1,0] neg_lo:[0,1] neg_hi:[0,1]
    v_pk_add_f32 v[50:51], v[50:51], v[28:29] op_sel_hi:[1,0] neg_lo:[0,1] neg_hi:[0,1]
    v_exp_f32 v48, v48
    v_exp_f32 v50, v50
    v_exp_f32 v49, v49
    v_exp_f32 v51, v51
    v_cvt_pk_bf16_f32 v14, v48, v49
    v_cvt_pk_bf16_f32 v15, v50, v51
    v_pk_add_f32 v[54:55], v[54:55], v[28:29] op_sel_hi:[1,0] neg_lo:[0,1] neg_hi:[0,1]
    v_exp_f32 v54, v54
    v_exp_f32 v55, v55
    v_mov_b32_dpp v20, v14 row_shr:8 row_mask:0xf bank_mask:0xf bound_ctrl:0
    v_mov_b32_dpp v18, v14 row_shl:8 row_mask:0xf bank_mask:0xf bound_ctrl:0
    v_cvt_pk_bf16_f32 v54, v54, v55
    v_mfma_f32_16x16x16_bf16 v[28:31], v[24:25], v[14:15], 0
    v_mov_b32 v26, 0x3f803f80
    v_cndmask_b32 v17, v15, 0, s[40:41]
    v_mov_b32_dpp v19, v15 row_shl:8 row_mask:0xf bank_mask:0xf bound_ctrl:0
    v_cndmask_b32 v16, v14, 0, s[40:41]
    v_cndmask_b32 v55, 0, v54, s[40:41]
    s_waitcnt lgkmcnt(2)
    v_mfma_f32_16x16x32_bf16 v[48:51], v[60:63], v[16:19], 0
    v_cndmask_b32 v54, v54, 0, s[40:41]
    s_nop 1
    v_mfma_f32_16x16x16_bf16 v[28:31], v[26:27], v[54:55], v[28:31]
    ds_read_b128 v[44:47], v2 offset:1024
    v_mov_b32_dpp v21, v15 row_shr:8 row_mask:0xf bank_mask:0xf bound_ctrl:0
    v_cndmask_b32 v22, 0, v14, s[40:41]
    v_cndmask_b32 v23, 0, v15, s[40:41]
    v_mfma_f32_16x16x32_bf16 v[48:51], v[36:39], v[52:55], v[48:51]
    ds_read_b128 v[56:59], v2 offset:2048
    s_waitcnt lgkmcnt(3)
    v_mfma_f32_16x16x32_bf16 v[48:51], v[32:35], v[20:23], v[48:51]
    ds_read_b128 v[60:63], v2 offset:3072
    v_add_f32_dpp v16, v28, v28 row_ror:8 row_mask:0xf bank_mask:0xf
    v_mov_b64 v[54:55], 0
    v_and_b32 v32, 0xffffffdf, v0
    v_mov_b64 v[28:29], 0
    v_mov_b64 v[30:31], 0
    v_rcp_f32 v16, v16
    s_nop 0
    v_pk_mul_f32 v[48:49], v[48:49], v[16:17] op_sel_hi:[1,0]
    v_pk_mul_f32 v[50:51], v[50:51], v[16:17] op_sel_hi:[1,0]
    v_cvt_pk_bf16_f32 v14, v48, v49
    v_cvt_pk_bf16_f32 v15, v50, v51
    ds_write_b64 v11, v[14:15]
    buffer_load_dwordx4 v0, s[8:11], s38 offen offset:0 sc1 lds
    buffer_load_dwordx4 v0, s[8:11], s38 offen offset:1024 sc1 lds
    s_waitcnt lgkmcnt(0)
    s_barrier
    ds_read_b128 v[16:19], v32 offset:30720
    s_add_u32 s38, s45, 20971520
    ds_read_b128 v[20:23], v32 offset:29696
    v_mov_b64 v[50:51], 0
    v_mov_b64 v[48:49], 0
    s_add_u32 m0, s47, 9216
    s_nop 0
    buffer_load_dwordx4 v0, s[8:11], s38 offen offset:0 sc1 lds
    ds_read_b128 v[24:27], v32 offset:30752
    ds_read_b128 v[32:35], v32 offset:29728
    s_waitcnt lgkmcnt(3)
    v_smfmac_f32_16x16x64_bf16 v[28:31], v[16:19], a[0:7], v1
    buffer_load_dwordx4 v0, s[8:11], s38 offen offset:1024 sc1 lds
    s_waitcnt lgkmcnt(2)
    v_lshrrev_b32 v14, 2, v0
    v_smfmac_f32_16x16x64_bf16 v[28:31], v[20:23], v[40:47], v1
    ds_read_b128 v[44:47], v2 offset:17408
    ds_read_b128 v[40:43], v2 offset:16384
    s_waitcnt lgkmcnt(3)
    v_smfmac_f32_16x16x64_bf16 v[28:31], v[24:27], a[8:15], v1
    s_waitcnt lgkmcnt(2)
    v_smfmac_f32_16x16x64_bf16 v[28:31], v[32:35], v[56:63], v1
    ds_read_b128 v[56:59], v2 offset:18432
    ds_read_b128 v[60:63], v2 offset:19456
    v_smfmac_f32_16x16x64_bf16 v[52:55], v[16:19], a[16:23], v1
    s_nop 3
    v_cvt_pk_bf16_f32 v28, v28, v29
    s_waitcnt lgkmcnt(2)
    v_smfmac_f32_16x16x64_bf16 v[52:55], v[20:23], v[40:47], v1
    ds_read_b128 v[44:47], v2 offset:33792
    ds_read_b128 v[40:43], v2 offset:32768
    v_cvt_pk_bf16_f32 v30, v30, v31
    v_and_b32 v28, -2, v28
    v_and_b32 v30, -2, v30
    v_smfmac_f32_16x16x64_bf16 v[52:55], v[24:27], a[24:31], v1
    buffer_store_dword v28, v14, s[8:11], s34 offen offset:0 sc0 sc1
    buffer_store_dword v30, v14, s[8:11], s34 offen offset:1024 sc0 sc1
    s_waitcnt lgkmcnt(2)
    v_mov_b64 v[30:31], 0
    v_smfmac_f32_16x16x64_bf16 v[52:55], v[32:35], v[56:63], v1
    ds_read_b128 v[56:59], v2 offset:34816
    ds_read_b128 v[60:63], v2 offset:35840
    v_smfmac_f32_16x16x64_bf16 v[48:51], v[16:19], a[32:39], v1
    s_waitcnt lgkmcnt(2)
    v_mov_b64 v[28:29], 0
    v_smfmac_f32_16x16x64_bf16 v[48:51], v[20:23], v[40:47], v1
    ds_read_b128 v[44:47], v2 offset:50176
    ds_read_b128 v[40:43], v2 offset:49152
    v_cvt_pk_bf16_f32 v52, v52, v53
    v_and_b32 v52, -2, v52
    v_cvt_pk_bf16_f32 v54, v54, v55
    v_and_b32 v54, -2, v54
    v_smfmac_f32_16x16x64_bf16 v[48:51], v[24:27], a[40:47], v1
    buffer_store_dword v52, v14, s[8:11], s34 offen offset:2048 sc0 sc1
    buffer_store_dword v54, v14, s[8:11], s34 offen offset:3072 sc0 sc1
    s_waitcnt lgkmcnt(2)
    v_smfmac_f32_16x16x64_bf16 v[48:51], v[32:35], v[56:63], v1
    ds_read_b128 v[56:59], v2 offset:51200
    ds_read_b128 v[60:63], v2 offset:52224
    v_smfmac_f32_16x16x64_bf16 v[28:31], v[16:19], a[48:55], v1
    s_waitcnt lgkmcnt(2)
    v_mov_b64 v[54:55], 0
    v_smfmac_f32_16x16x64_bf16 v[28:31], v[20:23], v[40:47], v1
    ds_read_b128 v[40:43], v0 offset:29696
    ds_read_b128 v[44:47], v0 offset:30720
    v_cvt_pk_bf16_f32 v50, v50, v51
    v_mov_b64 v[52:53], 0
    v_cvt_pk_bf16_f32 v48, v48, v49
    v_and_b32 v48, -2, v48
    v_and_b32 v50, -2, v50
    v_smfmac_f32_16x16x64_bf16 v[28:31], v[24:27], a[56:63], v1
    buffer_store_dword v48, v14, s[8:11], s68 offen offset:0 sc0 sc1
    buffer_store_dword v50, v14, s[8:11], s68 offen offset:1024 sc0 sc1
    s_waitcnt lgkmcnt(2)
    v_smfmac_f32_16x16x64_bf16 v[28:31], v[32:35], v[56:63], v1
    ds_read_b128 v[56:59], v0 offset:31744
    s_waitcnt lgkmcnt(1)
    v_smfmac_f32_16x16x64_bf16 v[52:55], v[44:47], a[64:71], v1
    v_mov_b32 v15, -1
    v_smfmac_f32_16x16x64_bf16 v[52:55], v[40:43], a[72:79], v1
    s_add_u32 s18, s43, s32
    s_add_u32 s19, s43, s33
    v_cvt_pk_bf16_f32 v30, v30, v31
    v_and_b32 v30, -2, v30
    v_cvt_pk_bf16_f32 v28, v28, v29
    v_and_b32 v28, -2, v28
    buffer_store_dword v28, v14, s[8:11], s68 offen offset:2048 sc0 sc1
    buffer_store_dword v30, v14, s[8:11], s68 offen offset:3072 sc0 sc1
    v_add_f32 v53, v53, v55
    v_add_f32 v52, v52, v54
    s_add_u32 s35, s32, s47
    v_cvt_pk_bf16_f32 v52, v52, v53
    v_and_b32 v52, -2, v52
    buffer_store_dword v52, v14, s[8:11], s69 offen offset:0 sc0 sc1
    s_mov_b32 s46, s72
    s_mov_b32 s38, s33
    s_mov_b32 s33, s32
    s_mov_b32 s32, s31
    s_mov_b32 s31, s38
    s_add_u32 s30, s30, 1
    s_add_u32 s45, s45, 262144
    s_add_u32 s72, s72, 131072
    s_add_u32 s38, s33, s73
    s_add_u32 s38, s38, 4096
    s_add_u32 m0, s73, 4096
    s_lshr_b32 s36, s73, 2
    s_add_u32 s36, s36, 8192
    s_cmp_lg_u32 s29, 1
    s_cbranch_scc1 Lch_slow0_n1
    s_waitcnt vmcnt(0)
Lch_slow0_r0:
Lch_slow0_r:
    buffer_load_dwordx4 v[16:19], v8, s[8:11], s42 offen sc1
    buffer_load_dwordx4 v[20:23], v8, s[8:11], s12 offen sc1
    buffer_load_dwordx4 v[24:27], v8, s[8:11], s13 offen sc1
    buffer_load_dwordx4 v[28:31], v8, s[8:11], s14 offen sc1
    s_sub_u32 s39, s39, 1
    s_cbranch_scc1 Lch_bail
    s_waitcnt vmcnt(3)
    s_waitcnt lgkmcnt(0)
    v_mfma_f32_16x16x32_bf16 v[60:63], v[56:59], v[16:19], 0
    v_bitop3_b32 v32, v16, v16, v17 bitop3:0xfe
    v_bitop3_b32 v32, v32, v18, v19 bitop3:0xfe
    s_waitcnt vmcnt(2)
    v_mfma_f32_16x16x32_bf16 v[60:63], v[56:59], v[20:23], v[60:63]
    v_bitop3_b32 v32, v32, v20, v21 bitop3:0xfe
    v_bitop3_b32 v32, v32, v22, v23 bitop3:0xfe
    s_waitcnt vmcnt(1)
    v_mfma_f32_16x16x32_bf16 v[60:63], v[56:59], v[24:27], v[60:63]
    v_bitop3_b32 v32, v32, v24, v25 bitop3:0xfe
    v_bitop3_b32 v32, v32, v26, v27 bitop3:0xfe
    s_waitcnt vmcnt(0)
    v_mfma_f32_16x16x32_bf16 v[60:63], v[56:59], v[28:31], v[60:63]
    v_bitop3_b32 v32, v32, v28, v29 bitop3:0xfe
    v_bitop3_b32 v32, v32, v30, v31 bitop3:0xfe
    v_and_b32 v32, 1, v32
    v_cmp_ne_u32 vcc, 0, v32
    s_nop 3
    v_add_f32_dpp v60, v60, v60 row_ror:8 row_mask:0xf bank_mask:0xf
    v_add_f32_dpp v61, v61, v61 row_ror:8 row_mask:0xf bank_mask:0xf
    v_cvt_pk_bf16_f32 v60, v60, v61
    v_min_u32 v60, -2, v60
    s_cbranch_vccnz Lch_slow0_r
    s_mov_b64 exec, s[22:23]
    buffer_store_dword v60, v9, s[8:11], s18 offen sc0 sc1
    buffer_store_dword v15, v9, s[8:11], s19 offen sc0 sc1
    s_mov_b64 exec, -1
Lch_slow0_j:
    s_waitcnt lgkmcnt(0)
    s_add_u32 s37, s36, s33
    s_add_u32 s71, s45, 21233664
    v_add_u32 v2, s3, v0
    ds_read_b128 v[48:51], v2 offset:0
    s_cmp_ge_u32 s29, 2
    s_cbranch_scc1 Lch_slow0_w2
    s_nop 15
    s_nop 15
    s_nop 15
    s_nop 15
    buffer_load_dwordx4 v[44:47], v0, s[8:11], s35 offen sc1
    buffer_load_dwordx4 v[60:63], v0, s[8:11], s35 offen offset:1024 sc1
    ds_read_b128 v[52:55], v2 offset:1024
    ds_read_b128 v[56:59], v2 offset:2048
    v_mov_b64 v[24:25], 0
    v_mov_b64 v[26:27], 0
    v_mov_b64 v[28:29], 0
    v_mov_b64 v[30:31], 0
    v_mov_b64 v[32:33], 0
    v_mov_b64 v[34:35], 0
    v_mov_b64 v[16:17], 0
    v_mov_b64 v[18:19], 0
    v_mov_b64 v[20:21], 0
    v_mov_b64 v[22:23], 0
    v_lshrrev_b32 v14, 2, v0
    s_max_i32 s16, s30, 1
    s_sub_u32 s16, s16, 1
    v_mov_b32 v15, s16
    v_add_u32 v40, s47, v0
    s_nop 15
    s_nop 15
    buffer_load_dwordx4 v[44:47], v0, s[8:11], s35 offen sc1
    buffer_load_dwordx4 v[60:63], v0, s[8:11], s35 offen offset:1024 sc1
Lch_slow0_gl:
    s_waitcnt vmcnt(3)
    v_max3_u32 v10, v44, v45, v46
    v_max_u32 v10, v10, v47
    ds_write_b128 v40, v[44:47] offset:0
    s_waitcnt vmcnt(2)
    v_max3_u32 v10, v10, v60, v61
    v_max3_u32 v10, v10, v62, v63
    v_cmp_eq_u32 vcc, -1, v10
    ds_write_b128 v40, v[60:63] offset:1024
    s_cbranch_vccnz Lch_slow0_gr
Lch_slow0_b:
    s_waitcnt lgkmcnt(0)
    s_barrier
Lch_slow1_start:
    ds_read_b128 v[40:43], v0 offset:0
    buffer_load_dwordx4 v0, s[8:11], s38 offen sc1 lds
    s_mov_b32 m0, s36
    s_nop 0
    buffer_load_dword v14, s[8:11], s37 offen sc1 lds
    s_waitcnt lgkmcnt(0)
    v_smfmac_f32_16x16x64_bf16 v[24:27], v[40:43], v[48:55], v1
    s_waitcnt vmcnt(2)
    ds_read_b128 v[60:63], v2 offset:3072
    ds_read_b128 v[52:55], v2 offset:17408
    v_smfmac_f32_16x16x64_bf16 v[32:35], v[40:43], v[112:119], v1
    v_smfmac_f32_16x16x64_bf16 v[20:23], v[40:43], a[88:95], v1
    buffer_store_dwordx4 v[36:39], v0, s[8:11], s46 offen sc1
    ds_read_b128 v[48:51], v2 offset:16384
    ds_read_b128 v[44:47], v0 offset:1024
    s_waitcnt lgkmcnt(3)
    v_mov_b64 v[36:37], 0
    v_smfmac_f32_16x16x64_bf16 v[28:31], v[40:43], v[56:63], v1
    ds_read_b128 v[56:59], v2 offset:18432
    v_mov_b64 v[38:39], 0
    v_smfmac_f32_16x16x64_bf16 v[16:19], v[40:43], a[80:87], v1
    ds_read_b128 v[60:63], v2 offset:19456
    v_smfmac_f32_16x16x64_bf16 v[36:39], v[40:43], v[120:127], v1
    ds_read_b128 v[40:43], v0 offset:2048
    s_waitcnt lgkmcnt(3)
    v_smfmac_f32_16x16x64_bf16 v[24:27], v[44:47], v[48:55], v1
    v_smfmac_f32_16x16x64_bf16 v[32:35], v[44:47], v[128:135], v1
    ds_read_b128 v[48:51], v2 offset:32768
    ds_read_b128 v[52:55], v2 offset:33792
    v_smfmac_f32_16x16x64_bf16 v[20:23], v[44:47], a[104:111], v1
    buffer_load_dword v10, v13, s[8:11], s71 offen sc1
    v_smfmac_f32_16x16x64_bf16 v[36:39], v[44:47], v[136:143], v1
    s_waitcnt lgkmcnt(3)
    v_smfmac_f32_16x16x64_bf16 v[28:31], v[44:47], v[56:63], v1
    ds_read_b128 v[56:59], v2 offset:34816
    v_smfmac_f32_16x16x64_bf16 v[16:19], v[44:47], a[96:103], v1
    ds_read_b128 v[60:63], v2 offset:35840
    s_waitcnt lgkmcnt(2)
    v_smfmac_f32_16x16x64_bf16 v[24:27], v[40:43], v[48:55], v1
    ds_read_b128 v[48:51], v2 offset:49152
    v_smfmac_f32_16x16x64_bf16 v[20:23], v[40:43], a[120:127], v1
    ds_read_b128 v[52:55], v2 offset:50176
    ds_read_b128 v[44:47], v0 offset:3072
    v_smfmac_f32_16x16x64_bf16 v[32:35], v[40:43], v[144:151], v1
    s_cmp_lg_u32 s25, 268435456
    s_cbranch_scc1 Lch_slow1_fp
    s_mov_b64 exec, 1
    buffer_store_dword v15, v0, s[8:11], s27 offen sc0 sc1
    s_mov_b64 exec, -1
Lch_slow1_fb:
    v_smfmac_f32_16x16x64_bf16 v[16:19], v[40:43], a[112:119], v1
    s_waitcnt lgkmcnt(3)
    v_smfmac_f32_16x16x64_bf16 v[28:31], v[40:43], v[56:63], v1
    s_waitcnt lgkmcnt(0)
    v_smfmac_f32_16x16x64_bf16 v[24:27], v[44:47], a[208:215], v1
    ds_read_b128 v[60:63], v2 offset:52224
    ds_read_b128 v[56:59], v2 offset:51200
    v_smfmac_f32_16x16x64_bf16 v[16:19], v[44:47], v[48:55], v1
    s_waitcnt vmcnt(3)
    s_barrier
    v_smfmac_f32_16x16x64_bf16 v[36:39], v[40:43], v[152:159], v1
    ds_read_b128 v[40:43], v0 offset:4096
    v_add_u32 v2, 0x10000, v2
    v_smfmac_f32_16x16x64_bf16 v[28:31], v[44:47], a[216:223], v1
    ds_read_b128 v[48:51], v0 offset:5120
    v_smfmac_f32_16x16x64_bf16 v[32:35], v[44:47], v[160:167], v1
    ds_read_b128 v[52:55], v0 offset:8192
    v_smfmac_f32_16x16x64_bf16 v[36:39], v[44:47], v[168:175], v1
    s_waitcnt lgkmcnt(3)
    v_smfmac_f32_16x16x64_bf16 v[20:23], v[44:47], v[56:63], v1
    ds_read_b128 v[60:63], v0 offset:7168
    s_waitcnt lgkmcnt(3)
    v_max3_u32 v14, v40, v41, v42
    v_smfmac_f32_16x16x64_bf16 v[20:23], v[40:43], a[136:143], v1
    ds_read_b128 v[56:59], v0 offset:6144
    v_max_u32 v14, v14, v43
    v_smfmac_f32_16x16x64_bf16 v[16:19], v[40:43], a[128:135], v1
    s_waitcnt lgkmcnt(3)
    v_max3_u32 v14, v48, v49, v14
    v_smfmac_f32_16x16x64_bf16 v[20:23], v[48:51], a[152:159], v1
    s_waitcnt lgkmcnt(2)
    v_max3_u32 v14, v14, v50, v51
    v_smfmac_f32_16x16x64_bf16 v[20:23], v[52:55], a[200:207], v1
    v_smfmac_f32_16x16x64_bf16 v[16:19], v[52:55], a[192:199], v1
    s_waitcnt lgkmcnt(0)
    v_max3_u32 v14, v52, v53, v14
    v_smfmac_f32_16x16x64_bf16 v[16:19], v[56:59], a[160:167], v1
    v_max3_u32 v14, v14, v54, v55
    v_smfmac_f32_16x16x64_bf16 v[20:23], v[56:59], a[168:175], v1
    v_max3_u32 v14, v56, v57, v14
    v_smfmac_f32_16x16x64_bf16 v[16:19], v[48:51], a[144:151], v1
    v_max3_u32 v14, v14, v58, v59
    v_smfmac_f32_16x16x64_bf16 v[16:19], v[60:63], a[176:183], v1
    v_max3_u32 v14, v60, v61, v14
    v_smfmac_f32_16x16x64_bf16 v[20:23], v[60:63], a[184:191], v1
    v_max3_u32 v14, v14, v62, v63
    v_smfmac_f32_16x16x64_bf16 v[28:31], v[40:43], a[232:239], v1
    v_cmp_eq_u32 vcc, -1, v14
    v_smfmac_f32_16x16x64_bf16 v[24:27], v[40:43], a[224:231], v1
    v_add_f32 v21, v21, v23
    v_smfmac_f32_16x16x64_bf16 v[24:27], v[48:51], a[240:247], v1
    s_cbranch_vccnz Lch_slow1_rect2
    v_add_f32 v16, v16, v18
    v_add_f32 v20, v20, v22
    v_add_f32 v17, v17, v19
    v_cvt_pk_bf16_f32 v14, v16, v17
    v_cvt_pk_bf16_f32 v15, v20, v21
    v_smfmac_f32_16x16x64_bf16 v[28:31], v[48:51], a[248:255], v1
    ds_write2_b32 v3, v14, v15 offset0:0 offset1:64
    v_smfmac_f32_16x16x64_bf16 v[24:27], v[56:59], v[64:71], v1
    v_smfmac_f32_16x16x64_bf16 v[28:31], v[56:59], v[72:79], v1
    ds_read_b128 v[56:59], v12 offset:9472
    ds_read_b128 v[48:51], v12 offset:9216
    v_smfmac_f32_16x16x64_bf16 v[24:27], v[60:63], v[80:87], v1
    v_smfmac_f32_16x16x64_bf16 v[24:27], v[52:55], v[96:103], v1
    v_smfmac_f32_16x16x64_bf16 v[28:31], v[60:63], v[88:95], v1
    s_waitcnt lgkmcnt(2)
    s_barrier
    ds_read_b64_tr_b16 v[16:17], v5 offset:25600
    v_smfmac_f32_16x16x64_bf16 v[28:31], v[52:55], v[104:111], v1
    ds_read_b64_tr_b16 v[18:19], v5 offset:25632
    v_add_f32 v24, v24, v26
    v_smfmac_f32_16x16x64_bf16 v[32:35], v[60:63], v[224:231], v1
    ds_read_b64_tr_b16 v[20:21], v5 offset:26112
    v_add_f32 v25, v25, v27
    v_smfmac_f32_16x16x64_bf16 v[36:39], v[60:63], v[232:239], v1
    ds_read_b128 v[60:63], v0 offset:4096
    v_add_f32 v29, v29, v31
    v_add_f32 v28, v28, v30
    v_cvt_pk_bf16_f32 v15, v28, v29
    v_smfmac_f32_16x16x64_bf16 v[32:35], v[52:55], v[240:247], v1
    ds_read_b64_tr_b16 v[22:23], v5 offset:26144
    v_cvt_pk_bf16_f32 v14, v24, v25
    v_smfmac_f32_16x16x64_bf16 v[36:39], v[52:55], v[248:255], v1
    ds_read_b128 v[24:27], v12 offset:11264
    s_waitcnt lgkmcnt(4)
    v_mfma_f32_16x16x32_bf16 v[48:51], v[48:51], v[16:19], 0
    ds_read_b128 v[28:31], v12 offset:11520
    ds_read_b128 v[52:55], v0 offset:5120
    v_mfma_f32_16x16x32_bf16 v[56:59], v[56:59], v[16:19], 0
    ds_read_b64_tr_b16 v[42:43], v5 offset:26656
    s_waitcnt lgkmcnt(5)
    v_smfmac_f32_16x16x64_bf16 v[32:35], v[60:63], v[176:183], v1
    ds_write_b64 v4, v[14:15]
    v_smfmac_f32_16x16x64_bf16 v[36:39], v[60:63], v[184:191], v1
    ds_read_b128 v[60:63], v0 offset:6144
    s_waitcnt lgkmcnt(5)
    v_mfma_f32_16x16x32_bf16 v[48:51], v[24:27], v[20:23], v[48:51]
    ds_read_b128 v[24:27], v12 offset:13312
    s_waitcnt lgkmcnt(5)
    v_mfma_f32_16x16x32_bf16 v[56:59], v[28:31], v[20:23], v[56:59]
    ds_read_b128 v[28:31], v12 offset:13568
    s_waitcnt lgkmcnt(5)
    v_smfmac_f32_16x16x64_bf16 v[32:35], v[52:55], v[192:199], v1
    ds_read_b64_tr_b16 v[46:47], v5 offset:27168
    v_smfmac_f32_16x16x64_bf16 v[36:39], v[52:55], v[200:207], v1
    ds_read_b64_tr_b16 v[40:41], v5 offset:26624
    ds_read_b64_tr_b16 v[44:45], v5 offset:27136
    s_waitcnt lgkmcnt(5)
    v_smfmac_f32_16x16x64_bf16 v[32:35], v[60:63], v[208:215], v1
    s_barrier
    ds_read_b128 v[52:55], v12 offset:15360
    v_smfmac_f32_16x16x64_bf16 v[36:39], v[60:63], v[216:223], v1
    ds_read_b128 v[60:63], v12 offset:15616
    s_waitcnt lgkmcnt(3)
    v_mfma_f32_16x16x32_bf16 v[48:51], v[24:27], v[40:43], v[48:51]
    ds_read_b64_tr_b16 v[26:27], v6 offset:27680
    ds_read_b64_tr_b16 v[24:25], v6 offset:27648
    v_add_f32 v32, v32, v34
    v_mfma_f32_16x16x32_bf16 v[56:59], v[28:31], v[40:43], v[56:59]
    ds_read_b64_tr_b16 v[30:31], v6 offset:28704
    ds_read_b64_tr_b16 v[28:29], v6 offset:28672
    v_add_f32 v37, v37, v39
    v_add_f32 v33, v33, v35
    v_add_f32 v36, v36, v38
    v_cvt_pk_bf16_f32 v38, v32, v33
    s_waitcnt lgkmcnt(5)
    v_mfma_f32_16x16x32_bf16 v[48:51], v[52:55], v[44:47], v[48:51]
    s_waitcnt lgkmcnt(4)
    v_mov_b64 v[52:53], 0
    v_mov_b64 v[54:55], 0
    v_mfma_f32_16x16x32_bf16 v[56:59], v[60:63], v[44:47], v[56:59]
    s_add_u32 s38, s45, 37748736
    ds_read_b128 v[60:63], v7 offset:17408
    s_waitcnt lgkmcnt(3)
    v_cvt_pk_bf16_f32 v39, v36, v37
    v_mov_b64 v[36:37], v[14:15]
    v_smfmac_f32_16x16x64_bf16 v[52:55], v[24:27], v[16:23], v1
    s_cmp_eq_u32 s30, 63
    s_cbranch_scc1 Lch_last
    s_waitcnt lgkmcnt(1)
    v_smfmac_f32_16x16x64_bf16 v[52:55], v[28:31], v[40:47], v1
    s_add_u32 m0, s47, 17408
    ds_read_b128 v[32:35], v7 offset:17664
    ds_read_b128 v[40:43], v2 offset:0
    v_max3_f32 v28, v48, v49, v50
    v_mov_b32 v25, 0x3f803f80
    v_max3_f32 v28, v28, v51, v56
    v_cndmask_b32 v51, v51, v59, s[40:41]
    v_mov_b32 v24, 0x3f803f80
    v_pk_add_f32 v[54:55], v[52:53], v[54:55]
    v_max3_f32 v29, v57, v58, v59
    v_max3_f32 v29, v29, v54, v55
    v_max_f32 v30, v28, v29
    v_cndmask_b32 v48, v48, v56, s[40:41]
    v_max_f32 v28, v28, v29
    v_cndmask_b32 v49, v49, v57, s[40:41]
    v_mov_b64 v[52:53], 0
    v_pk_mul_f32 v[48:49], v[48:49], s[44:45] op_sel_hi:[1,0]
    v_permlane16_swap_b32 v28, v30
    v_max_f32 v29, v28, v30
    v_cndmask_b32 v50, v50, v58, s[40:41]
    v_max_f32 v28, v28, v30
    v_pk_mul_f32 v[54:55], v[54:55], s[44:45] op_sel_hi:[1,0]
    v_mov_b32 v27, 0
    v_permlane32_swap_b32 v28, v29
    v_pk_mul_f32 v[50:51], v[50:51], s[44:45] op_sel_hi:[1,0]
    v_max_f32 v28, v28, v29
    v_mul_f32 v28, s44, v28
    v_pk_add_f32 v[48:49], v[48:49], v[28:29] op_sel_hi:[1,0] neg_lo:[0,1] neg_hi:[0,1]
    v_pk_add_f32 v[50:51], v[50:51], v[28:29] op_sel_hi:[1,0] neg_lo:[0,1] neg_hi:[0,1]
    v_exp_f32 v48, v48
    v_exp_f32 v50, v50
    v_exp_f32 v49, v49
    v_exp_f32 v51, v51
    v_cvt_pk_bf16_f32 v14, v48, v49
    v_cvt_pk_bf16_f32 v15, v50, v51
    v_pk_add_f32 v[54:55], v[54:55], v[28:29] op_sel_hi:[1,0] neg_lo:[0,1] neg_hi:[0,1]
    v_exp_f32 v54, v54
    v_exp_f32 v55, v55
    v_mov_b32_dpp v20, v14 row_shr:8 row_mask:0xf bank_mask:0xf bound_ctrl:0
    v_mov_b32_dpp v18, v14 row_shl:8 row_mask:0xf bank_mask:0xf bound_ctrl:0
    v_cvt_pk_bf16_f32 v54, v54, v55
    v_mfma_f32_16x16x16_bf16 v[28:31], v[24:25], v[14:15], 0
    v_mov_b32 v26, 0x3f803f80
    v_cndmask_b32 v17, v15, 0, s[40:41]
    v_mov_b32_dpp v19, v15 row_shl:8 row_mask:0xf bank_mask:0xf bound_ctrl:0
    v_cndmask_b32 v16, v14, 0, s[40:41]
    v_cndmask_b32 v55, 0, v54, s[40:41]
    s_waitcnt lgkmcnt(2)
    v_mfma_f32_16x16x32_bf16 v[48:51], v[60:63], v[16:19], 0
    v_cndmask_b32 v54, v54, 0, s[40:41]
    s_nop 1
    v_mfma_f32_16x16x16_bf16 v[28:31], v[26:27], v[54:55], v[28:31]
    ds_read_b128 v[44:47], v2 offset:1024
    v_mov_b32_dpp v21, v15 row_shr:8 row_mask:0xf bank_mask:0xf bound_ctrl:0
    v_cndmask_b32 v22, 0, v14, s[40:41]
    v_cndmask_b32 v23, 0, v15, s[40:41]
    v_mfma_f32_16x16x32_bf16 v[48:51], v[36:39], v[52:55], v[48:51]
    ds_read_b128 v[56:59], v2 offset:2048
    s_waitcnt lgkmcnt(3)
    v_mfma_f32_16x16x32_bf16 v[48:51], v[32:35], v[20:23], v[48:51]
    ds_read_b128 v[60:63], v2 offset:3072
    v_add_f32_dpp v16, v28, v28 row_ror:8 row_mask:0xf bank_mask:0xf
    v_mov_b64 v[54:55], 0
    v_and_b32 v32, 0xffffffdf, v0
    v_mov_b64 v[28:29], 0
    v_mov_b64 v[30:31], 0
    v_rcp_f32 v16, v16
    s_nop 0
    v_pk_mul_f32 v[48:49], v[48:49], v[16:17] op_sel_hi:[1,0]
    v_pk_mul_f32 v[50:51], v[50:51], v[16:17] op_sel_hi:[1,0]
    v_cvt_pk_bf16_f32 v14, v48, v49
    v_cvt_pk_bf16_f32 v15, v50, v51
    ds_write_b64 v11, v[14:15]
    buffer_load_dwordx4 v0, s[8:11], s38 offen offset:0 sc1 lds
    buffer_load_dwordx4 v0, s[8:11], s38 offen offset:1024 sc1 lds
    s_waitcnt lgkmcnt(0)
    s_barrier
    ds_read_b128 v[16:19], v32 offset:30720
    s_add_u32 s38, s45, 20971520
    ds_read_b128 v[20:23], v32 offset:29696
    v_mov_b64 v[50:51], 0
    v_mov_b64 v[48:49], 0
    s_add_u32 m0, s47, 9216
    s_nop 0
    buffer_load_dwordx4 v0, s[8:11], s38 offen offset:0 sc1 lds
    ds_read_b128 v[24:27], v32 offset:30752
    ds_read_b128 v[32:35], v32 offset:29728
    s_waitcnt lgkmcnt(3)
    v_smfmac_f32_16x16x64_bf16 v[28:31], v[16:19], a[0:7], v1
    buffer_load_dwordx4 v0, s[8:11], s38 offen offset:1024 sc1 lds
    s_waitcnt lgkmcnt(2)
    v_lshrrev_b32 v14, 2, v0
    v_smfmac_f32_16x16x64_bf16 v[28:31], v[20:23], v[40:47], v1
    ds_read_b128 v[44:47], v2 offset:17408
    ds_read_b128 v[40:43], v2 offset:16384
    s_waitcnt lgkmcnt(3)
    v_smfmac_f32_16x16x64_bf16 v[28:31], v[24:27], a[8:15], v1
    s_waitcnt lgkmcnt(2)
    v_smfmac_f32_16x16x64_bf16 v[28:31], v[32:35], v[56:63], v1
    ds_read_b128 v[56:59], v2 offset:18432
    ds_read_b128 v[60:63], v2 offset:19456
    v_smfmac_f32_16x16x64_bf16 v[52:55], v[16:19], a[16:23], v1
    s_nop 3
    v_cvt_pk_bf16_f32 v28, v28, v29
    s_waitcnt lgkmcnt(2)
    v_smfmac_f32_16x16x64_bf16 v[52:55], v[20:23], v[40:47], v1
    ds_read_b128 v[44:47], v2 offset:33792
    ds_read_b128 v[40:43], v2 offset:32768
    v_cvt_pk_bf16_f32 v30, v30, v31
    v_or_b32 v28, 1, v28
    v_or_b32 v30, 1, v30
    v_smfmac_f32_16x16x64_bf16 v[52:55], v[24:27], a[24:31], v1
    buffer_store_dword v28, v14, s[8:11], s34 offen offset:0 sc0 sc1
    buffer_store_dword v30, v14, s[8:11], s34 offen offset:1024 sc0 sc1
    s_waitcnt lgkmcnt(2)
    v_mov_b64 v[30:31], 0
    v_smfmac_f32_16x16x64_bf16 v[52:55], v[32:35], v[56:63], v1
    ds_read_b128 v[56:59], v2 offset:34816
    ds_read_b128 v[60:63], v2 offset:35840
    v_smfmac_f32_16x16x64_bf16 v[48:51], v[16:19], a[32:39], v1
    s_waitcnt lgkmcnt(2)
    v_mov_b64 v[28:29], 0
    v_smfmac_f32_16x16x64_bf16 v[48:51], v[20:23], v[40:47], v1
    ds_read_b128 v[44:47], v2 offset:50176
    ds_read_b128 v[40:43], v2 offset:49152
    v_cvt_pk_bf16_f32 v52, v52, v53
    v_or_b32 v52, 1, v52
    v_cvt_pk_bf16_f32 v54, v54, v55
    v_or_b32 v54, 1, v54
    v_smfmac_f32_16x16x64_bf16 v[48:51], v[24:27], a[40:47], v1
    buffer_store_dword v52, v14, s[8:11], s34 offen offset:2048 sc0 sc1
    buffer_store_dword v54, v14, s[8:11], s34 offen offset:3072 sc0 sc1
    s_waitcnt lgkmcnt(2)
    v_smfmac_f32_16x16x64_bf16 v[48:51], v[32:35], v[56:63], v1
    ds_read_b128 v[56:59], v2 offset:51200
    ds_read_b128 v[60:63], v2 offset:52224
    v_smfmac_f32_16x16x64_bf16 v[28:31], v[16:19], a[48:55], v1
    s_waitcnt lgkmcnt(2)
    v_mov_b64 v[54:55], 0
    v_smfmac_f32_16x16x64_bf16 v[28:31], v[20:23], v[40:47], v1
    ds_read_b128 v[40:43], v0 offset:29696
    ds_read_b128 v[44:47], v0 offset:30720
    v_cvt_pk_bf16_f32 v50, v50, v51
    v_mov_b64 v[52:53], 0
    v_cvt_pk_bf16_f32 v48, v48, v49
    v_or_b32 v48, 1, v48
    v_or_b32 v50, 1, v50
    v_smfmac_f32_16x16x64_bf16 v[28:31], v[24:27], a[56:63], v1
    buffer_store_dword v48, v14, s[8:11], s68 offen offset:0 sc0 sc1
    buffer_store_dword v50, v14, s[8:11], s68 offen offset:1024 sc0 sc1
    s_waitcnt lgkmcnt(2)
    v_smfmac_f32_16x16x64_bf16 v[28:31], v[32:35], v[56:63], v1
    ds_read_b128 v[56:59], v0 offset:31744
    s_waitcnt lgkmcnt(1)
    v_smfmac_f32_16x16x64_bf16 v[52:55], v[44:47], a[64:71], v1
    v_mov_b32 v15, -1
    v_smfmac_f32_16x16x64_bf16 v[52:55], v[40:43], a[72:79], v1
    s_add_u32 s18, s43, s32
    s_add_u32 s19, s43, s33
    v_cvt_pk_bf16_f32 v30, v30, v31
    v_or_b32 v30, 1, v30
    v_cvt_pk_bf16_f32 v28, v28, v29
    v_or_b32 v28, 1, v28
    buffer_store_dword v28, v14, s[8:11], s68 offen offset:2048 sc0 sc1
    buffer_store_dword v30, v14, s[8:11], s68 offen offset:3072 sc0 sc1
    v_add_f32 v53, v53, v55
    v_add_f32 v52, v52, v54
    s_add_u32 s35, s32, s47
    v_cvt_pk_bf16_f32 v52, v52, v53
    v_or_b32 v52, 1, v52
    buffer_store_dword v52, v14, s[8:11], s69 offen offset:0 sc0 sc1
    s_mov_b32 s46, s72
    s_mov_b32 s38, s33
    s_mov_b32 s33, s32
    s_mov_b32 s32, s31
    s_mov_b32 s31, s38
    s_add_u32 s30, s30, 1
    s_add_u32 s45, s45, 262144
    s_add_u32 s72, s72, 131072
    s_add_u32 s38, s33, s73
    s_add_u32 s38, s38, 4096
    s_add_u32 m0, s73, 4096
    s_lshr_b32 s36, s73, 2
    s_add_u32 s36, s36, 8192
    s_cmp_lg_u32 s29, 1
    s_cbranch_scc1 Lch_slow1_n1
    s_waitcnt vmcnt(0)
Lch_slow1_r0:
Lch_slow1_r:
    buffer_load_dwordx4 v[16:19], v8, s[8:11], s42 offen sc1
    buffer_load_dwordx4 v[20:23], v8, s[8:11], s12 offen sc1
    buffer_load_dwordx4 v[24:27], v8, s[8:11], s13 offen sc1
    buffer_load_dwordx4 v[28:31], v8, s[8:11], s14 offen sc1
    s_sub_u32 s39, s39, 1
    s_cbranch_scc1 Lch_bail
    s_waitcnt vmcnt(3)
    s_waitcnt lgkmcnt(0)
    v_mfma_f32_16x16x32_bf16 v[60:63], v[56:59], v[16:19], 0
    v_bitop3_b32 v32, v16, v16, v17 bitop3:0x80
    v_bitop3_b32 v32, v32, v18, v19 bitop3:0x80
    s_waitcnt vmcnt(2)
    v_mfma_f32_16x16x32_bf16 v[60:63], v[56:59], v[20:23], v[60:63]
    v_bitop3_b32 v32, v32, v20, v21 bitop3:0x80
    v_bitop3_b32 v32, v32, v22, v23 bitop3:0x80
    s_waitcnt vmcnt(1)
    v_mfma_f32_16x16x32_bf16 v[60:63], v[56:59], v[24:27], v[60:63]
    v_bitop3_b32 v32, v32, v24, v25 bitop3:0x80
    v_bitop3_b32 v32, v32, v26, v27 bitop3:0x80
    s_waitcnt vmcnt(0)
    v_mfma_f32_16x16x32_bf16 v[60:63], v[56:59], v[28:31], v[60:63]
    v_bitop3_b32 v32, v32, v28, v29 bitop3:0x80
    v_bitop3_b32 v32, v32, v30, v31 bitop3:0x80
    v_and_b32 v32, 1, v32
    v_cmp_ne_u32 vcc, 1, v32
    s_nop 3
    v_add_f32_dpp v60, v60, v60 row_ror:8 row_mask:0xf bank_mask:0xf
    v_add_f32_dpp v61, v61, v61 row_ror:8 row_mask:0xf bank_mask:0xf
    v_cvt_pk_bf16_f32 v60, v60, v61
    v_min_u32 v60, -2, v60
    s_cbranch_vccnz Lch_slow1_r
    s_mov_b64 exec, s[22:23]
    buffer_store_dword v60, v9, s[8:11], s18 offen sc0 sc1
    buffer_store_dword v15, v9, s[8:11], s19 offen sc0 sc1
    s_mov_b64 exec, -1
Lch_slow1_j:
    s_waitcnt lgkmcnt(0)
    s_add_u32 s37, s36, s33
    s_add_u32 s71, s45, 21233664
    v_add_u32 v2, s3, v0
    ds_read_b128 v[48:51], v2 offset:0
    s_cmp_ge_u32 s29, 2
    s_cbranch_scc1 Lch_slow1_w2
    s_nop 15
    s_nop 15
    s_nop 15
    s_nop 15
    buffer_load_dwordx4 v[44:47], v0, s[8:11], s35 offen sc1
    buffer_load_dwordx4 v[60:63], v0, s[8:11], s35 offen offset:1024 sc1
    ds_read_b128 v[52:55], v2 offset:1024
    ds_read_b128 v[56:59], v2 offset:2048
    v_mov_b64 v[24:25], 0
    v_mov_b64 v[26:27], 0
    v_mov_b64 v[28:29], 0
    v_mov_b64 v[30:31], 0
    v_mov_b64 v[32:33], 0
    v_mov_b64 v[34:35], 0
    v_mov_b64 v[16:17], 0
    v_mov_b64 v[18:19], 0
    v_mov_b64 v[20:21], 0
    v_mov_b64 v[22:23], 0
    v_lshrrev_b32 v14, 2, v0
    s_max_i32 s16, s30, 1
    s_sub_u32 s16, s16, 1
    v_mov_b32 v15, s16
    v_add_u32 v40, s47, v0
    s_nop 15
    s_nop 15
    buffer_load_dwordx4 v[44:47], v0, s[8:11], s35 offen sc1
    buffer_load_dwordx4 v[60:63], v0, s[8:11], s35 offen offset:1024 sc1
Lch_slow1_gl:
    s_waitcnt vmcnt(3)
    v_max3_u32 v10, v44, v45, v46
    v_max_u32 v10, v10, v47
    ds_write_b128 v40, v[44:47] offset:0
    s_waitcnt vmcnt(2)
    v_max3_u32 v10, v10, v60, v61
    v_max3_u32 v10, v10, v62, v63
    v_cmp_eq_u32 vcc, -1, v10
    ds_write_b128 v40, v[60:63] offset:1024
    s_cbranch_vccnz Lch_slow1_gr
Lch_slow1_b:
    s_waitcnt lgkmcnt(0)
    s_barrier
    s_branch Lch_slow_loop
.p2align 6
Lch_slow0_n1:
    s_cmp_lt_u32 s70, 1
    s_cbranch_scc1 Lch_slow0_nu
    s_waitcnt vmcnt(0)
    s_branch Lch_slow0_r0
.p2align 6
Lch_slow0_nu:
    s_cmp_eq_u32 s25, 268435456
    s_cbranch_scc1 Lch_slow0_nu2
    s_add_u32 s48, s30, 2
    s_cmp_lt_u32 s48, s26
    s_cbranch_scc1 Lch_slow0_nu2
    s_min_u32 s48, s48, 63
Lch_slow0_kv:
    s_waitcnt lgkmcnt(0)
    s_add_u32 s16, s24, 0
    s_load_dword s16, s[8:9], s16 glc
    s_add_u32 s17, s24, 384
    s_load_dword s17, s[8:9], s17 glc
    s_add_u32 s18, s24, 128
    s_load_dword s18, s[8:9], s18 glc
    s_add_u32 s19, s24, 512
    s_load_dword s19, s[8:9], s19 glc
    s_add_u32 s20, s24, 256
    s_load_dword s20, s[8:9], s20 glc
    s_add_u32 s21, s24, 640
    s_load_dword s21, s[8:9], s21 glc
    s_sub_u32 s39, s39, 1
    s_cbranch_scc1 Lch_bail
    s_waitcnt lgkmcnt(0)
    s_min_u32 s16, s16, s17
    s_mul_i32 s16, s16, 3
    s_add_u32 s16, s16, 0
    s_min_u32 s18, s18, s19
    s_mul_i32 s18, s18, 3
    s_add_u32 s18, s18, 1
    s_min_u32 s20, s20, s21
    s_mul_i32 s20, s20, 3
    s_add_u32 s20, s20, 2
    s_min_u32 s16, s16, s18
    s_min_u32 s16, s16, s20
    s_max_u32 s26, s26, s16
    s_cmp_ge_u32 s26, 64
    s_cselect_b32 s25, 268435456, s25
    s_cmp_ge_u32 s48, s26
    s_cbranch_scc1 Lch_slow0_kv
Lch_slow0_nu2:
    s_waitcnt vmcnt(0)
    s_nop 15
    s_nop 15
    s_nop 15
    s_nop 15
    s_branch Lch_slow0_j
.p2align 6
Lch_slow0_w2:
    ds_read_b128 v[52:55], v2 offset:1024
    ds_read_b128 v[56:59], v2 offset:2048
    v_mov_b64 v[24:25], 0
    v_mov_b64 v[26:27], 0
    v_mov_b64 v[28:29], 0
    v_mov_b64 v[30:31], 0
    v_mov_b64 v[32:33], 0
    v_mov_b64 v[34:35], 0
    v_mov_b64 v[16:17], 0
    v_mov_b64 v[18:19], 0
    v_mov_b64 v[20:21], 0
    v_mov_b64 v[22:23], 0
    v_lshrrev_b32 v14, 2, v0
    s_max_i32 s16, s30, 1
    s_sub_u32 s16, s16, 1
    v_mov_b32 v15, s16
    v_add_u32 v40, s47, v0
    s_branch Lch_slow0_b
.p2align 6
Lch_slow0_gr:
    buffer_load_dwordx4 v[44:47], v0, s[8:11], s35 offen sc1
    buffer_load_dwordx4 v[60:63], v0, s[8:11], s35 offen offset:1024 sc1
    s_sub_u32 s39, s39, 1
    s_cbranch_scc0 Lch_slow0_gl
    s_branch Lch_bail
Lch_slow0_rect2:
Lch_slow0_rect1:
Lch_slow0_rec:
    s_nop 15
    s_nop 3
    s_waitcnt vmcnt(0) lgkmcnt(0)
Lch_slow0_rec2:
    s_barrier
    s_add_u32 s35, s33, s73
    s_add_u32 s36, s35, 4096
    s_add_u32 s37, s33, 8192
    s_mov_b32 s46, 268435456
    s_add_u32 m0, s73, 0
    s_nop 0
    buffer_load_dwordx4 v0, s[8:11], s35 offen sc1 lds
    s_add_u32 m0, s73, 4096
    s_nop 0
    buffer_load_dwordx4 v0, s[8:11], s36 offen sc1 lds
    s_mov_b32 m0, 8192
    s_nop 0
    buffer_load_dwordx4 v0, s[8:11], s37 offen sc1 lds
Lch_slow0_rec3:
    s_waitcnt vmcnt(0) lgkmcnt(0)
    s_barrier
    ds_read_b128 v[24:27], v0 offset:0
    ds_read_b128 v[28:31], v0 offset:1024
    ds_read_b128 v[32:35], v0 offset:2048
    ds_read_b128 v[36:39], v0 offset:3072
    ds_read_b128 v[40:43], v0 offset:4096
    ds_read_b128 v[44:47], v0 offset:5120
    ds_read_b128 v[48:51], v0 offset:6144
    ds_read_b128 v[52:55], v0 offset:7168
    ds_read_b128 v[56:59], v0 offset:8192
    v_mov_b32 v14, 0
    s_waitcnt lgkmcnt(8)
    v_max3_u32 v14, v14, v24, v25
    v_max3_u32 v14, v14, v26, v27
    s_waitcnt lgkmcnt(7)
    v_max3_u32 v14, v14, v28, v29
    v_max3_u32 v14, v14, v30, v31
    s_waitcnt lgkmcnt(6)
    v_max3_u32 v14, v14, v32, v33
    v_max3_u32 v14, v14, v34, v35
    s_waitcnt lgkmcnt(5)
    v_max3_u32 v14, v14, v36, v37
    v_max3_u32 v14, v14, v38, v39
    s_waitcnt lgkmcnt(4)
    v_max3_u32 v14, v14, v40, v41
    v_max3_u32 v14, v14, v42, v43
    s_waitcnt lgkmcnt(3)
    v_max3_u32 v14, v14, v44, v45
    v_max3_u32 v14, v14, v46, v47
    s_waitcnt lgkmcnt(2)
    v_max3_u32 v14, v14, v48, v49
    v_max3_u32 v14, v14, v50, v51
    s_waitcnt lgkmcnt(1)
    v_max3_u32 v14, v14, v52, v53
    v_max3_u32 v14, v14, v54, v55
    s_waitcnt lgkmcnt(0)
    v_max3_u32 v14, v14, v56, v57
    v_max3_u32 v14, v14, v58, v59
    v_cmp_eq_u32 vcc, -1, v14
    s_sub_u32 s39, s39, 1
    s_cbranch_scc1 Lch_bail
    s_cbranch_vccnz Lch_slow0_rec2
    v_add_u32 v2, s3, v0
    ds_read_b128 v[48:51], v2 offset:0
    ds_read_b128 v[52:55], v2 offset:1024
    ds_read_b128 v[56:59], v2 offset:2048
    v_mov_b64 v[24:25], 0
    v_mov_b64 v[26:27], 0
    v_mov_b64 v[28:29], 0
    v_mov_b64 v[30:31], 0
    v_mov_b64 v[32:33], 0
    v_mov_b64 v[34:35], 0
    v_mov_b64 v[16:17], 0
    v_mov_b64 v[18:19], 0
    v_mov_b64 v[20:21], 0
    v_mov_b64 v[22:23], 0
    s_add_u32 s38, s33, s73
    s_add_u32 s38, s38, 4096
    s_add_u32 m0, s73, 4096
    s_lshr_b32 s36, s73, 2
    s_add_u32 s36, s36, 8192
    s_add_u32 s37, s36, s33
    s_add_u32 s71, s45, 21233664
    v_lshrrev_b32 v14, 2, v0
    s_max_i32 s16, s30, 1
    s_sub_u32 s16, s16, 1
    v_mov_b32 v15, s16
    s_waitcnt lgkmcnt(0)
    s_barrier
    s_branch Lch_slow0_start
Lch_slow1_fp:
    s_mov_b64 exec, 0x555
    buffer_load_dword v10, v13, s[8:11], s25 offen sc1
    s_mov_b64 exec, -1
    s_branch Lch_slow1_fb
.p2align 6
Lch_slow1_n1:
    s_cmp_lt_u32 s70, 1
    s_cbranch_scc1 Lch_slow1_nu
    s_waitcnt vmcnt(0)
    s_branch Lch_slow1_r0
.p2align 6
Lch_slow1_nu:
    s_cmp_eq_u32 s25, 268435456
    s_cbranch_scc1 Lch_slow1_nu2
    s_waitcnt vmcnt(9)
    v_readlane_b32 s16, v10, 0
    v_readlane_b32 s17, v10, 6
    v_readlane_b32 s18, v10, 2
    v_readlane_b32 s19, v10, 8
    v_readlane_b32 s20, v10, 4
    v_readlane_b32 s21, v10, 10
    s_min_u32 s16, s16, s17
    s_mul_i32 s16, s16, 3
    s_add_u32 s16, s16, 0
    s_min_u32 s18, s18, s19
    s_mul_i32 s18, s18, 3
    s_add_u32 s18, s18, 1
    s_min_u32 s20, s20, s21
    s_mul_i32 s20, s20, 3
    s_add_u32 s20, s20, 2
    s_min_u32 s16, s16, s18
    s_min_u32 s16, s16, s20
    s_max_u32 s26, s26, s16
    s_cmp_ge_u32 s26, 64
    s_cselect_b32 s25, 268435456, s25
    s_add_u32 s48, s30, 2
    s_cmp_lt_u32 s48, s26
    s_cbranch_scc1 Lch_slow1_nu2
    s_min_u32 s48, s48, 63
Lch_slow1_kv:
    s_waitcnt lgkmcnt(0)
    s_add_u32 s16, s24, 0
    s_load_dword s16, s[8:9], s16 glc
    s_add_u32 s17, s24, 384
    s_load_dword s17, s[8:9], s17 glc
    s_add_u32 s18, s24, 128
    s_load_dword s18, s[8:9], s18 glc
    s_add_u32 s19, s24, 512
    s_load_dword s19, s[8:9], s19 glc
    s_add_u32 s20, s24, 256
    s_load_dword s20, s[8:9], s20 glc
    s_add_u32 s21, s24, 640
    s_load_dword s21, s[8:9], s21 glc
    s_sub_u32 s39, s39, 1
    s_cbranch_scc1 Lch_bail
    s_waitcnt lgkmcnt(0)
    s_min_u32 s16, s16, s17
    s_mul_i32 s16, s16, 3
    s_add_u32 s16, s16, 0
    s_min_u32 s18, s18, s19
    s_mul_i32 s18, s18, 3
    s_add_u32 s18, s18, 1
    s_min_u32 s20, s20, s21
    s_mul_i32 s20, s20, 3
    s_add_u32 s20, s20, 2
    s_min_u32 s16, s16, s18
    s_min_u32 s16, s16, s20
    s_max_u32 s26, s26, s16
    s_cmp_ge_u32 s26, 64
    s_cselect_b32 s25, 268435456, s25
    s_cmp_ge_u32 s48, s26
    s_cbranch_scc1 Lch_slow1_kv
Lch_slow1_nu2:
    s_waitcnt vmcnt(0)
    s_nop 15
    s_nop 15
    s_nop 15
    s_nop 15
    s_branch Lch_slow1_j
.p2align 6
Lch_slow1_w2:
    ds_read_b128 v[52:55], v2 offset:1024
    ds_read_b128 v[56:59], v2 offset:2048
    v_mov_b64 v[24:25], 0
    v_mov_b64 v[26:27], 0
    v_mov_b64 v[28:29], 0
    v_mov_b64 v[30:31], 0
    v_mov_b64 v[32:33], 0
    v_mov_b64 v[34:35], 0
    v_mov_b64 v[16:17], 0
    v_mov_b64 v[18:19], 0
    v_mov_b64 v[20:21], 0
    v_mov_b64 v[22:23], 0
    v_lshrrev_b32 v14, 2, v0
    s_max_i32 s16, s30, 1
    s_sub_u32 s16, s16, 1
    v_mov_b32 v15, s16
    v_add_u32 v40, s47, v0
    s_branch Lch_slow1_b
.p2align 6
Lch_slow1_gr:
    buffer_load_dwordx4 v[44:47], v0, s[8:11], s35 offen sc1
    buffer_load_dwordx4 v[60:63], v0, s[8:11], s35 offen offset:1024 sc1
    s_sub_u32 s39, s39, 1
    s_cbranch_scc0 Lch_slow1_gl
    s_branch Lch_bail
Lch_slow1_rect2:
Lch_slow1_rect1:
Lch_slow1_rec:
    s_nop 15
    s_nop 3
    s_waitcnt vmcnt(0) lgkmcnt(0)
Lch_slow1_rec2:
    s_barrier
    s_add_u32 s35, s33, s73
    s_add_u32 s36, s35, 4096
    s_add_u32 s37, s33, 8192
    s_mov_b32 s46, 268435456
    s_add_u32 m0, s73, 0
    s_nop 0
    buffer_load_dwordx4 v0, s[8:11], s35 offen sc1 lds
    s_add_u32 m0, s73, 4096
    s_nop 0
    buffer_load_dwordx4 v0, s[8:11], s36 offen sc1 lds
    s_mov_b32 m0, 8192
    s_nop 0
    buffer_load_dwordx4 v0, s[8:11], s37 offen sc1 lds
Lch_slow1_rec3:
    s_waitcnt vmcnt(0) lgkmcnt(0)
    s_barrier
    ds_read_b128 v[24:27], v0 offset:0
    ds_read_b128 v[28:31], v0 offset:1024
    ds_read_b128 v[32:35], v0 offset:2048
    ds_read_b128 v[36:39], v0 offset:3072
    ds_read_b128 v[40:43], v0 offset:4096
    ds_read_b128 v[44:47], v0 offset:5120
    ds_read_b128 v[48:51], v0 offset:6144
    ds_read_b128 v[52:55], v0 offset:7168
    ds_read_b128 v[56:59], v0 offset:8192
    v_mov_b32 v14, 0
    s_waitcnt lgkmcnt(8)
    v_max3_u32 v14, v14, v24, v25
    v_max3_u32 v14, v14, v26, v27
    s_waitcnt lgkmcnt(7)
    v_max3_u32 v14, v14, v28, v29
    v_max3_u32 v14, v14, v30, v31
    s_waitcnt lgkmcnt(6)
    v_max3_u32 v14, v14, v32, v33
    v_max3_u32 v14, v14, v34, v35
    s_waitcnt lgkmcnt(5)
    v_max3_u32 v14, v14, v36, v37
    v_max3_u32 v14, v14, v38, v39
    s_waitcnt lgkmcnt(4)
    v_max3_u32 v14, v14, v40, v41
    v_max3_u32 v14, v14, v42, v43
    s_waitcnt lgkmcnt(3)
    v_max3_u32 v14, v14, v44, v45
    v_max3_u32 v14, v14, v46, v47
    s_waitcnt lgkmcnt(2)
    v_max3_u32 v14, v14, v48, v49
    v_max3_u32 v14, v14, v50, v51
    s_waitcnt lgkmcnt(1)
    v_max3_u32 v14, v14, v52, v53
    v_max3_u32 v14, v14, v54, v55
    s_waitcnt lgkmcnt(0)
    v_max3_u32 v14, v14, v56, v57
    v_max3_u32 v14, v14, v58, v59
    v_cmp_eq_u32 vcc, -1, v14
    s_sub_u32 s39, s39, 1
    s_cbranch_scc1 Lch_bail
    s_cbranch_vccnz Lch_slow1_rec2
    v_add_u32 v2, s3, v0
    ds_read_b128 v[48:51], v2 offset:0
    ds_read_b128 v[52:55], v2 offset:1024
    ds_read_b128 v[56:59], v2 offset:2048
    v_mov_b64 v[24:25], 0
    v_mov_b64 v[26:27], 0
    v_mov_b64 v[28:29], 0
    v_mov_b64 v[30:31], 0
    v_mov_b64 v[32:33], 0
    v_mov_b64 v[34:35], 0
    v_mov_b64 v[16:17], 0
    v_mov_b64 v[18:19], 0
    v_mov_b64 v[20:21], 0
    v_mov_b64 v[22:23], 0
    s_add_u32 s38, s33, s73
    s_add_u32 s38, s38, 4096
    s_add_u32 m0, s73, 4096
    s_lshr_b32 s36, s73, 2
    s_add_u32 s36, s36, 8192
    s_add_u32 s37, s36, s33
    s_add_u32 s71, s45, 21233664
    v_lshrrev_b32 v14, 2, v0
    s_max_i32 s16, s30, 1
    s_sub_u32 s16, s16, 1
    v_mov_b32 v15, s16
    s_waitcnt lgkmcnt(0)
    s_barrier
    s_branch Lch_slow1_start
Lch_last:
    buffer_store_dwordx4 v[36:39], v0, s[8:11], s72 offen sc1
    s_waitcnt vmcnt(1)
    s_barrier
    v_mov_b32 v15, 63
    s_mov_b64 exec, 1
    buffer_store_dword v15, v0, s[8:11], s27 offen sc0 sc1
    s_mov_b64 exec, -1
    s_waitcnt vmcnt(1)
    s_barrier
    v_mov_b32 v14, 64
    s_mov_b64 exec, 1
    buffer_store_dword v14, v0, s[8:11], s27 offen sc0 sc1
    s_mov_b64 exec, -1
Lch_done:
Lch_bail:
    s_endpgm
Lexit0:
    s_endpgm
Lworker2:
Lworker:
    s_mov_b32 s28, s97
    v_lshrrev_b32 v1, 6, v0
    s_nop 0
    v_readfirstlane_b32 s29, v1
    v_and_b32 v1, 63, v0
    v_lshlrev_b32 v0, 4, v1
    s_mov_b32 s39, 0x20000
    s_cmp_lg_u32 s28, 197
    s_cbranch_scc1 Lnoinit
    v_mov_b32 v4, 0
    v_mov_b32 v5, 0
    v_mov_b32 v6, 0
    v_mov_b32 v7, 0
    s_mul_i32 s35, s29, 20480
    s_add_u32 s35, s35, 102760448
    buffer_store_dwordx4 v[4:7], v0, s[8:11], s35 offen offset:0 sc0 sc1
    buffer_store_dwordx4 v[4:7], v0, s[8:11], s35 offen offset:1024 sc0 sc1
    buffer_store_dwordx4 v[4:7], v0, s[8:11], s35 offen offset:2048 sc0 sc1
    buffer_store_dwordx4 v[4:7], v0, s[8:11], s35 offen offset:3072 sc0 sc1
    s_add_u32 s35, s35, 4096
    buffer_store_dwordx4 v[4:7], v0, s[8:11], s35 offen offset:0 sc0 sc1
    buffer_store_dwordx4 v[4:7], v0, s[8:11], s35 offen offset:1024 sc0 sc1
    buffer_store_dwordx4 v[4:7], v0, s[8:11], s35 offen offset:2048 sc0 sc1
    buffer_store_dwordx4 v[4:7], v0, s[8:11], s35 offen offset:3072 sc0 sc1
    s_add_u32 s35, s35, 4096
    buffer_store_dwordx4 v[4:7], v0, s[8:11], s35 offen offset:0 sc0 sc1
    buffer_store_dwordx4 v[4:7], v0, s[8:11], s35 offen offset:1024 sc0 sc1
    buffer_store_dwordx4 v[4:7], v0, s[8:11], s35 offen offset:2048 sc0 sc1
    buffer_store_dwordx4 v[4:7], v0, s[8:11], s35 offen offset:3072 sc0 sc1
    s_add_u32 s35, s35, 4096
    buffer_store_dwordx4 v[4:7], v0, s[8:11], s35 offen offset:0 sc0 sc1
    buffer_store_dwordx4 v[4:7], v0, s[8:11], s35 offen offset:1024 sc0 sc1
    buffer_store_dwordx4 v[4:7], v0, s[8:11], s35 offen offset:2048 sc0 sc1
    buffer_store_dwordx4 v[4:7], v0, s[8:11], s35 offen offset:3072 sc0 sc1
    s_add_u32 s35, s35, 4096
    buffer_store_dwordx4 v[4:7], v0, s[8:11], s35 offen offset:0 sc0 sc1
    buffer_store_dwordx4 v[4:7], v0, s[8:11], s35 offen offset:1024 sc0 sc1
    buffer_store_dwordx4 v[4:7], v0, s[8:11], s35 offen offset:2048 sc0 sc1
    buffer_store_dwordx4 v[4:7], v0, s[8:11], s35 offen offset:3072 sc0 sc1
    s_waitcnt vmcnt(0)
    s_barrier
    v_mov_b32 v5, 1
    global_store_dword v4, v5, s[6:7] offset:132 sc0 sc1
Lnoinit:
    s_sub_u32 s30, 188, s28
    s_cmp_ge_u32 s30, 64
    s_cbranch_scc1 Lnoln
    s_load_dwordx2 s[12:13], s[0:1], 0
    s_mov_b32 s14, 2359296
    s_mov_b32 s15, 0x20000
    s_waitcnt lgkmcnt(0)
    v_and_b32 v4, 31, v1
    v_mul_u32_u24 v2, 1152, v4
    v_lshrrev_b32 v5, 5, v1
    v_lshl_add_u32 v2, v5, 4, v2
    s_mul_i32 s35, s29, 288
    v_add_u32 v2, s35, v2
    v_lshlrev_b32 v3, 2, v1
    s_lshl_b32 s35, s29, 8
    v_add_u32 v6, s35, v3
    v_lshlrev_b32 v7, 2, v4
    s_mul_i32 s35, s30, 36864
    buffer_load_dwordx4 v[16:19], v2, s[12:15], s35 offen offset:0
    buffer_load_dwordx4 v[20:23], v2, s[12:15], s35 offen offset:32
    buffer_load_dwordx4 v[24:27], v2, s[12:15], s35 offen offset:64
    buffer_load_dwordx4 v[28:31], v2, s[12:15], s35 offen offset:96
    buffer_load_dwordx4 v[32:35], v2, s[12:15], s35 offen offset:128
    buffer_load_dwordx4 v[36:39], v2, s[12:15], s35 offen offset:160
    buffer_load_dwordx4 v[40:43], v2, s[12:15], s35 offen offset:192
    buffer_load_dwordx4 v[44:47], v2, s[12:15], s35 offen offset:224
    buffer_load_dwordx4 v[48:51], v2, s[12:15], s35 offen offset:256
    v_add_u32 v52, 1024, v7
    s_waitcnt vmcnt(8)
    v_lshlrev_b32 v64, 16, v16
    v_and_b32 v65, 0xffff0000, v16
    v_lshlrev_b32 v66, 16, v17
    v_and_b32 v67, 0xffff0000, v17
    v_lshlrev_b32 v68, 16, v18
    v_and_b32 v69, 0xffff0000, v18
    v_lshlrev_b32 v70, 16, v19
    v_and_b32 v71, 0xffff0000, v19
    s_waitcnt vmcnt(7)
    v_lshlrev_b32 v72, 16, v20
    v_and_b32 v73, 0xffff0000, v20
    v_lshlrev_b32 v74, 16, v21
    v_and_b32 v75, 0xffff0000, v21
    v_lshlrev_b32 v76, 16, v22
    v_and_b32 v77, 0xffff0000, v22
    v_lshlrev_b32 v78, 16, v23
    v_and_b32 v79, 0xffff0000, v23
    s_waitcnt vmcnt(6)
    v_lshlrev_b32 v80, 16, v24
    v_and_b32 v81, 0xffff0000, v24
    v_lshlrev_b32 v82, 16, v25
    v_and_b32 v83, 0xffff0000, v25
    v_lshlrev_b32 v84, 16, v26
    v_and_b32 v85, 0xffff0000, v26
    v_lshlrev_b32 v86, 16, v27
    v_and_b32 v87, 0xffff0000, v27
    s_waitcnt vmcnt(5)
    v_lshlrev_b32 v88, 16, v28
    v_and_b32 v89, 0xffff0000, v28
    v_lshlrev_b32 v90, 16, v29
    v_and_b32 v91, 0xffff0000, v29
    v_lshlrev_b32 v92, 16, v30
    v_and_b32 v93, 0xffff0000, v30
    v_lshlrev_b32 v94, 16, v31
    v_and_b32 v95, 0xffff0000, v31
    s_waitcnt vmcnt(4)
    v_lshlrev_b32 v96, 16, v32
    v_and_b32 v97, 0xffff0000, v32
    v_lshlrev_b32 v98, 16, v33
    v_and_b32 v99, 0xffff0000, v33
    v_lshlrev_b32 v100, 16, v34
    v_and_b32 v101, 0xffff0000, v34
    v_lshlrev_b32 v102, 16, v35
    v_and_b32 v103, 0xffff0000, v35
    s_waitcnt vmcnt(3)
    v_lshlrev_b32 v104, 16, v36
    v_and_b32 v105, 0xffff0000, v36
    v_lshlrev_b32 v106, 16, v37
    v_and_b32 v107, 0xffff0000, v37
    v_lshlrev_b32 v108, 16, v38
    v_and_b32 v109, 0xffff0000, v38
    v_lshlrev_b32 v110, 16, v39
    v_and_b32 v111, 0xffff0000, v39
    s_waitcnt vmcnt(2)
    v_lshlrev_b32 v112, 16, v40
    v_and_b32 v113, 0xffff0000, v40
    v_lshlrev_b32 v114, 16, v41
    v_and_b32 v115, 0xffff0000, v41
    v_lshlrev_b32 v116, 16, v42
    v_and_b32 v117, 0xffff0000, v42
    v_lshlrev_b32 v118, 16, v43
    v_and_b32 v119, 0xffff0000, v43
    s_waitcnt vmcnt(1)
    v_lshlrev_b32 v120, 16, v44
    v_and_b32 v121, 0xffff0000, v44
    v_lshlrev_b32 v122, 16, v45
    v_and_b32 v123, 0xffff0000, v45
    v_lshlrev_b32 v124, 16, v46
    v_and_b32 v125, 0xffff0000, v46
    v_lshlrev_b32 v126, 16, v47
    v_and_b32 v127, 0xffff0000, v47
    s_waitcnt vmcnt(0)
    v_lshlrev_b32 v128, 16, v48
    v_and_b32 v129, 0xffff0000, v48
    v_lshlrev_b32 v130, 16, v49
    v_and_b32 v131, 0xffff0000, v49
    v_lshlrev_b32 v132, 16, v50
    v_and_b32 v133, 0xffff0000, v50
    v_lshlrev_b32 v134, 16, v51
    v_and_b32 v135, 0xffff0000, v51
    v_add_f32 v56, v64, v68
    v_add_f32 v57, v65, v69
    v_add_f32 v58, v66, v70
    v_add_f32 v59, v67, v71
    v_add_f32 v56, v56, v72
    v_add_f32 v57, v57, v73
    v_add_f32 v58, v58, v74
    v_add_f32 v59, v59, v75
    v_add_f32 v56, v56, v76
    v_add_f32 v57, v57, v77
    v_add_f32 v58, v58, v78
    v_add_f32 v59, v59, v79
    v_add_f32 v56, v56, v80
    v_add_f32 v57, v57, v81
    v_add_f32 v58, v58, v82
    v_add_f32 v59, v59, v83
    v_add_f32 v56, v56, v84
    v_add_f32 v57, v57, v85
    v_add_f32 v58, v58, v86
    v_add_f32 v59, v59, v87
    v_add_f32 v56, v56, v88
    v_add_f32 v57, v57, v89
    v_add_f32 v58, v58, v90
    v_add_f32 v59, v59, v91
    v_add_f32 v56, v56, v92
    v_add_f32 v57, v57, v93
    v_add_f32 v58, v58, v94
    v_add_f32 v59, v59, v95
    v_add_f32 v56, v56, v96
    v_add_f32 v57, v57, v97
    v_add_f32 v58, v58, v98
    v_add_f32 v59, v59, v99
    v_add_f32 v56, v56, v100
    v_add_f32 v57, v57, v101
    v_add_f32 v58, v58, v102
    v_add_f32 v59, v59, v103
    v_add_f32 v56, v56, v104
    v_add_f32 v57, v57, v105
    v_add_f32 v58, v58, v106
    v_add_f32 v59, v59, v107
    v_add_f32 v56, v56, v108
    v_add_f32 v57, v57, v109
    v_add_f32 v58, v58, v110
    v_add_f32 v59, v59, v111
    v_add_f32 v56, v56, v112
    v_add_f32 v57, v57, v113
    v_add_f32 v58, v58, v114
    v_add_f32 v59, v59, v115
    v_add_f32 v56, v56, v116
    v_add_f32 v57, v57, v117
    v_add_f32 v58, v58, v118
    v_add_f32 v59, v59, v119
    v_add_f32 v56, v56, v120
    v_add_f32 v57, v57, v121
    v_add_f32 v58, v58, v122
    v_add_f32 v59, v59, v123
    v_add_f32 v56, v56, v124
    v_add_f32 v57, v57, v125
    v_add_f32 v58, v58, v126
    v_add_f32 v59, v59, v127
    v_add_f32 v56, v56, v128
    v_add_f32 v57, v57, v129
    v_add_f32 v58, v58, v130
    v_add_f32 v59, v59, v131
    v_add_f32 v56, v56, v132
    v_add_f32 v57, v57, v133
    v_add_f32 v58, v58, v134
    v_add_f32 v59, v59, v135
    v_add_f32 v56, v56, v57
    v_add_f32 v58, v58, v59
    v_add_f32 v56, v56, v58
    ds_write_b32 v6, v56 offset:0
    s_waitcnt lgkmcnt(0)
    s_barrier
    ds_read2_b32 v[8:9], v7 offset0:0 offset1:32
    ds_read2_b32 v[10:11], v7 offset0:64 offset1:96
    ds_read2_b32 v[12:13], v7 offset0:128 offset1:160
    ds_read2_b32 v[14:15], v7 offset0:192 offset1:224
    s_waitcnt lgkmcnt(3)
    v_add_f32 v8, v8, v9
    s_waitcnt lgkmcnt(2)
    v_add_f32 v10, v10, v11
    s_waitcnt lgkmcnt(1)
    v_add_f32 v12, v12, v13
    s_waitcnt lgkmcnt(0)
    v_add_f32 v14, v14, v15
    v_add_f32 v8, v8, v10
    v_add_f32 v12, v12, v14
    v_add_f32 v53, v8, v12
    v_mul_f32 v53, 0x3ae38e39, v53
    v_mov_b32 v56, 0
    v_mov_b32 v57, 0
    v_mov_b32 v58, 0
    v_mov_b32 v59, 0
    v_sub_f32 v60, v64, v53
    v_fmac_f32 v56, v60, v60
    v_sub_f32 v60, v65, v53
    v_fmac_f32 v57, v60, v60
    v_sub_f32 v60, v66, v53
    v_fmac_f32 v58, v60, v60
    v_sub_f32 v60, v67, v53
    v_fmac_f32 v59, v60, v60
    v_sub_f32 v60, v68, v53
    v_fmac_f32 v56, v60, v60
    v_sub_f32 v60, v69, v53
    v_fmac_f32 v57, v60, v60
    v_sub_f32 v60, v70, v53
    v_fmac_f32 v58, v60, v60
    v_sub_f32 v60, v71, v53
    v_fmac_f32 v59, v60, v60
    v_sub_f32 v60, v72, v53
    v_fmac_f32 v56, v60, v60
    v_sub_f32 v60, v73, v53
    v_fmac_f32 v57, v60, v60
    v_sub_f32 v60, v74, v53
    v_fmac_f32 v58, v60, v60
    v_sub_f32 v60, v75, v53
    v_fmac_f32 v59, v60, v60
    v_sub_f32 v60, v76, v53
    v_fmac_f32 v56, v60, v60
    v_sub_f32 v60, v77, v53
    v_fmac_f32 v57, v60, v60
    v_sub_f32 v60, v78, v53
    v_fmac_f32 v58, v60, v60
    v_sub_f32 v60, v79, v53
    v_fmac_f32 v59, v60, v60
    v_sub_f32 v60, v80, v53
    v_fmac_f32 v56, v60, v60
    v_sub_f32 v60, v81, v53
    v_fmac_f32 v57, v60, v60
    v_sub_f32 v60, v82, v53
    v_fmac_f32 v58, v60, v60
    v_sub_f32 v60, v83, v53
    v_fmac_f32 v59, v60, v60
    v_sub_f32 v60, v84, v53
    v_fmac_f32 v56, v60, v60
    v_sub_f32 v60, v85, v53
    v_fmac_f32 v57, v60, v60
    v_sub_f32 v60, v86, v53
    v_fmac_f32 v58, v60, v60
    v_sub_f32 v60, v87, v53
    v_fmac_f32 v59, v60, v60
    v_sub_f32 v60, v88, v53
    v_fmac_f32 v56, v60, v60
    v_sub_f32 v60, v89, v53
    v_fmac_f32 v57, v60, v60
    v_sub_f32 v60, v90, v53
    v_fmac_f32 v58, v60, v60
    v_sub_f32 v60, v91, v53
    v_fmac_f32 v59, v60, v60
    v_sub_f32 v60, v92, v53
    v_fmac_f32 v56, v60, v60
    v_sub_f32 v60, v93, v53
    v_fmac_f32 v57, v60, v60
    v_sub_f32 v60, v94, v53
    v_fmac_f32 v58, v60, v60
    v_sub_f32 v60, v95, v53
    v_fmac_f32 v59, v60, v60
    v_sub_f32 v60, v96, v53
    v_fmac_f32 v56, v60, v60
    v_sub_f32 v60, v97, v53
    v_fmac_f32 v57, v60, v60
    v_sub_f32 v60, v98, v53
    v_fmac_f32 v58, v60, v60
    v_sub_f32 v60, v99, v53
    v_fmac_f32 v59, v60, v60
    v_sub_f32 v60, v100, v53
    v_fmac_f32 v56, v60, v60
    v_sub_f32 v60, v101, v53
    v_fmac_f32 v57, v60, v60
    v_sub_f32 v60, v102, v53
    v_fmac_f32 v58, v60, v60
    v_sub_f32 v60, v103, v53
    v_fmac_f32 v59, v60, v60
    v_sub_f32 v60, v104, v53
    v_fmac_f32 v56, v60, v60
    v_sub_f32 v60, v105, v53
    v_fmac_f32 v57, v60, v60
    v_sub_f32 v60, v106, v53
    v_fmac_f32 v58, v60, v60
    v_sub_f32 v60, v107, v53
    v_fmac_f32 v59, v60, v60
    v_sub_f32 v60, v108, v53
    v_fmac_f32 v56, v60, v60
    v_sub_f32 v60, v109, v53
    v_fmac_f32 v57, v60, v60
    v_sub_f32 v60, v110, v53
    v_fmac_f32 v58, v60, v60
    v_sub_f32 v60, v111, v53
    v_fmac_f32 v59, v60, v60
    v_sub_f32 v60, v112, v53
    v_fmac_f32 v56, v60, v60
    v_sub_f32 v60, v113, v53
    v_fmac_f32 v57, v60, v60
    v_sub_f32 v60, v114, v53
    v_fmac_f32 v58, v60, v60
    v_sub_f32 v60, v115, v53
    v_fmac_f32 v59, v60, v60
    v_sub_f32 v60, v116, v53
    v_fmac_f32 v56, v60, v60
    v_sub_f32 v60, v117, v53
    v_fmac_f32 v57, v60, v60
    v_sub_f32 v60, v118, v53
    v_fmac_f32 v58, v60, v60
    v_sub_f32 v60, v119, v53
    v_fmac_f32 v59, v60, v60
    v_sub_f32 v60, v120, v53
    v_fmac_f32 v56, v60, v60
    v_sub_f32 v60, v121, v53
    v_fmac_f32 v57, v60, v60
    v_sub_f32 v60, v122, v53
    v_fmac_f32 v58, v60, v60
    v_sub_f32 v60, v123, v53
    v_fmac_f32 v59, v60, v60
    v_sub_f32 v60, v124, v53
    v_fmac_f32 v56, v60, v60
    v_sub_f32 v60, v125, v53
    v_fmac_f32 v57, v60, v60
    v_sub_f32 v60, v126, v53
    v_fmac_f32 v58, v60, v60
    v_sub_f32 v60, v127, v53
    v_fmac_f32 v59, v60, v60
    v_sub_f32 v60, v128, v53
    v_fmac_f32 v56, v60, v60
    v_sub_f32 v60, v129, v53
    v_fmac_f32 v57, v60, v60
    v_sub_f32 v60, v130, v53
    v_fmac_f32 v58, v60, v60
    v_sub_f32 v60, v131, v53
    v_fmac_f32 v59, v60, v60
    v_sub_f32 v60, v132, v53
    v_fmac_f32 v56, v60, v60
    v_sub_f32 v60, v133, v53
    v_fmac_f32 v57, v60, v60
    v_sub_f32 v60, v134, v53
    v_fmac_f32 v58, v60, v60
    v_sub_f32 v60, v135, v53
    v_fmac_f32 v59, v60, v60
    v_add_f32 v56, v56, v57
    v_add_f32 v58, v58, v59
    v_add_f32 v56, v56, v58
    ds_write_b32 v6, v56 offset:1024
    s_waitcnt lgkmcnt(0)
    s_barrier
    ds_read2_b32 v[8:9], v52 offset0:0 offset1:32
    ds_read2_b32 v[10:11], v52 offset0:64 offset1:96
    ds_read2_b32 v[12:13], v52 offset0:128 offset1:160
    ds_read2_b32 v[14:15], v52 offset0:192 offset1:224
    s_waitcnt lgkmcnt(3)
    v_add_f32 v8, v8, v9
    s_waitcnt lgkmcnt(2)
    v_add_f32 v10, v10, v11
    s_waitcnt lgkmcnt(1)
    v_add_f32 v12, v12, v13
    s_waitcnt lgkmcnt(0)
    v_add_f32 v14, v14, v15
    v_add_f32 v8, v8, v10
    v_add_f32 v12, v12, v14
    v_add_f32 v54, v8, v12
    v_mul_f32 v54, 0x3ae38e39, v54
    v_cvt_pk_bf16_f32 v53, v53, v53
    v_and_b32 v53, 0xffff0000, v53
    v_cvt_pk_bf16_f32 v54, v54, v54
    v_and_b32 v54, 0xffff0000, v54
    v_add_f32 v54, 0x3727c5ac, v54
    v_cvt_pk_bf16_f32 v54, v54, v54
    v_and_b32 v54, 0xffff0000, v54
    v_sqrt_f32 v54, v54
    s_nop 0
    v_cvt_pk_bf16_f32 v54, v54, v54
    v_and_b32 v54, 0xffff0000, v54
    v_rcp_f32 v54, v54
    v_sub_f32 v64, v64, v53
    v_sub_f32 v65, v65, v53
    v_cvt_pk_bf16_f32 v60, v64, v65
    v_lshlrev_b32 v64, 16, v60
    v_and_b32 v65, 0xffff0000, v60
    v_mul_f32 v64, v64, v54
    v_mul_f32 v65, v65, v54
    v_cvt_pk_bf16_f32 v16, v64, v65
    v_sub_f32 v66, v66, v53
    v_sub_f32 v67, v67, v53
    v_cvt_pk_bf16_f32 v60, v66, v67
    v_lshlrev_b32 v66, 16, v60
    v_and_b32 v67, 0xffff0000, v60
    v_mul_f32 v66, v66, v54
    v_mul_f32 v67, v67, v54
    v_cvt_pk_bf16_f32 v17, v66, v67
    v_sub_f32 v68, v68, v53
    v_sub_f32 v69, v69, v53
    v_cvt_pk_bf16_f32 v60, v68, v69
    v_lshlrev_b32 v68, 16, v60
    v_and_b32 v69, 0xffff0000, v60
    v_mul_f32 v68, v68, v54
    v_mul_f32 v69, v69, v54
    v_cvt_pk_bf16_f32 v18, v68, v69
    v_sub_f32 v70, v70, v53
    v_sub_f32 v71, v71, v53
    v_cvt_pk_bf16_f32 v60, v70, v71
    v_lshlrev_b32 v70, 16, v60
    v_and_b32 v71, 0xffff0000, v60
    v_mul_f32 v70, v70, v54
    v_mul_f32 v71, v71, v54
    v_cvt_pk_bf16_f32 v19, v70, v71
    v_sub_f32 v72, v72, v53
    v_sub_f32 v73, v73, v53
    v_cvt_pk_bf16_f32 v60, v72, v73
    v_lshlrev_b32 v72, 16, v60
    v_and_b32 v73, 0xffff0000, v60
    v_mul_f32 v72, v72, v54
    v_mul_f32 v73, v73, v54
    v_cvt_pk_bf16_f32 v20, v72, v73
    v_sub_f32 v74, v74, v53
    v_sub_f32 v75, v75, v53
    v_cvt_pk_bf16_f32 v60, v74, v75
    v_lshlrev_b32 v74, 16, v60
    v_and_b32 v75, 0xffff0000, v60
    v_mul_f32 v74, v74, v54
    v_mul_f32 v75, v75, v54
    v_cvt_pk_bf16_f32 v21, v74, v75
    v_sub_f32 v76, v76, v53
    v_sub_f32 v77, v77, v53
    v_cvt_pk_bf16_f32 v60, v76, v77
    v_lshlrev_b32 v76, 16, v60
    v_and_b32 v77, 0xffff0000, v60
    v_mul_f32 v76, v76, v54
    v_mul_f32 v77, v77, v54
    v_cvt_pk_bf16_f32 v22, v76, v77
    v_sub_f32 v78, v78, v53
    v_sub_f32 v79, v79, v53
    v_cvt_pk_bf16_f32 v60, v78, v79
    v_lshlrev_b32 v78, 16, v60
    v_and_b32 v79, 0xffff0000, v60
    v_mul_f32 v78, v78, v54
    v_mul_f32 v79, v79, v54
    v_cvt_pk_bf16_f32 v23, v78, v79
    v_sub_f32 v80, v80, v53
    v_sub_f32 v81, v81, v53
    v_cvt_pk_bf16_f32 v60, v80, v81
    v_lshlrev_b32 v80, 16, v60
    v_and_b32 v81, 0xffff0000, v60
    v_mul_f32 v80, v80, v54
    v_mul_f32 v81, v81, v54
    v_cvt_pk_bf16_f32 v24, v80, v81
    v_sub_f32 v82, v82, v53
    v_sub_f32 v83, v83, v53
    v_cvt_pk_bf16_f32 v60, v82, v83
    v_lshlrev_b32 v82, 16, v60
    v_and_b32 v83, 0xffff0000, v60
    v_mul_f32 v82, v82, v54
    v_mul_f32 v83, v83, v54
    v_cvt_pk_bf16_f32 v25, v82, v83
    v_sub_f32 v84, v84, v53
    v_sub_f32 v85, v85, v53
    v_cvt_pk_bf16_f32 v60, v84, v85
    v_lshlrev_b32 v84, 16, v60
    v_and_b32 v85, 0xffff0000, v60
    v_mul_f32 v84, v84, v54
    v_mul_f32 v85, v85, v54
    v_cvt_pk_bf16_f32 v26, v84, v85
    v_sub_f32 v86, v86, v53
    v_sub_f32 v87, v87, v53
    v_cvt_pk_bf16_f32 v60, v86, v87
    v_lshlrev_b32 v86, 16, v60
    v_and_b32 v87, 0xffff0000, v60
    v_mul_f32 v86, v86, v54
    v_mul_f32 v87, v87, v54
    v_cvt_pk_bf16_f32 v27, v86, v87
    v_sub_f32 v88, v88, v53
    v_sub_f32 v89, v89, v53
    v_cvt_pk_bf16_f32 v60, v88, v89
    v_lshlrev_b32 v88, 16, v60
    v_and_b32 v89, 0xffff0000, v60
    v_mul_f32 v88, v88, v54
    v_mul_f32 v89, v89, v54
    v_cvt_pk_bf16_f32 v28, v88, v89
    v_sub_f32 v90, v90, v53
    v_sub_f32 v91, v91, v53
    v_cvt_pk_bf16_f32 v60, v90, v91
    v_lshlrev_b32 v90, 16, v60
    v_and_b32 v91, 0xffff0000, v60
    v_mul_f32 v90, v90, v54
    v_mul_f32 v91, v91, v54
    v_cvt_pk_bf16_f32 v29, v90, v91
    v_sub_f32 v92, v92, v53
    v_sub_f32 v93, v93, v53
    v_cvt_pk_bf16_f32 v60, v92, v93
    v_lshlrev_b32 v92, 16, v60
    v_and_b32 v93, 0xffff0000, v60
    v_mul_f32 v92, v92, v54
    v_mul_f32 v93, v93, v54
    v_cvt_pk_bf16_f32 v30, v92, v93
    v_sub_f32 v94, v94, v53
    v_sub_f32 v95, v95, v53
    v_cvt_pk_bf16_f32 v60, v94, v95
    v_lshlrev_b32 v94, 16, v60
    v_and_b32 v95, 0xffff0000, v60
    v_mul_f32 v94, v94, v54
    v_mul_f32 v95, v95, v54
    v_cvt_pk_bf16_f32 v31, v94, v95
    v_sub_f32 v96, v96, v53
    v_sub_f32 v97, v97, v53
    v_cvt_pk_bf16_f32 v60, v96, v97
    v_lshlrev_b32 v96, 16, v60
    v_and_b32 v97, 0xffff0000, v60
    v_mul_f32 v96, v96, v54
    v_mul_f32 v97, v97, v54
    v_cvt_pk_bf16_f32 v32, v96, v97
    v_sub_f32 v98, v98, v53
    v_sub_f32 v99, v99, v53
    v_cvt_pk_bf16_f32 v60, v98, v99
    v_lshlrev_b32 v98, 16, v60
    v_and_b32 v99, 0xffff0000, v60
    v_mul_f32 v98, v98, v54
    v_mul_f32 v99, v99, v54
    v_cvt_pk_bf16_f32 v33, v98, v99
    v_sub_f32 v100, v100, v53
    v_sub_f32 v101, v101, v53
    v_cvt_pk_bf16_f32 v60, v100, v101
    v_lshlrev_b32 v100, 16, v60
    v_and_b32 v101, 0xffff0000, v60
    v_mul_f32 v100, v100, v54
    v_mul_f32 v101, v101, v54
    v_cvt_pk_bf16_f32 v34, v100, v101
    v_sub_f32 v102, v102, v53
    v_sub_f32 v103, v103, v53
    v_cvt_pk_bf16_f32 v60, v102, v103
    v_lshlrev_b32 v102, 16, v60
    v_and_b32 v103, 0xffff0000, v60
    v_mul_f32 v102, v102, v54
    v_mul_f32 v103, v103, v54
    v_cvt_pk_bf16_f32 v35, v102, v103
    v_sub_f32 v104, v104, v53
    v_sub_f32 v105, v105, v53
    v_cvt_pk_bf16_f32 v60, v104, v105
    v_lshlrev_b32 v104, 16, v60
    v_and_b32 v105, 0xffff0000, v60
    v_mul_f32 v104, v104, v54
    v_mul_f32 v105, v105, v54
    v_cvt_pk_bf16_f32 v36, v104, v105
    v_sub_f32 v106, v106, v53
    v_sub_f32 v107, v107, v53
    v_cvt_pk_bf16_f32 v60, v106, v107
    v_lshlrev_b32 v106, 16, v60
    v_and_b32 v107, 0xffff0000, v60
    v_mul_f32 v106, v106, v54
    v_mul_f32 v107, v107, v54
    v_cvt_pk_bf16_f32 v37, v106, v107
    v_sub_f32 v108, v108, v53
    v_sub_f32 v109, v109, v53
    v_cvt_pk_bf16_f32 v60, v108, v109
    v_lshlrev_b32 v108, 16, v60
    v_and_b32 v109, 0xffff0000, v60
    v_mul_f32 v108, v108, v54
    v_mul_f32 v109, v109, v54
    v_cvt_pk_bf16_f32 v38, v108, v109
    v_sub_f32 v110, v110, v53
    v_sub_f32 v111, v111, v53
    v_cvt_pk_bf16_f32 v60, v110, v111
    v_lshlrev_b32 v110, 16, v60
    v_and_b32 v111, 0xffff0000, v60
    v_mul_f32 v110, v110, v54
    v_mul_f32 v111, v111, v54
    v_cvt_pk_bf16_f32 v39, v110, v111
    v_sub_f32 v112, v112, v53
    v_sub_f32 v113, v113, v53
    v_cvt_pk_bf16_f32 v60, v112, v113
    v_lshlrev_b32 v112, 16, v60
    v_and_b32 v113, 0xffff0000, v60
    v_mul_f32 v112, v112, v54
    v_mul_f32 v113, v113, v54
    v_cvt_pk_bf16_f32 v40, v112, v113
    v_sub_f32 v114, v114, v53
    v_sub_f32 v115, v115, v53
    v_cvt_pk_bf16_f32 v60, v114, v115
    v_lshlrev_b32 v114, 16, v60
    v_and_b32 v115, 0xffff0000, v60
    v_mul_f32 v114, v114, v54
    v_mul_f32 v115, v115, v54
    v_cvt_pk_bf16_f32 v41, v114, v115
    v_sub_f32 v116, v116, v53
    v_sub_f32 v117, v117, v53
    v_cvt_pk_bf16_f32 v60, v116, v117
    v_lshlrev_b32 v116, 16, v60
    v_and_b32 v117, 0xffff0000, v60
    v_mul_f32 v116, v116, v54
    v_mul_f32 v117, v117, v54
    v_cvt_pk_bf16_f32 v42, v116, v117
    v_sub_f32 v118, v118, v53
    v_sub_f32 v119, v119, v53
    v_cvt_pk_bf16_f32 v60, v118, v119
    v_lshlrev_b32 v118, 16, v60
    v_and_b32 v119, 0xffff0000, v60
    v_mul_f32 v118, v118, v54
    v_mul_f32 v119, v119, v54
    v_cvt_pk_bf16_f32 v43, v118, v119
    v_sub_f32 v120, v120, v53
    v_sub_f32 v121, v121, v53
    v_cvt_pk_bf16_f32 v60, v120, v121
    v_lshlrev_b32 v120, 16, v60
    v_and_b32 v121, 0xffff0000, v60
    v_mul_f32 v120, v120, v54
    v_mul_f32 v121, v121, v54
    v_cvt_pk_bf16_f32 v44, v120, v121
    v_sub_f32 v122, v122, v53
    v_sub_f32 v123, v123, v53
    v_cvt_pk_bf16_f32 v60, v122, v123
    v_lshlrev_b32 v122, 16, v60
    v_and_b32 v123, 0xffff0000, v60
    v_mul_f32 v122, v122, v54
    v_mul_f32 v123, v123, v54
    v_cvt_pk_bf16_f32 v45, v122, v123
    v_sub_f32 v124, v124, v53
    v_sub_f32 v125, v125, v53
    v_cvt_pk_bf16_f32 v60, v124, v125
    v_lshlrev_b32 v124, 16, v60
    v_and_b32 v125, 0xffff0000, v60
    v_mul_f32 v124, v124, v54
    v_mul_f32 v125, v125, v54
    v_cvt_pk_bf16_f32 v46, v124, v125
    v_sub_f32 v126, v126, v53
    v_sub_f32 v127, v127, v53
    v_cvt_pk_bf16_f32 v60, v126, v127
    v_lshlrev_b32 v126, 16, v60
    v_and_b32 v127, 0xffff0000, v60
    v_mul_f32 v126, v126, v54
    v_mul_f32 v127, v127, v54
    v_cvt_pk_bf16_f32 v47, v126, v127
    v_sub_f32 v128, v128, v53
    v_sub_f32 v129, v129, v53
    v_cvt_pk_bf16_f32 v60, v128, v129
    v_lshlrev_b32 v128, 16, v60
    v_and_b32 v129, 0xffff0000, v60
    v_mul_f32 v128, v128, v54
    v_mul_f32 v129, v129, v54
    v_cvt_pk_bf16_f32 v48, v128, v129
    v_sub_f32 v130, v130, v53
    v_sub_f32 v131, v131, v53
    v_cvt_pk_bf16_f32 v60, v130, v131
    v_lshlrev_b32 v130, 16, v60
    v_and_b32 v131, 0xffff0000, v60
    v_mul_f32 v130, v130, v54
    v_mul_f32 v131, v131, v54
    v_cvt_pk_bf16_f32 v49, v130, v131
    v_sub_f32 v132, v132, v53
    v_sub_f32 v133, v133, v53
    v_cvt_pk_bf16_f32 v60, v132, v133
    v_lshlrev_b32 v132, 16, v60
    v_and_b32 v133, 0xffff0000, v60
    v_mul_f32 v132, v132, v54
    v_mul_f32 v133, v133, v54
    v_cvt_pk_bf16_f32 v50, v132, v133
    v_sub_f32 v134, v134, v53
    v_sub_f32 v135, v135, v53
    v_cvt_pk_bf16_f32 v60, v134, v135
    v_lshlrev_b32 v134, 16, v60
    v_and_b32 v135, 0xffff0000, v60
    v_mul_f32 v134, v134, v54
    v_mul_f32 v135, v135, v54
    v_cvt_pk_bf16_f32 v51, v134, v135
    s_mul_i32 s35, s30, 36864
    s_mul_i32 s36, s29, 9216
    s_add_u32 s35, s35, s36
    buffer_store_dwordx4 v[16:19], v0, s[8:11], s35 offen offset:0 sc0 sc1
    buffer_store_dwordx4 v[20:23], v0, s[8:11], s35 offen offset:1024 sc0 sc1
    buffer_store_dwordx4 v[24:27], v0, s[8:11], s35 offen offset:2048 sc0 sc1
    buffer_store_dwordx4 v[28:31], v0, s[8:11], s35 offen offset:3072 sc0 sc1
    s_add_u32 s35, s35, 4096
    buffer_store_dwordx4 v[32:35], v0, s[8:11], s35 offen offset:0 sc0 sc1
    buffer_store_dwordx4 v[36:39], v0, s[8:11], s35 offen offset:1024 sc0 sc1
    buffer_store_dwordx4 v[40:43], v0, s[8:11], s35 offen offset:2048 sc0 sc1
    buffer_store_dwordx4 v[44:47], v0, s[8:11], s35 offen offset:3072 sc0 sc1
    s_add_u32 s35, s35, 4096
    buffer_store_dwordx4 v[48:51], v0, s[8:11], s35 offen offset:0 sc0 sc1
    s_waitcnt vmcnt(0)
    s_barrier
    s_cmp_lg_u32 s29, 0
    s_cbranch_scc1 Lln_next
    v_mov_b32 v8, 0
Linit1:
    s_sleep 4
    global_load_dword v9, v8, s[6:7] offset:132 sc1
    s_sub_u32 s39, s39, 1
    s_cbranch_scc1 Lbail
    s_waitcnt vmcnt(0)
    v_cmp_eq_u32 vcc, 0, v9
    s_nop 0
    s_cbranch_vccnz Linit1
    s_lshl_b32 s35, s30, 2
    s_add_u32 s35, s35, 102760448
    v_mov_b32 v8, 0
    v_mov_b32 v9, 1
    s_mov_b64 exec, 1
    buffer_store_dword v9, v8, s[8:11], s35 offen sc0 sc1
    s_mov_b64 exec, -1
Lln_next:
    s_barrier
Lnoln:
    s_cmp_lt_u32 s28, 198
    s_cbranch_scc1 Lgemm
    s_sub_u32 s28, s28, 198
    v_bfe_u32 v4, v1, 5, 1
    v_lshlrev_b32 v2, 9, v4
    v_bfe_u32 v4, v1, 3, 1
    v_lshl_add_u32 v2, v4, 8, v2
    v_bfe_u32 v4, v1, 4, 1
    v_lshl_add_u32 v2, v4, 7, v2
    v_bfe_u32 v4, v1, 0, 3
    v_lshl_add_u32 v2, v4, 4, v2
    v_mul_u32_u24 v3, 384, v1
    s_lshl_b32 s38, s29, 12
    s_add_u32 s38, s38, 4096
    v_bfe_u32 v4, v1, 0, 2
    v_lshlrev_b32 v5, 8, v4
    v_bfe_u32 v4, v1, 5, 1
    v_lshl_add_u32 v5, v4, 6, v5
    v_bfe_u32 v4, v1, 2, 2
    v_lshl_add_u32 v5, v4, 4, v5
    v_add_u32 v5, s38, v5
    v_bfe_u32 v4, v1, 5, 1
    v_lshlrev_b32 v6, 8, v4
    v_bfe_u32 v4, v1, 0, 4
    v_lshl_add_u32 v6, v4, 4, v6
    v_bfe_u32 v4, v1, 4, 1
    v_lshl_add_u32 v6, v4, 2, v6
    v_add_u32 v6, s38, v6
    v_and_b32 v4, 31, v1
    v_lshrrev_b32 v7, 5, v1
    v_lshlrev_b32 v7, 2, v7
    v_sub_u32 v7, v4, v7
    v_and_b32 v4, 2, v1
    v_cmp_ne_u32 s[42:43], 0, v4
    s_mov_b32 s40, 0x3e0293ee
    s_lshl_b32 s30, s28, 2
    s_add_u32 s30, s30, s29
    v_mov_b32 v12, -1
    v_mov_b32 v13, -1
    v_mov_b32 v14, -1
    v_mov_b32 v15, -1
    s_add_u32 s35, s30, 1976
    s_sub_u32 s36, s35, 104
    s_cmp_lt_u32 s35, 2048
    s_cselect_b32 s35, s35, s36
    s_lshl_b32 s35, s35, 13
    s_add_u32 s35, s35, 54525952
    s_add_u32 s36, s35, 4096
    buffer_store_dwordx4 v[12:15], v0, s[8:11], s35 offen offset:0 sc0 sc1
    buffer_store_dwordx4 v[12:15], v0, s[8:11], s35 offen offset:1024 sc0 sc1
    buffer_store_dwordx4 v[12:15], v0, s[8:11], s35 offen offset:2048 sc0 sc1
    buffer_store_dwordx4 v[12:15], v0, s[8:11], s35 offen offset:3072 sc0 sc1
    buffer_store_dwordx4 v[12:15], v0, s[8:11], s36 offen offset:0 sc0 sc1
    buffer_store_dwordx4 v[12:15], v0, s[8:11], s36 offen offset:1024 sc0 sc1
    buffer_store_dwordx4 v[12:15], v0, s[8:11], s36 offen offset:2048 sc0 sc1
    buffer_store_dwordx4 v[12:15], v0, s[8:11], s36 offen offset:3072 sc0 sc1
    v_mov_b32 v8, 0
Linit2:
    s_sleep 4
    global_load_dword v9, v8, s[6:7] offset:132 sc1
    s_sub_u32 s39, s39, 1
    s_cbranch_scc1 Lbail
    s_waitcnt vmcnt(0)
    v_cmp_eq_u32 vcc, 0, v9
    s_nop 0
    s_cbranch_vccnz Linit2
    s_lshl_b32 s35, s30, 2
    s_add_u32 s35, s35, 102761472
    v_mov_b32 v8, 0
    v_mov_b32 v9, 1
    s_mov_b64 exec, 1
    buffer_store_dword v9, v8, s[8:11], s35 offen sc0 sc1
    s_mov_b64 exec, -1
    v_add_u32 v4, s38, v0
    v_lshrrev_b32 v252, 2, v1
    v_lshlrev_b32 v252, 11, v252
    v_and_b32 v8, 3, v1
    v_min_u32 v8, 2, v8
    v_mul_u32_u24 v8, 384, v8
    v_add_u32 v252, v252, v8
    s_mov_b32 s45, 0
    s_mov_b32 s44, s30
    v_lshlrev_b32 v8, 2, v1
    s_mov_b32 s35, 102760448
    s_nop 0
Lpoll3:
    buffer_load_dword v9, v8, s[8:11], s35 offen sc1
    s_sub_u32 s39, s39, 1
    s_cbranch_scc1 Lbail
    s_waitcnt vmcnt(0)
    v_cmp_gt_u32 vcc, 1, v9
    s_nop 0
    s_cbranch_vccz Lpoll3d
    s_sleep 48
    s_branch Lpoll3
Lpoll3d:
    s_load_dwordx2 s[16:17], s[0:1], 72
    s_mov_b32 s18, 5308416
    s_mov_b32 s19, 0x20000
    s_waitcnt lgkmcnt(0)
    s_mul_i32 s35, s30, 51200
    buffer_load_dwordx4 v[16:19], v0, s[16:19], s35 offen offset:0
    buffer_load_dwordx4 v[16:19], v0, s[16:19], s35 offen offset:1024
    buffer_load_dwordx4 v[16:19], v0, s[16:19], s35 offen offset:2048
    buffer_load_dwordx4 v[16:19], v0, s[16:19], s35 offen offset:3072
    s_add_u32 s35, s35, 4096
    buffer_load_dwordx4 v[16:19], v0, s[16:19], s35 offen offset:0
    buffer_load_dwordx4 v[16:19], v0, s[16:19], s35 offen offset:1024
    buffer_load_dwordx4 v[16:19], v0, s[16:19], s35 offen offset:2048
    buffer_load_dwordx4 v[16:19], v0, s[16:19], s35 offen offset:3072
    s_add_u32 s35, s35, 4096
    buffer_load_dwordx4 v[16:19], v0, s[16:19], s35 offen offset:0
    buffer_load_dwordx4 v[16:19], v0, s[16:19], s35 offen offset:1024
    buffer_load_dwordx4 v[16:19], v0, s[16:19], s35 offen offset:2048
    buffer_load_dwordx4 v[16:19], v0, s[16:19], s35 offen offset:3072
    s_add_u32 s35, s35, 4096
    buffer_load_dwordx4 v[16:19], v0, s[16:19], s35 offen offset:0
    buffer_load_dwordx4 v[16:19], v0, s[16:19], s35 offen offset:1024
    buffer_load_dwordx4 v[16:19], v0, s[16:19], s35 offen offset:2048
    buffer_load_dwordx4 v[16:19], v0, s[16:19], s35 offen offset:3072
    s_add_u32 s35, s35, 4096
    buffer_load_dwordx4 v[16:19], v0, s[16:19], s35 offen offset:0
    buffer_load_dwordx4 v[16:19], v0, s[16:19], s35 offen offset:1024
    buffer_load_dwordx4 v[16:19], v0, s[16:19], s35 offen offset:2048
    buffer_load_dwordx4 v[16:19], v0, s[16:19], s35 offen offset:3072
    s_add_u32 s35, s35, 4096
    buffer_load_dwordx4 v[16:19], v0, s[16:19], s35 offen offset:0
    buffer_load_dwordx4 v[16:19], v0, s[16:19], s35 offen offset:1024
    buffer_load_dwordx4 v[16:19], v0, s[16:19], s35 offen offset:2048
    buffer_load_dwordx4 v[16:19], v0, s[16:19], s35 offen offset:3072
    s_add_u32 s35, s35, 4096
    buffer_load_dwordx4 v[16:19], v0, s[16:19], s35 offen offset:0
    buffer_load_dwordx4 v[16:19], v0, s[16:19], s35 offen offset:1024
    buffer_load_dwordx4 v[16:19], v0, s[16:19], s35 offen offset:2048
    buffer_load_dwordx4 v[16:19], v0, s[16:19], s35 offen offset:3072
    s_add_u32 s35, s35, 4096
    buffer_load_dwordx4 v[16:19], v0, s[16:19], s35 offen offset:0
    buffer_load_dwordx4 v[16:19], v0, s[16:19], s35 offen offset:1024
    buffer_load_dwordx4 v[16:19], v0, s[16:19], s35 offen offset:2048
    buffer_load_dwordx4 v[16:19], v0, s[16:19], s35 offen offset:3072
    s_add_u32 s35, s35, 4096
    buffer_load_dwordx4 v[16:19], v0, s[16:19], s35 offen offset:0
    buffer_load_dwordx4 v[16:19], v0, s[16:19], s35 offen offset:1024
    buffer_load_dwordx4 v[16:19], v0, s[16:19], s35 offen offset:2048
    buffer_load_dwordx4 v[16:19], v0, s[16:19], s35 offen offset:3072
    s_add_u32 s35, s35, 4096
    buffer_load_dwordx4 v[16:19], v0, s[16:19], s35 offen offset:0
    buffer_load_dwordx4 v[16:19], v0, s[16:19], s35 offen offset:1024
    buffer_load_dwordx4 v[16:19], v0, s[16:19], s35 offen offset:2048
    buffer_load_dwordx4 v[16:19], v0, s[16:19], s35 offen offset:3072
    s_add_u32 s35, s35, 4096
    buffer_load_dwordx4 v[16:19], v0, s[16:19], s35 offen offset:0
    buffer_load_dwordx4 v[16:19], v0, s[16:19], s35 offen offset:1024
    buffer_load_dwordx4 v[16:19], v0, s[16:19], s35 offen offset:2048
    buffer_load_dwordx4 v[16:19], v0, s[16:19], s35 offen offset:3072
    s_add_u32 s35, s35, 4096
    buffer_load_dwordx4 v[16:19], v0, s[16:19], s35 offen offset:0
    buffer_load_dwordx4 v[16:19], v0, s[16:19], s35 offen offset:1024
    buffer_load_dwordx4 v[16:19], v0, s[16:19], s35 offen offset:2048
    buffer_load_dwordx4 v[16:19], v0, s[16:19], s35 offen offset:3072
    s_add_u32 s35, s35, 4096
    buffer_load_dwordx4 v[16:19], v0, s[16:19], s35 offen offset:0
    buffer_load_dwordx4 v[16:19], v0, s[16:19], s35 offen offset:1024
    s_waitcnt vmcnt(0)
    s_cmp_lg_u32 s45, 0
    s_cbranch_scc1 Lp4_f
    s_lshr_b32 s46, s44, 5
    s_and_b32 s47, s44, 31
    s_mul_hi_u32 s36, s46, 0x55555556
    s_mul_i32 s35, s36, 3
    s_sub_u32 s35, s46, s35
    s_lshl_b32 s35, s35, 7
    s_lshr_b32 s37, s47, 1
    s_lshl_b32 s37, s37, 11
    s_add_u32 s35, s35, s37
    s_add_u32 s35, s35, 102776832
    s_add_u32 s36, s36, 1
    s_mov_b64 exec, 0x7
Lpoll4:
    buffer_load_dword v8, v3, s[8:11], s35 offen sc1
    s_sub_u32 s39, s39, 1
    s_cbranch_scc1 Lbail
    s_waitcnt vmcnt(0)
    v_cmp_gt_u32 vcc, s36, v8
    s_nop 0
    s_cbranch_vccz Lpoll4d
    s_sleep 32
    s_branch Lpoll4
Lpoll4d:
    s_mov_b64 exec, -1
    v_readfirstlane_b32 s46, v8
    s_nop 0
    s_cmp_lt_u32 s46, 64
    s_cbranch_scc1 Lp4_f
    s_mov_b32 s35, 102776832
    buffer_load_dword v13, v252, s[8:11], s35 offen offset:0 sc1
    buffer_load_dword v14, v252, s[8:11], s35 offen offset:128 sc1
    buffer_load_dword v15, v252, s[8:11], s35 offen offset:256 sc1
    s_waitcnt vmcnt(0)
    v_min3_u32 v8, v13, v14, v15
    v_cmp_gt_u32 vcc, 64, v8
    s_nop 0
    s_cmp_eq_u64 vcc, 0
    s_cselect_b32 s45, 1, 0
Lp4_f:
    s_lshl_b32 s35, s44, 13
    s_add_u32 s35, s35, 4194304
    s_add_u32 s36, s35, 4096
    buffer_load_dwordx4 a[0:3], v0, s[8:11], s35 offen offset:0 sc1
    buffer_load_dwordx4 a[4:7], v0, s[8:11], s35 offen offset:1024 sc1
    buffer_load_dwordx4 a[8:11], v0, s[8:11], s35 offen offset:2048 sc1
    buffer_load_dwordx4 a[12:15], v0, s[8:11], s35 offen offset:3072 sc1
    buffer_load_dwordx4 a[16:19], v0, s[8:11], s36 offen offset:0 sc1
    buffer_load_dwordx4 a[20:23], v0, s[8:11], s36 offen offset:1024 sc1
    buffer_load_dwordx4 a[24:27], v0, s[8:11], s36 offen offset:2048 sc1
    buffer_load_dwordx4 a[28:31], v0, s[8:11], s36 offen offset:3072 sc1
    s_lshl_b32 s35, s44, 13
    s_add_u32 s35, s35, 20971520
    s_add_u32 s36, s35, 4096
    buffer_load_dwordx4 a[32:35], v2, s[8:11], s35 offen offset:0 sc1
    buffer_load_dwordx4 a[36:39], v2, s[8:11], s35 offen offset:1024 sc1
    buffer_load_dwordx4 a[40:43], v2, s[8:11], s35 offen offset:2048 sc1
    buffer_load_dwordx4 a[44:47], v2, s[8:11], s35 offen offset:3072 sc1
    buffer_load_dwordx4 a[48:51], v2, s[8:11], s36 offen offset:0 sc1
    buffer_load_dwordx4 a[52:55], v2, s[8:11], s36 offen offset:1024 sc1
    buffer_load_dwordx4 a[56:59], v2, s[8:11], s36 offen offset:2048 sc1
    buffer_load_dwordx4 a[60:63], v2, s[8:11], s36 offen offset:3072 sc1
    s_lshl_b32 s35, s44, 13
    s_add_u32 s35, s35, 37748736
    s_add_u32 s36, s35, 4096
    buffer_load_dwordx4 a[64:67], v0, s[8:11], s35 offen offset:0 sc1
    buffer_load_dwordx4 a[68:71], v0, s[8:11], s35 offen offset:1024 sc1
    buffer_load_dwordx4 a[72:75], v0, s[8:11], s35 offen offset:2048 sc1
    buffer_load_dwordx4 a[76:79], v0, s[8:11], s35 offen offset:3072 sc1
    buffer_load_dwordx4 a[80:83], v0, s[8:11], s36 offen offset:0 sc1
    buffer_load_dwordx4 a[84:87], v0, s[8:11], s36 offen offset:1024 sc1
    buffer_load_dwordx4 a[88:91], v0, s[8:11], s36 offen offset:2048 sc1
    buffer_load_dwordx4 a[92:95], v0, s[8:11], s36 offen offset:3072 sc1
    s_waitcnt vmcnt(0)
Lp4_loop0:
    s_nop 15
    s_nop 3
    s_waitcnt vmcnt(1)
    s_lshr_b32 s31, s30, 5
    s_and_b32 s32, s30, 31
    v_mfma_f32_32x32x16_bf16 v[112:127], a[32:35], a[0:3], 0
    v_mfma_f32_32x32x16_bf16 v[112:127], a[36:39], a[4:7], v[112:127]
    v_mfma_f32_32x32x16_bf16 v[112:127], a[40:43], a[8:11], v[112:127]
    v_mfma_f32_32x32x16_bf16 v[112:127], a[44:47], a[12:15], v[112:127]
    v_mfma_f32_32x32x16_bf16 v[112:127], a[48:51], a[16:19], v[112:127]
    v_mfma_f32_32x32x16_bf16 v[112:127], a[52:55], a[20:23], v[112:127]
    v_mfma_f32_32x32x16_bf16 v[112:127], a[56:59], a[24:27], v[112:127]
    v_mfma_f32_32x32x16_bf16 v[112:127], a[60:63], a[28:31], v[112:127]
    s_add_u32 s44, s30, 104
    s_min_u32 s44, s44, 2047
    s_cmp_lg_u32 s45, 0
    s_cbranch_scc1 Lp4_f0
    s_lshr_b32 s46, s44, 5
    s_and_b32 s47, s44, 31
    s_mul_hi_u32 s36, s46, 0x55555556
    s_mul_i32 s35, s36, 3
    s_sub_u32 s35, s46, s35
    s_lshl_b32 s35, s35, 7
    s_lshr_b32 s37, s47, 1
    s_lshl_b32 s37, s37, 11
    s_add_u32 s35, s35, s37
    s_add_u32 s35, s35, 102776832
    s_add_u32 s36, s36, 1
    s_mov_b64 exec, 0x7
Lpoll5:
    buffer_load_dword v8, v3, s[8:11], s35 offen sc1
    s_sub_u32 s39, s39, 1
    s_cbranch_scc1 Lbail
    s_waitcnt vmcnt(0)
    v_cmp_gt_u32 vcc, s36, v8
    s_nop 0
    s_cbranch_vccz Lpoll5d
    s_sleep 32
    s_branch Lpoll5
Lpoll5d:
    s_mov_b64 exec, -1
    v_readfirstlane_b32 s46, v8
    s_nop 0
    s_cmp_lt_u32 s46, 64
    s_cbranch_scc1 Lp4_f0
    s_mov_b32 s35, 102776832
    buffer_load_dword v13, v252, s[8:11], s35 offen offset:0 sc1
    buffer_load_dword v14, v252, s[8:11], s35 offen offset:128 sc1
    buffer_load_dword v15, v252, s[8:11], s35 offen offset:256 sc1
    s_waitcnt vmcnt(0)
    v_min3_u32 v8, v13, v14, v15
    v_cmp_gt_u32 vcc, 64, v8
    s_nop 0
    s_cmp_eq_u64 vcc, 0
    s_cselect_b32 s45, 1, 0
Lp4_f0:
    s_lshl_b32 s35, s44, 13
    s_add_u32 s35, s35, 4194304
    s_add_u32 s36, s35, 4096
    buffer_load_dwordx4 a[96:99], v0, s[8:11], s35 offen offset:0 sc1
    buffer_load_dwordx4 a[100:103], v0, s[8:11], s35 offen offset:1024 sc1
    buffer_load_dwordx4 a[104:107], v0, s[8:11], s35 offen offset:2048 sc1
    buffer_load_dwordx4 a[108:111], v0, s[8:11], s35 offen offset:3072 sc1
    buffer_load_dwordx4 a[112:115], v0, s[8:11], s36 offen offset:0 sc1
    buffer_load_dwordx4 a[116:119], v0, s[8:11], s36 offen offset:1024 sc1
    buffer_load_dwordx4 a[120:123], v0, s[8:11], s36 offen offset:2048 sc1
    buffer_load_dwordx4 a[124:127], v0, s[8:11], s36 offen offset:3072 sc1
    s_lshl_b32 s35, s44, 13
    s_add_u32 s35, s35, 20971520
    s_add_u32 s36, s35, 4096
    buffer_load_dwordx4 a[128:131], v2, s[8:11], s35 offen offset:0 sc1
    buffer_load_dwordx4 a[132:135], v2, s[8:11], s35 offen offset:1024 sc1
    buffer_load_dwordx4 a[136:139], v2, s[8:11], s35 offen offset:2048 sc1
    buffer_load_dwordx4 a[140:143], v2, s[8:11], s35 offen offset:3072 sc1
    buffer_load_dwordx4 a[144:147], v2, s[8:11], s36 offen offset:0 sc1
    buffer_load_dwordx4 a[148:151], v2, s[8:11], s36 offen offset:1024 sc1
    buffer_load_dwordx4 a[152:155], v2, s[8:11], s36 offen offset:2048 sc1
    buffer_load_dwordx4 a[156:159], v2, s[8:11], s36 offen offset:3072 sc1
    s_lshl_b32 s35, s44, 13
    s_add_u32 s35, s35, 37748736
    s_add_u32 s36, s35, 4096
    buffer_load_dwordx4 a[160:163], v0, s[8:11], s35 offen offset:0 sc1
    buffer_load_dwordx4 a[164:167], v0, s[8:11], s35 offen offset:1024 sc1
    buffer_load_dwordx4 a[168:171], v0, s[8:11], s35 offen offset:2048 sc1
    buffer_load_dwordx4 a[172:175], v0, s[8:11], s35 offen offset:3072 sc1
    buffer_load_dwordx4 a[176:179], v0, s[8:11], s36 offen offset:0 sc1
    buffer_load_dwordx4 a[180:183], v0, s[8:11], s36 offen offset:1024 sc1
    buffer_load_dwordx4 a[184:187], v0, s[8:11], s36 offen offset:2048 sc1
    buffer_load_dwordx4 a[188:191], v0, s[8:11], s36 offen offset:3072 sc1
    v_mov_b32 v9, 0xd028965f
    v_cmp_gt_i32 vcc, 0, v7
    s_nop 1
    v_cndmask_b32 v112, v112, v9, vcc
    v_cmp_gt_i32 vcc, 1, v7
    s_nop 1
    v_cndmask_b32 v113, v113, v9, vcc
    v_cmp_gt_i32 vcc, 2, v7
    s_nop 1
    v_cndmask_b32 v114, v114, v9, vcc
    v_cmp_gt_i32 vcc, 3, v7
    s_nop 1
    v_cndmask_b32 v115, v115, v9, vcc
    v_cmp_gt_i32 vcc, 8, v7
    s_nop 1
    v_cndmask_b32 v116, v116, v9, vcc
    v_cmp_gt_i32 vcc, 9, v7
    s_nop 1
    v_cndmask_b32 v117, v117, v9, vcc
    v_cmp_gt_i32 vcc, 10, v7
    s_nop 1
    v_cndmask_b32 v118, v118, v9, vcc
    v_cmp_gt_i32 vcc, 11, v7
    s_nop 1
    v_cndmask_b32 v119, v119, v9, vcc
    v_cmp_gt_i32 vcc, 16, v7
    s_nop 1
    v_cndmask_b32 v120, v120, v9, vcc
    v_cmp_gt_i32 vcc, 17, v7
    s_nop 1
    v_cndmask_b32 v121, v121, v9, vcc
    v_cmp_gt_i32 vcc, 18, v7
    s_nop 1
    v_cndmask_b32 v122, v122, v9, vcc
    v_cmp_gt_i32 vcc, 19, v7
    s_nop 1
    v_cndmask_b32 v123, v123, v9, vcc
    v_cmp_gt_i32 vcc, 24, v7
    s_nop 1
    v_cndmask_b32 v124, v124, v9, vcc
    v_cmp_gt_i32 vcc, 25, v7
    s_nop 1
    v_cndmask_b32 v125, v125, v9, vcc
    v_cmp_gt_i32 vcc, 26, v7
    s_nop 1
    v_cndmask_b32 v126, v126, v9, vcc
    v_cmp_gt_i32 vcc, 27, v7
    s_nop 1
    v_cndmask_b32 v127, v127, v9, vcc
    v_max3_f32 v10, v112, v113, v114
    v_max3_f32 v10, v10, v115, v116
    v_max3_f32 v10, v10, v117, v118
    v_max3_f32 v10, v10, v119, v120
    v_max3_f32 v10, v10, v121, v122
    v_max3_f32 v10, v10, v123, v124
    v_max3_f32 v10, v10, v125, v126
    v_max_f32 v10, v10, v127
    v_mov_b32 v11, v10
    s_nop 1
    v_permlane32_swap_b32 v10, v11
    v_max_f32 v10, v10, v11
    v_sub_f32 v112, v112, v10
    v_mul_f32 v112, s40, v112
    v_sub_f32 v113, v113, v10
    v_mul_f32 v113, s40, v113
    v_sub_f32 v114, v114, v10
    v_mul_f32 v114, s40, v114
    v_sub_f32 v115, v115, v10
    v_mul_f32 v115, s40, v115
    v_sub_f32 v116, v116, v10
    v_mul_f32 v116, s40, v116
    v_sub_f32 v117, v117, v10
    v_mul_f32 v117, s40, v117
    v_sub_f32 v118, v118, v10
    v_mul_f32 v118, s40, v118
    v_sub_f32 v119, v119, v10
    v_mul_f32 v119, s40, v119
    v_sub_f32 v120, v120, v10
    v_mul_f32 v120, s40, v120
    v_sub_f32 v121, v121, v10
    v_mul_f32 v121, s40, v121
    v_sub_f32 v122, v122, v10
    v_mul_f32 v122, s40, v122
    v_sub_f32 v123, v123, v10
    v_mul_f32 v123, s40, v123
    v_sub_f32 v124, v124, v10
    v_mul_f32 v124, s40, v124
    v_sub_f32 v125, v125, v10
    v_mul_f32 v125, s40, v125
    v_sub_f32 v126, v126, v10
    v_mul_f32 v126, s40, v126
    v_sub_f32 v127, v127, v10
    v_mul_f32 v127, s40, v127
    v_exp_f32 v112, v112
    v_exp_f32 v113, v113
    v_exp_f32 v114, v114
    v_exp_f32 v115, v115
    v_exp_f32 v116, v116
    v_exp_f32 v117, v117
    v_exp_f32 v118, v118
    v_exp_f32 v119, v119
    v_exp_f32 v120, v120
    v_exp_f32 v121, v121
    v_exp_f32 v122, v122
    v_exp_f32 v123, v123
    v_exp_f32 v124, v124
    v_exp_f32 v125, v125
    v_exp_f32 v126, v126
    v_exp_f32 v127, v127
    v_add_f32 v12, v112, v116
    v_add_f32 v13, v113, v117
    v_add_f32 v14, v114, v118
    v_add_f32 v15, v115, v119
    v_add_f32 v12, v12, v120
    v_add_f32 v13, v13, v121
    v_add_f32 v14, v14, v122
    v_add_f32 v15, v15, v123
    v_add_f32 v12, v12, v124
    v_add_f32 v13, v13, v125
    v_add_f32 v14, v14, v126
    v_add_f32 v15, v15, v127
    v_add_f32 v12, v12, v13
    v_add_f32 v14, v14, v15
    v_add_f32 v12, v12, v14
    v_cvt_pk_bf16_f32 v240, v112, v113
    v_cvt_pk_bf16_f32 v241, v114, v115
    v_cvt_pk_bf16_f32 v242, v116, v117
    v_cvt_pk_bf16_f32 v243, v118, v119
    v_cvt_pk_bf16_f32 v244, v120, v121
    v_cvt_pk_bf16_f32 v245, v122, v123
    v_cvt_pk_bf16_f32 v246, v124, v125
    v_cvt_pk_bf16_f32 v247, v126, v127
    v_mov_b64 v[250:251], 0
    v_mfma_f32_32x32x16_bf16 v[176:191], a[64:67], v[240:243], 0
    v_mfma_f32_32x32x16_bf16 v[176:191], a[68:71], v[244:247], v[176:191]
    v_mfma_f32_32x32x16_bf16 v[192:207], a[72:75], v[240:243], 0
    v_mfma_f32_32x32x16_bf16 v[192:207], a[76:79], v[244:247], v[192:207]
    v_mfma_f32_32x32x16_bf16 v[208:223], a[80:83], v[240:243], 0
    v_mfma_f32_32x32x16_bf16 v[208:223], a[84:87], v[244:247], v[208:223]
    v_mfma_f32_32x32x16_bf16 v[224:239], a[88:91], v[240:243], 0
    v_mfma_f32_32x32x16_bf16 v[224:239], a[92:95], v[244:247], v[224:239]
    v_mov_b64 v[66:67], 0
    v_mov_b64 v[70:71], 0
    v_mov_b64 v[74:75], 0
    v_mov_b64 v[78:79], 0
    s_lshl_b32 s35, s32, 7
    s_add_u32 s35, s35, 102764544
    s_mov_b32 s41, s35
    s_cmp_lt_u32 s31, 58
    s_addc_u32 s36, s31, 0
    s_min_u32 s36, s36, 62
    s_lshl_b32 s35, s30, 12
    s_add_u32 s35, s35, 92274688
    s_mov_b32 m0, s38
Lsp6:
    s_load_dword s60, s[8:9], s41 glc
    s_sub_u32 s39, s39, 1
    s_cbranch_scc1 Lbail
    s_waitcnt lgkmcnt(0)
    s_cmp_ge_u32 s60, s36
    s_cbranch_scc1 Lsp6d
    s_sleep 1
    s_branch Lsp6
Lsp6d:
Lp4_pub0:
    buffer_load_dwordx4 v0, s[8:11], s35 offen offset:0 sc1 lds
    buffer_load_dwordx4 v0, s[8:11], s35 offen offset:1024 sc1 lds
    buffer_load_dwordx4 v0, s[8:11], s35 offen offset:2048 sc1 lds
    buffer_load_dwordx4 v0, s[8:11], s35 offen offset:3072 sc1 lds
    s_cmp_gt_u32 s60, s31
    s_cbranch_scc1 Lp4_ok0
    s_load_dword s60, s[8:9], s41 glc
    s_sub_u32 s39, s39, 1
    s_cbranch_scc1 Lbail
    s_waitcnt vmcnt(0)
    ds_read_b128 v[80:83], v4 offset:0
    ds_read_b128 v[84:87], v4 offset:1024
    ds_read_b128 v[88:91], v4 offset:2048
    ds_read_b128 v[92:95], v4 offset:3072
    s_waitcnt lgkmcnt(0)
    v_max_u32 v13, v80, v81
    v_max3_u32 v13, v13, v82, v83
    v_max3_u32 v13, v13, v84, v85
    v_max3_u32 v13, v13, v86, v87
    v_max3_u32 v13, v13, v88, v89
    v_max3_u32 v13, v13, v90, v91
    v_max3_u32 v13, v13, v92, v93
    v_max3_u32 v13, v13, v94, v95
    v_cmp_eq_u32 vcc, -1, v13
    s_nop 0
    s_cbranch_vccnz Lp4_pub0
Lp4_ok0:
    s_waitcnt vmcnt(0)
    ds_read_b64_tr_b16 v[48:49], v5 offset:0
    ds_read_b64_tr_b16 v[50:51], v5 offset:128
    ds_read_b64_tr_b16 v[52:53], v5 offset:1024
    ds_read_b64_tr_b16 v[54:55], v5 offset:1152
    ds_read_b64_tr_b16 v[56:57], v5 offset:2048
    ds_read_b64_tr_b16 v[58:59], v5 offset:2176
    ds_read_b64_tr_b16 v[60:61], v5 offset:3072
    ds_read_b64_tr_b16 v[62:63], v5 offset:3200
    ds_read_b32 v64, v6 offset:8
    ds_read_b32 v65, v6 offset:520
    ds_read_b32 v68, v6 offset:1032
    ds_read_b32 v69, v6 offset:1544
    ds_read_b32 v72, v6 offset:2056
    ds_read_b32 v73, v6 offset:2568
    ds_read_b32 v76, v6 offset:3080
    ds_read_b32 v77, v6 offset:3592
    s_waitcnt lgkmcnt(15)
    v_cndmask_b32 v144, v48, 0, s[42:43]
    v_cndmask_b32 v145, 0, v48, s[42:43]
    v_cndmask_b32 v146, v49, 0, s[42:43]
    v_cndmask_b32 v147, 0, v49, s[42:43]
    s_nop 1
    v_mfma_f32_32x32x16_bf16 v[128:143], v[144:147], a[0:3], 0
    s_waitcnt lgkmcnt(14)
    v_cndmask_b32 v148, v50, 0, s[42:43]
    v_cndmask_b32 v149, 0, v50, s[42:43]
    v_cndmask_b32 v150, v51, 0, s[42:43]
    v_cndmask_b32 v151, 0, v51, s[42:43]
    s_nop 1
    v_mfma_f32_32x32x16_bf16 v[128:143], v[148:151], a[4:7], v[128:143]
    s_waitcnt lgkmcnt(13)
    v_cndmask_b32 v152, v52, 0, s[42:43]
    v_cndmask_b32 v153, 0, v52, s[42:43]
    v_cndmask_b32 v154, v53, 0, s[42:43]
    v_cndmask_b32 v155, 0, v53, s[42:43]
    s_nop 1
    v_mfma_f32_32x32x16_bf16 v[128:143], v[152:155], a[8:11], v[128:143]
    s_waitcnt lgkmcnt(12)
    v_cndmask_b32 v156, v54, 0, s[42:43]
    v_cndmask_b32 v157, 0, v54, s[42:43]
    v_cndmask_b32 v158, v55, 0, s[42:43]
    v_cndmask_b32 v159, 0, v55, s[42:43]
    s_nop 1
    v_mfma_f32_32x32x16_bf16 v[128:143], v[156:159], a[12:15], v[128:143]
    s_waitcnt lgkmcnt(11)
    v_cndmask_b32 v160, v56, 0, s[42:43]
    v_cndmask_b32 v161, 0, v56, s[42:43]
    v_cndmask_b32 v162, v57, 0, s[42:43]
    v_cndmask_b32 v163, 0, v57, s[42:43]
    s_nop 1
    v_mfma_f32_32x32x16_bf16 v[128:143], v[160:163], a[16:19], v[128:143]
    s_waitcnt lgkmcnt(10)
    v_cndmask_b32 v164, v58, 0, s[42:43]
    v_cndmask_b32 v165, 0, v58, s[42:43]
    v_cndmask_b32 v166, v59, 0, s[42:43]
    v_cndmask_b32 v167, 0, v59, s[42:43]
    s_nop 1
    v_mfma_f32_32x32x16_bf16 v[128:143], v[164:167], a[20:23], v[128:143]
    s_waitcnt lgkmcnt(9)
    v_cndmask_b32 v168, v60, 0, s[42:43]
    v_cndmask_b32 v169, 0, v60, s[42:43]
    v_cndmask_b32 v170, v61, 0, s[42:43]
    v_cndmask_b32 v171, 0, v61, s[42:43]
    s_nop 1
    v_mfma_f32_32x32x16_bf16 v[128:143], v[168:171], a[24:27], v[128:143]
    s_waitcnt lgkmcnt(8)
    v_cndmask_b32 v172, v62, 0, s[42:43]
    v_cndmask_b32 v173, 0, v62, s[42:43]
    v_cndmask_b32 v174, v63, 0, s[42:43]
    v_cndmask_b32 v175, 0, v63, s[42:43]
    s_nop 1
    v_mfma_f32_32x32x16_bf16 v[128:143], v[172:175], a[28:31], v[128:143]
    s_nop 11
    v_add_f32 v128, v128, v130
    v_add_f32 v129, v129, v131
    v_add_f32 v130, v132, v134
    v_add_f32 v131, v133, v135
    v_max3_f32 v13, v128, v129, v130
    v_max_f32 v13, v13, v131
    v_mov_b32 v11, v13
    s_nop 1
    v_permlane32_swap_b32 v13, v11
    v_max3_f32 v13, v13, v11, v10
    v_sub_f32 v128, v128, v13
    v_mul_f32 v128, s40, v128
    v_sub_f32 v129, v129, v13
    v_mul_f32 v129, s40, v129
    v_sub_f32 v130, v130, v13
    v_mul_f32 v130, s40, v130
    v_sub_f32 v131, v131, v13
    v_mul_f32 v131, s40, v131
    v_sub_f32 v14, v10, v13
    v_mul_f32 v14, s40, v14
    v_exp_f32 v128, v128
    v_exp_f32 v129, v129
    v_exp_f32 v130, v130
    v_exp_f32 v131, v131
    v_exp_f32 v14, v14
    v_add_f32 v10, v128, v129
    v_add_f32 v11, v130, v131
    v_add_f32 v10, v10, v11
    v_fma_f32 v12, v12, v14, v10
    v_mov_b32 v11, v12
    s_nop 1
    v_permlane32_swap_b32 v12, v11
    v_add_f32 v12, v12, v11
    v_rcp_f32 v12, v12
    s_nop 0
    v_mul_f32 v128, v128, v12
    v_mul_f32 v129, v129, v12
    v_mul_f32 v130, v130, v12
    v_mul_f32 v131, v131, v12
    v_mul_f32 v14, v14, v12
    v_cvt_pk_bf16_f32 v248, v128, v129
    v_cvt_pk_bf16_f32 v249, v130, v131
    v_pk_mul_f32 v[176:177], v[176:177], v[14:15] op_sel_hi:[1,0]
    v_pk_mul_f32 v[178:179], v[178:179], v[14:15] op_sel_hi:[1,0]
    v_pk_mul_f32 v[180:181], v[180:181], v[14:15] op_sel_hi:[1,0]
    v_pk_mul_f32 v[182:183], v[182:183], v[14:15] op_sel_hi:[1,0]
    v_pk_mul_f32 v[184:185], v[184:185], v[14:15] op_sel_hi:[1,0]
    v_pk_mul_f32 v[186:187], v[186:187], v[14:15] op_sel_hi:[1,0]
    v_pk_mul_f32 v[188:189], v[188:189], v[14:15] op_sel_hi:[1,0]
    v_pk_mul_f32 v[190:191], v[190:191], v[14:15] op_sel_hi:[1,0]
    v_pk_mul_f32 v[192:193], v[192:193], v[14:15] op_sel_hi:[1,0]
    v_pk_mul_f32 v[194:195], v[194:195], v[14:15] op_sel_hi:[1,0]
    v_pk_mul_f32 v[196:197], v[196:197], v[14:15] op_sel_hi:[1,0]
    v_pk_mul_f32 v[198:199], v[198:199], v[14:15] op_sel_hi:[1,0]
    v_pk_mul_f32 v[200:201], v[200:201], v[14:15] op_sel_hi:[1,0]
    v_pk_mul_f32 v[202:203], v[202:203], v[14:15] op_sel_hi:[1,0]
    v_pk_mul_f32 v[204:205], v[204:205], v[14:15] op_sel_hi:[1,0]
    v_pk_mul_f32 v[206:207], v[206:207], v[14:15] op_sel_hi:[1,0]
    v_pk_mul_f32 v[208:209], v[208:209], v[14:15] op_sel_hi:[1,0]
    v_pk_mul_f32 v[210:211], v[210:211], v[14:15] op_sel_hi:[1,0]
    v_pk_mul_f32 v[212:213], v[212:213], v[14:15] op_sel_hi:[1,0]
    v_pk_mul_f32 v[214:215], v[214:215], v[14:15] op_sel_hi:[1,0]
    v_pk_mul_f32 v[216:217], v[216:217], v[14:15] op_sel_hi:[1,0]
    v_pk_mul_f32 v[218:219], v[218:219], v[14:15] op_sel_hi:[1,0]
    v_pk_mul_f32 v[220:221], v[220:221], v[14:15] op_sel_hi:[1,0]
    v_pk_mul_f32 v[222:223], v[222:223], v[14:15] op_sel_hi:[1,0]
    v_pk_mul_f32 v[224:225], v[224:225], v[14:15] op_sel_hi:[1,0]
    v_pk_mul_f32 v[226:227], v[226:227], v[14:15] op_sel_hi:[1,0]
    v_pk_mul_f32 v[228:229], v[228:229], v[14:15] op_sel_hi:[1,0]
    v_pk_mul_f32 v[230:231], v[230:231], v[14:15] op_sel_hi:[1,0]
    v_pk_mul_f32 v[232:233], v[232:233], v[14:15] op_sel_hi:[1,0]
    v_pk_mul_f32 v[234:235], v[234:235], v[14:15] op_sel_hi:[1,0]
    v_pk_mul_f32 v[236:237], v[236:237], v[14:15] op_sel_hi:[1,0]
    v_pk_mul_f32 v[238:239], v[238:239], v[14:15] op_sel_hi:[1,0]
    s_waitcnt lgkmcnt(6)
    v_mfma_f32_32x32x16_bf16 v[176:191], v[64:67], v[248:251], v[176:191]
    s_waitcnt lgkmcnt(4)
    v_mfma_f32_32x32x16_bf16 v[192:207], v[68:71], v[248:251], v[192:207]
    s_waitcnt lgkmcnt(2)
    v_mfma_f32_32x32x16_bf16 v[208:223], v[72:75], v[248:251], v[208:223]
    s_waitcnt lgkmcnt(0)
    v_mfma_f32_32x32x16_bf16 v[224:239], v[76:79], v[248:251], v[224:239]
    s_lshl_b32 s35, s30, 13
    s_add_u32 s35, s35, 54525952
    s_add_u32 s36, s35, 4096
    v_cvt_pk_bf16_f32 v16, v176, v177
    v_cvt_pk_bf16_f32 v17, v178, v179
    v_cvt_pk_bf16_f32 v18, v180, v181
    v_cvt_pk_bf16_f32 v19, v182, v183
    v_min_u32 v16, -2, v16
    v_min_u32 v17, -2, v17
    v_min_u32 v18, -2, v18
    v_min_u32 v19, -2, v19
    buffer_store_dwordx4 v[16:19], v0, s[8:11], s35 offen offset:0 sc0 sc1
    v_cvt_pk_bf16_f32 v20, v184, v185
    v_cvt_pk_bf16_f32 v21, v186, v187
    v_cvt_pk_bf16_f32 v22, v188, v189
    v_cvt_pk_bf16_f32 v23, v190, v191
    v_min_u32 v20, -2, v20
    v_min_u32 v21, -2, v21
    v_min_u32 v22, -2, v22
    v_min_u32 v23, -2, v23
    buffer_store_dwordx4 v[20:23], v0, s[8:11], s35 offen offset:1024 sc0 sc1
    v_cvt_pk_bf16_f32 v24, v192, v193
    v_cvt_pk_bf16_f32 v25, v194, v195
    v_cvt_pk_bf16_f32 v26, v196, v197
    v_cvt_pk_bf16_f32 v27, v198, v199
    v_min_u32 v24, -2, v24
    v_min_u32 v25, -2, v25
    v_min_u32 v26, -2, v26
    v_min_u32 v27, -2, v27
    buffer_store_dwordx4 v[24:27], v0, s[8:11], s35 offen offset:2048 sc0 sc1
    v_cvt_pk_bf16_f32 v28, v200, v201
    v_cvt_pk_bf16_f32 v29, v202, v203
    v_cvt_pk_bf16_f32 v30, v204, v205
    v_cvt_pk_bf16_f32 v31, v206, v207
    v_min_u32 v28, -2, v28
    v_min_u32 v29, -2, v29
    v_min_u32 v30, -2, v30
    v_min_u32 v31, -2, v31
    buffer_store_dwordx4 v[28:31], v0, s[8:11], s35 offen offset:3072 sc0 sc1
    v_cvt_pk_bf16_f32 v32, v208, v209
    v_cvt_pk_bf16_f32 v33, v210, v211
    v_cvt_pk_bf16_f32 v34, v212, v213
    v_cvt_pk_bf16_f32 v35, v214, v215
    v_min_u32 v32, -2, v32
    v_min_u32 v33, -2, v33
    v_min_u32 v34, -2, v34
    v_min_u32 v35, -2, v35
    buffer_store_dwordx4 v[32:35], v0, s[8:11], s36 offen offset:0 sc0 sc1
    v_cvt_pk_bf16_f32 v36, v216, v217
    v_cvt_pk_bf16_f32 v37, v218, v219
    v_cvt_pk_bf16_f32 v38, v220, v221
    v_cvt_pk_bf16_f32 v39, v222, v223
    v_min_u32 v36, -2, v36
    v_min_u32 v37, -2, v37
    v_min_u32 v38, -2, v38
    v_min_u32 v39, -2, v39
    buffer_store_dwordx4 v[36:39], v0, s[8:11], s36 offen offset:1024 sc0 sc1
    v_cvt_pk_bf16_f32 v40, v224, v225
    v_cvt_pk_bf16_f32 v41, v226, v227
    v_cvt_pk_bf16_f32 v42, v228, v229
    v_cvt_pk_bf16_f32 v43, v230, v231
    v_min_u32 v40, -2, v40
    v_min_u32 v41, -2, v41
    v_min_u32 v42, -2, v42
    v_min_u32 v43, -2, v43
    buffer_store_dwordx4 v[40:43], v0, s[8:11], s36 offen offset:2048 sc0 sc1
    v_cvt_pk_bf16_f32 v44, v232, v233
    v_cvt_pk_bf16_f32 v45, v234, v235
    v_cvt_pk_bf16_f32 v46, v236, v237
    v_cvt_pk_bf16_f32 v47, v238, v239
    v_min_u32 v44, -2, v44
    v_min_u32 v45, -2, v45
    v_min_u32 v46, -2, v46
    v_min_u32 v47, -2, v47
    buffer_store_dwordx4 v[44:47], v0, s[8:11], s36 offen offset:3072 sc0 sc1
    s_cmp_ge_u32 s31, 61
    s_cbranch_scc1 Lp4_end
    s_waitcnt vmcnt(0)
    s_lshr_b32 s35, s30, 3
    s_lshl_b32 s35, s35, 7
    s_and_b32 s36, s30, 7
    s_lshl_b32 s36, s36, 2
    s_add_u32 s35, s35, s36
    s_add_u32 s35, s35, 102809600
    v_mov_b32 v8, 0
    v_mov_b32 v9, 1
    s_mov_b64 exec, 1
    buffer_store_dword v9, v8, s[8:11], s35 offen sc0 sc1
    s_mov_b64 exec, -1
    s_add_u32 s30, s30, 104
    s_cmp_lt_u32 s30, 2048
    s_cbranch_scc0 Lp4_end
Lp4_loop1:
    s_nop 15
    s_nop 3
    s_waitcnt vmcnt(1)
    s_lshr_b32 s31, s30, 5
    s_and_b32 s32, s30, 31
    v_mfma_f32_32x32x16_bf16 v[112:127], a[128:131], a[96:99], 0
    v_mfma_f32_32x32x16_bf16 v[112:127], a[132:135], a[100:103], v[112:127]
    v_mfma_f32_32x32x16_bf16 v[112:127], a[136:139], a[104:107], v[112:127]
    v_mfma_f32_32x32x16_bf16 v[112:127], a[140:143], a[108:111], v[112:127]
    v_mfma_f32_32x32x16_bf16 v[112:127], a[144:147], a[112:115], v[112:127]
    v_mfma_f32_32x32x16_bf16 v[112:127], a[148:151], a[116:119], v[112:127]
    v_mfma_f32_32x32x16_bf16 v[112:127], a[152:155], a[120:123], v[112:127]
    v_mfma_f32_32x32x16_bf16 v[112:127], a[156:159], a[124:127], v[112:127]
    s_add_u32 s44, s30, 104
    s_min_u32 s44, s44, 2047
    s_cmp_lg_u32 s45, 0
    s_cbranch_scc1 Lp4_f1
    s_lshr_b32 s46, s44, 5
    s_and_b32 s47, s44, 31
    s_mul_hi_u32 s36, s46, 0x55555556
    s_mul_i32 s35, s36, 3
    s_sub_u32 s35, s46, s35
    s_lshl_b32 s35, s35, 7
    s_lshr_b32 s37, s47, 1
    s_lshl_b32 s37, s37, 11
    s_add_u32 s35, s35, s37
    s_add_u32 s35, s35, 102776832
    s_add_u32 s36, s36, 1
    s_mov_b64 exec, 0x7
Lpoll7:
    buffer_load_dword v8, v3, s[8:11], s35 offen sc1
    s_sub_u32 s39, s39, 1
    s_cbranch_scc1 Lbail
    s_waitcnt vmcnt(0)
    v_cmp_gt_u32 vcc, s36, v8
    s_nop 0
    s_cbranch_vccz Lpoll7d
    s_sleep 32
    s_branch Lpoll7
Lpoll7d:
    s_mov_b64 exec, -1
    v_readfirstlane_b32 s46, v8
    s_nop 0
    s_cmp_lt_u32 s46, 64
    s_cbranch_scc1 Lp4_f1
    s_mov_b32 s35, 102776832
    buffer_load_dword v13, v252, s[8:11], s35 offen offset:0 sc1
    buffer_load_dword v14, v252, s[8:11], s35 offen offset:128 sc1
    buffer_load_dword v15, v252, s[8:11], s35 offen offset:256 sc1
    s_waitcnt vmcnt(0)
    v_min3_u32 v8, v13, v14, v15
    v_cmp_gt_u32 vcc, 64, v8
    s_nop 0
    s_cmp_eq_u64 vcc, 0
    s_cselect_b32 s45, 1, 0
Lp4_f1:
    s_lshl_b32 s35, s44, 13
    s_add_u32 s35, s35, 4194304
    s_add_u32 s36, s35, 4096
    buffer_load_dwordx4 a[0:3], v0, s[8:11], s35 offen offset:0 sc1
    buffer_load_dwordx4 a[4:7], v0, s[8:11], s35 offen offset:1024 sc1
    buffer_load_dwordx4 a[8:11], v0, s[8:11], s35 offen offset:2048 sc1
    buffer_load_dwordx4 a[12:15], v0, s[8:11], s35 offen offset:3072 sc1
    buffer_load_dwordx4 a[16:19], v0, s[8:11], s36 offen offset:0 sc1
    buffer_load_dwordx4 a[20:23], v0, s[8:11], s36 offen offset:1024 sc1
    buffer_load_dwordx4 a[24:27], v0, s[8:11], s36 offen offset:2048 sc1
    buffer_load_dwordx4 a[28:31], v0, s[8:11], s36 offen offset:3072 sc1
    s_lshl_b32 s35, s44, 13
    s_add_u32 s35, s35, 20971520
    s_add_u32 s36, s35, 4096
    buffer_load_dwordx4 a[32:35], v2, s[8:11], s35 offen offset:0 sc1
    buffer_load_dwordx4 a[36:39], v2, s[8:11], s35 offen offset:1024 sc1
    buffer_load_dwordx4 a[40:43], v2, s[8:11], s35 offen offset:2048 sc1
    buffer_load_dwordx4 a[44:47], v2, s[8:11], s35 offen offset:3072 sc1
    buffer_load_dwordx4 a[48:51], v2, s[8:11], s36 offen offset:0 sc1
    buffer_load_dwordx4 a[52:55], v2, s[8:11], s36 offen offset:1024 sc1
    buffer_load_dwordx4 a[56:59], v2, s[8:11], s36 offen offset:2048 sc1
    buffer_load_dwordx4 a[60:63], v2, s[8:11], s36 offen offset:3072 sc1
    s_lshl_b32 s35, s44, 13
    s_add_u32 s35, s35, 37748736
    s_add_u32 s36, s35, 4096
    buffer_load_dwordx4 a[64:67], v0, s[8:11], s35 offen offset:0 sc1
    buffer_load_dwordx4 a[68:71], v0, s[8:11], s35 offen offset:1024 sc1
    buffer_load_dwordx4 a[72:75], v0, s[8:11], s35 offen offset:2048 sc1
    buffer_load_dwordx4 a[76:79], v0, s[8:11], s35 offen offset:3072 sc1
    buffer_load_dwordx4 a[80:83], v0, s[8:11], s36 offen offset:0 sc1
    buffer_load_dwordx4 a[84:87], v0, s[8:11], s36 offen offset:1024 sc1
    buffer_load_dwordx4 a[88:91], v0, s[8:11], s36 offen offset:2048 sc1
    buffer_load_dwordx4 a[92:95], v0, s[8:11], s36 offen offset:3072 sc1
    v_mov_b32 v9, 0xd028965f
    v_cmp_gt_i32 vcc, 0, v7
    s_nop 1
    v_cndmask_b32 v112, v112, v9, vcc
    v_cmp_gt_i32 vcc, 1, v7
    s_nop 1
    v_cndmask_b32 v113, v113, v9, vcc
    v_cmp_gt_i32 vcc, 2, v7
    s_nop 1
    v_cndmask_b32 v114, v114, v9, vcc
    v_cmp_gt_i32 vcc, 3, v7
    s_nop 1
    v_cndmask_b32 v115, v115, v9, vcc
    v_cmp_gt_i32 vcc, 8, v7
    s_nop 1
    v_cndmask_b32 v116, v116, v9, vcc
    v_cmp_gt_i32 vcc, 9, v7
    s_nop 1
    v_cndmask_b32 v117, v117, v9, vcc
    v_cmp_gt_i32 vcc, 10, v7
    s_nop 1
    v_cndmask_b32 v118, v118, v9, vcc
    v_cmp_gt_i32 vcc, 11, v7
    s_nop 1
    v_cndmask_b32 v119, v119, v9, vcc
    v_cmp_gt_i32 vcc, 16, v7
    s_nop 1
    v_cndmask_b32 v120, v120, v9, vcc
    v_cmp_gt_i32 vcc, 17, v7
    s_nop 1
    v_cndmask_b32 v121, v121, v9, vcc
    v_cmp_gt_i32 vcc, 18, v7
    s_nop 1
    v_cndmask_b32 v122, v122, v9, vcc
    v_cmp_gt_i32 vcc, 19, v7
    s_nop 1
    v_cndmask_b32 v123, v123, v9, vcc
    v_cmp_gt_i32 vcc, 24, v7
    s_nop 1
    v_cndmask_b32 v124, v124, v9, vcc
    v_cmp_gt_i32 vcc, 25, v7
    s_nop 1
    v_cndmask_b32 v125, v125, v9, vcc
    v_cmp_gt_i32 vcc, 26, v7
    s_nop 1
    v_cndmask_b32 v126, v126, v9, vcc
    v_cmp_gt_i32 vcc, 27, v7
    s_nop 1
    v_cndmask_b32 v127, v127, v9, vcc
    v_max3_f32 v10, v112, v113, v114
    v_max3_f32 v10, v10, v115, v116
    v_max3_f32 v10, v10, v117, v118
    v_max3_f32 v10, v10, v119, v120
    v_max3_f32 v10, v10, v121, v122
    v_max3_f32 v10, v10, v123, v124
    v_max3_f32 v10, v10, v125, v126
    v_max_f32 v10, v10, v127
    v_mov_b32 v11, v10
    s_nop 1
    v_permlane32_swap_b32 v10, v11
    v_max_f32 v10, v10, v11
    v_sub_f32 v112, v112, v10
    v_mul_f32 v112, s40, v112
    v_sub_f32 v113, v113, v10
    v_mul_f32 v113, s40, v113
    v_sub_f32 v114, v114, v10
    v_mul_f32 v114, s40, v114
    v_sub_f32 v115, v115, v10
    v_mul_f32 v115, s40, v115
    v_sub_f32 v116, v116, v10
    v_mul_f32 v116, s40, v116
    v_sub_f32 v117, v117, v10
    v_mul_f32 v117, s40, v117
    v_sub_f32 v118, v118, v10
    v_mul_f32 v118, s40, v118
    v_sub_f32 v119, v119, v10
    v_mul_f32 v119, s40, v119
    v_sub_f32 v120, v120, v10
    v_mul_f32 v120, s40, v120
    v_sub_f32 v121, v121, v10
    v_mul_f32 v121, s40, v121
    v_sub_f32 v122, v122, v10
    v_mul_f32 v122, s40, v122
    v_sub_f32 v123, v123, v10
    v_mul_f32 v123, s40, v123
    v_sub_f32 v124, v124, v10
    v_mul_f32 v124, s40, v124
    v_sub_f32 v125, v125, v10
    v_mul_f32 v125, s40, v125
    v_sub_f32 v126, v126, v10
    v_mul_f32 v126, s40, v126
    v_sub_f32 v127, v127, v10
    v_mul_f32 v127, s40, v127
    v_exp_f32 v112, v112
    v_exp_f32 v113, v113
    v_exp_f32 v114, v114
    v_exp_f32 v115, v115
    v_exp_f32 v116, v116
    v_exp_f32 v117, v117
    v_exp_f32 v118, v118
    v_exp_f32 v119, v119
    v_exp_f32 v120, v120
    v_exp_f32 v121, v121
    v_exp_f32 v122, v122
    v_exp_f32 v123, v123
    v_exp_f32 v124, v124
    v_exp_f32 v125, v125
    v_exp_f32 v126, v126
    v_exp_f32 v127, v127
    v_add_f32 v12, v112, v116
    v_add_f32 v13, v113, v117
    v_add_f32 v14, v114, v118
    v_add_f32 v15, v115, v119
    v_add_f32 v12, v12, v120
    v_add_f32 v13, v13, v121
    v_add_f32 v14, v14, v122
    v_add_f32 v15, v15, v123
    v_add_f32 v12, v12, v124
    v_add_f32 v13, v13, v125
    v_add_f32 v14, v14, v126
    v_add_f32 v15, v15, v127
    v_add_f32 v12, v12, v13
    v_add_f32 v14, v14, v15
    v_add_f32 v12, v12, v14
    v_cvt_pk_bf16_f32 v240, v112, v113
    v_cvt_pk_bf16_f32 v241, v114, v115
    v_cvt_pk_bf16_f32 v242, v116, v117
    v_cvt_pk_bf16_f32 v243, v118, v119
    v_cvt_pk_bf16_f32 v244, v120, v121
    v_cvt_pk_bf16_f32 v245, v122, v123
    v_cvt_pk_bf16_f32 v246, v124, v125
    v_cvt_pk_bf16_f32 v247, v126, v127
    v_mov_b64 v[250:251], 0
    v_mfma_f32_32x32x16_bf16 v[176:191], a[160:163], v[240:243], 0
    v_mfma_f32_32x32x16_bf16 v[176:191], a[164:167], v[244:247], v[176:191]
    v_mfma_f32_32x32x16_bf16 v[192:207], a[168:171], v[240:243], 0
    v_mfma_f32_32x32x16_bf16 v[192:207], a[172:175], v[244:247], v[192:207]
    v_mfma_f32_32x32x16_bf16 v[208:223], a[176:179], v[240:243], 0
    v_mfma_f32_32x32x16_bf16 v[208:223], a[180:183], v[244:247], v[208:223]
    v_mfma_f32_32x32x16_bf16 v[224:239], a[184:187], v[240:243], 0
    v_mfma_f32_32x32x16_bf16 v[224:239], a[188:191], v[244:247], v[224:239]
    v_mov_b64 v[66:67], 0
    v_mov_b64 v[70:71], 0
    v_mov_b64 v[74:75], 0
    v_mov_b64 v[78:79], 0
    s_lshl_b32 s35, s32, 7
    s_add_u32 s35, s35, 102764544
    s_mov_b32 s41, s35
    s_cmp_lt_u32 s31, 58
    s_addc_u32 s36, s31, 0
    s_min_u32 s36, s36, 62
    s_lshl_b32 s35, s30, 12
    s_add_u32 s35, s35, 92274688
    s_mov_b32 m0, s38
Lsp8:
    s_load_dword s60, s[8:9], s41 glc
    s_sub_u32 s39, s39, 1
    s_cbranch_scc1 Lbail
    s_waitcnt lgkmcnt(0)
    s_cmp_ge_u32 s60, s36
    s_cbranch_scc1 Lsp8d
    s_sleep 1
    s_branch Lsp8
Lsp8d:
Lp4_pub1:
    buffer_load_dwordx4 v0, s[8:11], s35 offen offset:0 sc1 lds
    buffer_load_dwordx4 v0, s[8:11], s35 offen offset:1024 sc1 lds
    buffer_load_dwordx4 v0, s[8:11], s35 offen offset:2048 sc1 lds
    buffer_load_dwordx4 v0, s[8:11], s35 offen offset:3072 sc1 lds
    s_cmp_gt_u32 s60, s31
    s_cbranch_scc1 Lp4_ok1
    s_load_dword s60, s[8:9], s41 glc
    s_sub_u32 s39, s39, 1
    s_cbranch_scc1 Lbail
    s_waitcnt vmcnt(0)
    ds_read_b128 v[80:83], v4 offset:0
    ds_read_b128 v[84:87], v4 offset:1024
    ds_read_b128 v[88:91], v4 offset:2048
    ds_read_b128 v[92:95], v4 offset:3072
    s_waitcnt lgkmcnt(0)
    v_max_u32 v13, v80, v81
    v_max3_u32 v13, v13, v82, v83
    v_max3_u32 v13, v13, v84, v85
    v_max3_u32 v13, v13, v86, v87
    v_max3_u32 v13, v13, v88, v89
    v_max3_u32 v13, v13, v90, v91
    v_max3_u32 v13, v13, v92, v93
    v_max3_u32 v13, v13, v94, v95
    v_cmp_eq_u32 vcc, -1, v13
    s_nop 0
    s_cbranch_vccnz Lp4_pub1
Lp4_ok1:
    s_waitcnt vmcnt(0)
    ds_read_b64_tr_b16 v[48:49], v5 offset:0
    ds_read_b64_tr_b16 v[50:51], v5 offset:128
    ds_read_b64_tr_b16 v[52:53], v5 offset:1024
    ds_read_b64_tr_b16 v[54:55], v5 offset:1152
    ds_read_b64_tr_b16 v[56:57], v5 offset:2048
    ds_read_b64_tr_b16 v[58:59], v5 offset:2176
    ds_read_b64_tr_b16 v[60:61], v5 offset:3072
    ds_read_b64_tr_b16 v[62:63], v5 offset:3200
    ds_read_b32 v64, v6 offset:8
    ds_read_b32 v65, v6 offset:520
    ds_read_b32 v68, v6 offset:1032
    ds_read_b32 v69, v6 offset:1544
    ds_read_b32 v72, v6 offset:2056
    ds_read_b32 v73, v6 offset:2568
    ds_read_b32 v76, v6 offset:3080
    ds_read_b32 v77, v6 offset:3592
    s_waitcnt lgkmcnt(15)
    v_cndmask_b32 v144, v48, 0, s[42:43]
    v_cndmask_b32 v145, 0, v48, s[42:43]
    v_cndmask_b32 v146, v49, 0, s[42:43]
    v_cndmask_b32 v147, 0, v49, s[42:43]
    s_nop 1
    v_mfma_f32_32x32x16_bf16 v[128:143], v[144:147], a[96:99], 0
    s_waitcnt lgkmcnt(14)
    v_cndmask_b32 v148, v50, 0, s[42:43]
    v_cndmask_b32 v149, 0, v50, s[42:43]
    v_cndmask_b32 v150, v51, 0, s[42:43]
    v_cndmask_b32 v151, 0, v51, s[42:43]
    s_nop 1
    v_mfma_f32_32x32x16_bf16 v[128:143], v[148:151], a[100:103], v[128:143]
    s_waitcnt lgkmcnt(13)
    v_cndmask_b32 v152, v52, 0, s[42:43]
    v_cndmask_b32 v153, 0, v52, s[42:43]
    v_cndmask_b32 v154, v53, 0, s[42:43]
    v_cndmask_b32 v155, 0, v53, s[42:43]
    s_nop 1
    v_mfma_f32_32x32x16_bf16 v[128:143], v[152:155], a[104:107], v[128:143]
    s_waitcnt lgkmcnt(12)
    v_cndmask_b32 v156, v54, 0, s[42:43]
    v_cndmask_b32 v157, 0, v54, s[42:43]
    v_cndmask_b32 v158, v55, 0, s[42:43]
    v_cndmask_b32 v159, 0, v55, s[42:43]
    s_nop 1
    v_mfma_f32_32x32x16_bf16 v[128:143], v[156:159], a[108:111], v[128:143]
    s_waitcnt lgkmcnt(11)
    v_cndmask_b32 v160, v56, 0, s[42:43]
    v_cndmask_b32 v161, 0, v56, s[42:43]
    v_cndmask_b32 v162, v57, 0, s[42:43]
    v_cndmask_b32 v163, 0, v57, s[42:43]
    s_nop 1
    v_mfma_f32_32x32x16_bf16 v[128:143], v[160:163], a[112:115], v[128:143]
    s_waitcnt lgkmcnt(10)
    v_cndmask_b32 v164, v58, 0, s[42:43]
    v_cndmask_b32 v165, 0, v58, s[42:43]
    v_cndmask_b32 v166, v59, 0, s[42:43]
    v_cndmask_b32 v167, 0, v59, s[42:43]
    s_nop 1
    v_mfma_f32_32x32x16_bf16 v[128:143], v[164:167], a[116:119], v[128:143]
    s_waitcnt lgkmcnt(9)
    v_cndmask_b32 v168, v60, 0, s[42:43]
    v_cndmask_b32 v169, 0, v60, s[42:43]
    v_cndmask_b32 v170, v61, 0, s[42:43]
    v_cndmask_b32 v171, 0, v61, s[42:43]
    s_nop 1
    v_mfma_f32_32x32x16_bf16 v[128:143], v[168:171], a[120:123], v[128:143]
    s_waitcnt lgkmcnt(8)
    v_cndmask_b32 v172, v62, 0, s[42:43]
    v_cndmask_b32 v173, 0, v62, s[42:43]
    v_cndmask_b32 v174, v63, 0, s[42:43]
    v_cndmask_b32 v175, 0, v63, s[42:43]
    s_nop 1
    v_mfma_f32_32x32x16_bf16 v[128:143], v[172:175], a[124:127], v[128:143]
    s_nop 11
    v_add_f32 v128, v128, v130
    v_add_f32 v129, v129, v131
    v_add_f32 v130, v132, v134
    v_add_f32 v131, v133, v135
    v_max3_f32 v13, v128, v129, v130
    v_max_f32 v13, v13, v131
    v_mov_b32 v11, v13
    s_nop 1
    v_permlane32_swap_b32 v13, v11
    v_max3_f32 v13, v13, v11, v10
    v_sub_f32 v128, v128, v13
    v_mul_f32 v128, s40, v128
    v_sub_f32 v129, v129, v13
    v_mul_f32 v129, s40, v129
    v_sub_f32 v130, v130, v13
    v_mul_f32 v130, s40, v130
    v_sub_f32 v131, v131, v13
    v_mul_f32 v131, s40, v131
    v_sub_f32 v14, v10, v13
    v_mul_f32 v14, s40, v14
    v_exp_f32 v128, v128
    v_exp_f32 v129, v129
    v_exp_f32 v130, v130
    v_exp_f32 v131, v131
    v_exp_f32 v14, v14
    v_add_f32 v10, v128, v129
    v_add_f32 v11, v130, v131
    v_add_f32 v10, v10, v11
    v_fma_f32 v12, v12, v14, v10
    v_mov_b32 v11, v12
    s_nop 1
    v_permlane32_swap_b32 v12, v11
    v_add_f32 v12, v12, v11
    v_rcp_f32 v12, v12
    s_nop 0
    v_mul_f32 v128, v128, v12
    v_mul_f32 v129, v129, v12
    v_mul_f32 v130, v130, v12
    v_mul_f32 v131, v131, v12
    v_mul_f32 v14, v14, v12
    v_cvt_pk_bf16_f32 v248, v128, v129
    v_cvt_pk_bf16_f32 v249, v130, v131
    v_pk_mul_f32 v[176:177], v[176:177], v[14:15] op_sel_hi:[1,0]
    v_pk_mul_f32 v[178:179], v[178:179], v[14:15] op_sel_hi:[1,0]
    v_pk_mul_f32 v[180:181], v[180:181], v[14:15] op_sel_hi:[1,0]
    v_pk_mul_f32 v[182:183], v[182:183], v[14:15] op_sel_hi:[1,0]
    v_pk_mul_f32 v[184:185], v[184:185], v[14:15] op_sel_hi:[1,0]
    v_pk_mul_f32 v[186:187], v[186:187], v[14:15] op_sel_hi:[1,0]
    v_pk_mul_f32 v[188:189], v[188:189], v[14:15] op_sel_hi:[1,0]
    v_pk_mul_f32 v[190:191], v[190:191], v[14:15] op_sel_hi:[1,0]
    v_pk_mul_f32 v[192:193], v[192:193], v[14:15] op_sel_hi:[1,0]
    v_pk_mul_f32 v[194:195], v[194:195], v[14:15] op_sel_hi:[1,0]
    v_pk_mul_f32 v[196:197], v[196:197], v[14:15] op_sel_hi:[1,0]
    v_pk_mul_f32 v[198:199], v[198:199], v[14:15] op_sel_hi:[1,0]
    v_pk_mul_f32 v[200:201], v[200:201], v[14:15] op_sel_hi:[1,0]
    v_pk_mul_f32 v[202:203], v[202:203], v[14:15] op_sel_hi:[1,0]
    v_pk_mul_f32 v[204:205], v[204:205], v[14:15] op_sel_hi:[1,0]
    v_pk_mul_f32 v[206:207], v[206:207], v[14:15] op_sel_hi:[1,0]
    v_pk_mul_f32 v[208:209], v[208:209], v[14:15] op_sel_hi:[1,0]
    v_pk_mul_f32 v[210:211], v[210:211], v[14:15] op_sel_hi:[1,0]
    v_pk_mul_f32 v[212:213], v[212:213], v[14:15] op_sel_hi:[1,0]
    v_pk_mul_f32 v[214:215], v[214:215], v[14:15] op_sel_hi:[1,0]
    v_pk_mul_f32 v[216:217], v[216:217], v[14:15] op_sel_hi:[1,0]
    v_pk_mul_f32 v[218:219], v[218:219], v[14:15] op_sel_hi:[1,0]
    v_pk_mul_f32 v[220:221], v[220:221], v[14:15] op_sel_hi:[1,0]
    v_pk_mul_f32 v[222:223], v[222:223], v[14:15] op_sel_hi:[1,0]
    v_pk_mul_f32 v[224:225], v[224:225], v[14:15] op_sel_hi:[1,0]
    v_pk_mul_f32 v[226:227], v[226:227], v[14:15] op_sel_hi:[1,0]
    v_pk_mul_f32 v[228:229], v[228:229], v[14:15] op_sel_hi:[1,0]
    v_pk_mul_f32 v[230:231], v[230:231], v[14:15] op_sel_hi:[1,0]
    v_pk_mul_f32 v[232:233], v[232:233], v[14:15] op_sel_hi:[1,0]
    v_pk_mul_f32 v[234:235], v[234:235], v[14:15] op_sel_hi:[1,0]
    v_pk_mul_f32 v[236:237], v[236:237], v[14:15] op_sel_hi:[1,0]
    v_pk_mul_f32 v[238:239], v[238:239], v[14:15] op_sel_hi:[1,0]
    s_waitcnt lgkmcnt(6)
    v_mfma_f32_32x32x16_bf16 v[176:191], v[64:67], v[248:251], v[176:191]
    s_waitcnt lgkmcnt(4)
    v_mfma_f32_32x32x16_bf16 v[192:207], v[68:71], v[248:251], v[192:207]
    s_waitcnt lgkmcnt(2)
    v_mfma_f32_32x32x16_bf16 v[208:223], v[72:75], v[248:251], v[208:223]
    s_waitcnt lgkmcnt(0)
    v_mfma_f32_32x32x16_bf16 v[224:239], v[76:79], v[248:251], v[224:239]
    s_lshl_b32 s35, s30, 13
    s_add_u32 s35, s35, 54525952
    s_add_u32 s36, s35, 4096
    v_cvt_pk_bf16_f32 v16, v176, v177
    v_cvt_pk_bf16_f32 v17, v178, v179
    v_cvt_pk_bf16_f32 v18, v180, v181
    v_cvt_pk_bf16_f32 v19, v182, v183
    v_min_u32 v16, -2, v16
    v_min_u32 v17, -2, v17
    v_min_u32 v18, -2, v18
    v_min_u32 v19, -2, v19
    buffer_store_dwordx4 v[16:19], v0, s[8:11], s35 offen offset:0 sc0 sc1
    v_cvt_pk_bf16_f32 v20, v184, v185
    v_cvt_pk_bf16_f32 v21, v186, v187
    v_cvt_pk_bf16_f32 v22, v188, v189
    v_cvt_pk_bf16_f32 v23, v190, v191
    v_min_u32 v20, -2, v20
    v_min_u32 v21, -2, v21
    v_min_u32 v22, -2, v22
    v_min_u32 v23, -2, v23
    buffer_store_dwordx4 v[20:23], v0, s[8:11], s35 offen offset:1024 sc0 sc1
    v_cvt_pk_bf16_f32 v24, v192, v193
    v_cvt_pk_bf16_f32 v25, v194, v195
    v_cvt_pk_bf16_f32 v26, v196, v197
    v_cvt_pk_bf16_f32 v27, v198, v199
    v_min_u32 v24, -2, v24
    v_min_u32 v25, -2, v25
    v_min_u32 v26, -2, v26
    v_min_u32 v27, -2, v27
    buffer_store_dwordx4 v[24:27], v0, s[8:11], s35 offen offset:2048 sc0 sc1
    v_cvt_pk_bf16_f32 v28, v200, v201
    v_cvt_pk_bf16_f32 v29, v202, v203
    v_cvt_pk_bf16_f32 v30, v204, v205
    v_cvt_pk_bf16_f32 v31, v206, v207
    v_min_u32 v28, -2, v28
    v_min_u32 v29, -2, v29
    v_min_u32 v30, -2, v30
    v_min_u32 v31, -2, v31
    buffer_store_dwordx4 v[28:31], v0, s[8:11], s35 offen offset:3072 sc0 sc1
    v_cvt_pk_bf16_f32 v32, v208, v209
    v_cvt_pk_bf16_f32 v33, v210, v211
    v_cvt_pk_bf16_f32 v34, v212, v213
    v_cvt_pk_bf16_f32 v35, v214, v215
    v_min_u32 v32, -2, v32
    v_min_u32 v33, -2, v33
    v_min_u32 v34, -2, v34
    v_min_u32 v35, -2, v35
    buffer_store_dwordx4 v[32:35], v0, s[8:11], s36 offen offset:0 sc0 sc1
    v_cvt_pk_bf16_f32 v36, v216, v217
    v_cvt_pk_bf16_f32 v37, v218, v219
    v_cvt_pk_bf16_f32 v38, v220, v221
    v_cvt_pk_bf16_f32 v39, v222, v223
    v_min_u32 v36, -2, v36
    v_min_u32 v37, -2, v37
    v_min_u32 v38, -2, v38
    v_min_u32 v39, -2, v39
    buffer_store_dwordx4 v[36:39], v0, s[8:11], s36 offen offset:1024 sc0 sc1
    v_cvt_pk_bf16_f32 v40, v224, v225
    v_cvt_pk_bf16_f32 v41, v226, v227
    v_cvt_pk_bf16_f32 v42, v228, v229
    v_cvt_pk_bf16_f32 v43, v230, v231
    v_min_u32 v40, -2, v40
    v_min_u32 v41, -2, v41
    v_min_u32 v42, -2, v42
    v_min_u32 v43, -2, v43
    buffer_store_dwordx4 v[40:43], v0, s[8:11], s36 offen offset:2048 sc0 sc1
    v_cvt_pk_bf16_f32 v44, v232, v233
    v_cvt_pk_bf16_f32 v45, v234, v235
    v_cvt_pk_bf16_f32 v46, v236, v237
    v_cvt_pk_bf16_f32 v47, v238, v239
    v_min_u32 v44, -2, v44
    v_min_u32 v45, -2, v45
    v_min_u32 v46, -2, v46
    v_min_u32 v47, -2, v47
    buffer_store_dwordx4 v[44:47], v0, s[8:11], s36 offen offset:3072 sc0 sc1
    s_cmp_ge_u32 s31, 61
    s_cbranch_scc1 Lp4_end
    s_waitcnt vmcnt(0)
    s_lshr_b32 s35, s30, 3
    s_lshl_b32 s35, s35, 7
    s_and_b32 s36, s30, 7
    s_lshl_b32 s36, s36, 2
    s_add_u32 s35, s35, s36
    s_add_u32 s35, s35, 102809600
    v_mov_b32 v8, 0
    v_mov_b32 v9, 1
    s_mov_b64 exec, 1
    buffer_store_dword v9, v8, s[8:11], s35 offen sc0 sc1
    s_mov_b64 exec, -1
    s_add_u32 s30, s30, 104
    s_cmp_lt_u32 s30, 2048
    s_cbranch_scc1 Lp4_loop0
Lp4_end:
    s_endpgm
Lgemm:
    s_mul_hi_u32 s30, s28, 0x55555556
    s_mul_i32 s35, s30, 3
    s_sub_u32 s31, s28, s35
    s_lshl_b32 s38, s29, 15
    s_lshr_b32 s43, s30, 4
    s_min_u32 s43, s43, 3
    s_load_dwordx4 s[44:47], s[0:1], 16
    s_load_dwordx2 s[48:49], s[0:1], 32
    s_load_dwordx2 s[50:51], s[0:1], 64
    s_mov_b32 s15, 0x20000
    s_waitcnt lgkmcnt(0)
    s_cmp_eq_u32 s43, 3
    s_cbranch_scc1 Lga_h
    s_cmp_eq_u32 s43, 0
    s_cselect_b64 s[12:13], s[46:47], s[48:49]
    s_cmp_eq_u32 s43, 2
    s_cselect_b64 s[12:13], s[44:45], s[12:13]
    s_mov_b32 s14, 4718592
    s_and_b32 s35, s30, 15
    s_lshl_b32 s36, s35, 9
    s_lshl_b32 s44, s29, 7
    s_add_u32 s44, s44, s36
    v_lshrrev_b32 v4, 3, v1
    s_mov_b32 s35, 8192
    v_mul_lo_u32 v2, v4, s35
    v_and_b32 v4, 7, v1
    v_lshl_add_u32 v2, v4, 4, v2
    v_bfe_u32 v4, v1, 5, 1
    v_lshlrev_b32 v3, 10, v4
    v_bfe_u32 v4, v1, 2, 2
    v_lshl_add_u32 v3, v4, 7, v3
    v_bfe_u32 v4, v1, 4, 1
    v_lshl_add_u32 v3, v4, 5, v3
    v_bfe_u32 v4, v1, 0, 2
    v_lshl_add_u32 v3, v4, 3, v3
    v_add_u32 v3, s38, v3
    s_add_u32 m0, s38, 0
    s_add_u32 s35, s44, 0
    buffer_load_dwordx4 v2, s[12:15], s35 offen lds
    s_add_u32 m0, s38, 1024
    s_add_u32 s35, s44, 65536
    buffer_load_dwordx4 v2, s[12:15], s35 offen lds
    s_add_u32 m0, s38, 2048
    s_add_u32 s35, s44, 131072
    buffer_load_dwordx4 v2, s[12:15], s35 offen lds
    s_add_u32 m0, s38, 3072
    s_add_u32 s35, s44, 196608
    buffer_load_dwordx4 v2, s[12:15], s35 offen lds
    s_add_u32 m0, s38, 4096
    s_add_u32 s35, s44, 262144
    buffer_load_dwordx4 v2, s[12:15], s35 offen lds
    s_add_u32 m0, s38, 5120
    s_add_u32 s35, s44, 327680
    buffer_load_dwordx4 v2, s[12:15], s35 offen lds
    s_add_u32 m0, s38, 6144
    s_add_u32 s35, s44, 393216
    buffer_load_dwordx4 v2, s[12:15], s35 offen lds
    s_add_u32 m0, s38, 7168
    s_add_u32 s35, s44, 458752
    buffer_load_dwordx4 v2, s[12:15], s35 offen lds
    s_add_u32 m0, s38, 8192
    s_add_u32 s35, s44, 524288
    buffer_load_dwordx4 v2, s[12:15], s35 offen lds
    s_add_u32 m0, s38, 9216
    s_add_u32 s35, s44, 589824
    buffer_load_dwordx4 v2, s[12:15], s35 offen lds
    s_add_u32 m0, s38, 10240
    s_add_u32 s35, s44, 655360
    buffer_load_dwordx4 v2, s[12:15], s35 offen lds
    s_add_u32 m0, s38, 11264
    s_add_u32 s35, s44, 720896
    buffer_load_dwordx4 v2, s[12:15], s35 offen lds
    s_add_u32 m0, s38, 12288
    s_add_u32 s35, s44, 786432
    buffer_load_dwordx4 v2, s[12:15], s35 offen lds
    s_add_u32 m0, s38, 13312
    s_add_u32 s35, s44, 851968
    buffer_load_dwordx4 v2, s[12:15], s35 offen lds
    s_add_u32 m0, s38, 14336
    s_add_u32 s35, s44, 917504
    buffer_load_dwordx4 v2, s[12:15], s35 offen lds
    s_add_u32 m0, s38, 15360
    s_add_u32 s35, s44, 983040
    buffer_load_dwordx4 v2, s[12:15], s35 offen lds
    s_waitcnt vmcnt(12)
    ds_read_b64_tr_b16 a[0:1], v3 offset:0
    ds_read_b64_tr_b16 a[2:3], v3 offset:512
    ds_read_b64_tr_b16 a[4:5], v3 offset:64
    ds_read_b64_tr_b16 a[6:7], v3 offset:576
    ds_read_b64_tr_b16 a[8:9], v3 offset:2048
    ds_read_b64_tr_b16 a[10:11], v3 offset:2560
    ds_read_b64_tr_b16 a[12:13], v3 offset:2112
    ds_read_b64_tr_b16 a[14:15], v3 offset:2624
    s_waitcnt lgkmcnt(0)
    s_add_u32 m0, s38, 16384
    s_add_u32 s35, s44, 1048576
    buffer_load_dwordx4 v2, s[12:15], s35 offen lds
    s_add_u32 m0, s38, 17408
    s_add_u32 s35, s44, 1114112
    buffer_load_dwordx4 v2, s[12:15], s35 offen lds
    s_add_u32 m0, s38, 18432
    s_add_u32 s35, s44, 1179648
    buffer_load_dwordx4 v2, s[12:15], s35 offen lds
    s_add_u32 m0, s38, 19456
    s_add_u32 s35, s44, 1245184
    buffer_load_dwordx4 v2, s[12:15], s35 offen lds
    s_waitcnt vmcnt(12)
    ds_read_b64_tr_b16 a[16:17], v3 offset:4096
    ds_read_b64_tr_b16 a[18:19], v3 offset:4608
    ds_read_b64_tr_b16 a[20:21], v3 offset:4160
    ds_read_b64_tr_b16 a[22:23], v3 offset:4672
    ds_read_b64_tr_b16 a[24:25], v3 offset:6144
    ds_read_b64_tr_b16 a[26:27], v3 offset:6656
    ds_read_b64_tr_b16 a[28:29], v3 offset:6208
    ds_read_b64_tr_b16 a[30:31], v3 offset:6720
    s_waitcnt lgkmcnt(0)
    s_add_u32 m0, s38, 20480
    s_add_u32 s35, s44, 1310720
    buffer_load_dwordx4 v2, s[12:15], s35 offen lds
    s_add_u32 m0, s38, 21504
    s_add_u32 s35, s44, 1376256
    buffer_load_dwordx4 v2, s[12:15], s35 offen lds
    s_add_u32 m0, s38, 22528
    s_add_u32 s35, s44, 1441792
    buffer_load_dwordx4 v2, s[12:15], s35 offen lds
    s_add_u32 m0, s38, 23552
    s_add_u32 s35, s44, 1507328
    buffer_load_dwordx4 v2, s[12:15], s35 offen lds
    s_waitcnt vmcnt(12)
    ds_read_b64_tr_b16 a[32:33], v3 offset:8192
    ds_read_b64_tr_b16 a[34:35], v3 offset:8704
    ds_read_b64_tr_b16 a[36:37], v3 offset:8256
    ds_read_b64_tr_b16 a[38:39], v3 offset:8768
    ds_read_b64_tr_b16 a[40:41], v3 offset:10240
    ds_read_b64_tr_b16 a[42:43], v3 offset:10752
    ds_read_b64_tr_b16 a[44:45], v3 offset:10304
    ds_read_b64_tr_b16 a[46:47], v3 offset:10816
    s_waitcnt lgkmcnt(0)
    s_add_u32 m0, s38, 24576
    s_add_u32 s35, s44, 1572864
    buffer_load_dwordx4 v2, s[12:15], s35 offen lds
    s_add_u32 m0, s38, 25600
    s_add_u32 s35, s44, 1638400
    buffer_load_dwordx4 v2, s[12:15], s35 offen lds
    s_add_u32 m0, s38, 26624
    s_add_u32 s35, s44, 1703936
    buffer_load_dwordx4 v2, s[12:15], s35 offen lds
    s_add_u32 m0, s38, 27648
    s_add_u32 s35, s44, 1769472
    buffer_load_dwordx4 v2, s[12:15], s35 offen lds
    s_waitcnt vmcnt(12)
    ds_read_b64_tr_b16 a[48:49], v3 offset:12288
    ds_read_b64_tr_b16 a[50:51], v3 offset:12800
    ds_read_b64_tr_b16 a[52:53], v3 offset:12352
    ds_read_b64_tr_b16 a[54:55], v3 offset:12864
    ds_read_b64_tr_b16 a[56:57], v3 offset:14336
    ds_read_b64_tr_b16 a[58:59], v3 offset:14848
    ds_read_b64_tr_b16 a[60:61], v3 offset:14400
    ds_read_b64_tr_b16 a[62:63], v3 offset:14912
    s_waitcnt lgkmcnt(0)
    s_add_u32 m0, s38, 28672
    s_add_u32 s35, s44, 1835008
    buffer_load_dwordx4 v2, s[12:15], s35 offen lds
    s_add_u32 m0, s38, 29696
    s_add_u32 s35, s44, 1900544
    buffer_load_dwordx4 v2, s[12:15], s35 offen lds
    s_add_u32 m0, s38, 30720
    s_add_u32 s35, s44, 1966080
    buffer_load_dwordx4 v2, s[12:15], s35 offen lds
    s_add_u32 m0, s38, 31744
    s_add_u32 s35, s44, 2031616
    buffer_load_dwordx4 v2, s[12:15], s35 offen lds
    s_waitcnt vmcnt(12)
    ds_read_b64_tr_b16 a[64:65], v3 offset:16384
    ds_read_b64_tr_b16 a[66:67], v3 offset:16896
    ds_read_b64_tr_b16 a[68:69], v3 offset:16448
    ds_read_b64_tr_b16 a[70:71], v3 offset:16960
    ds_read_b64_tr_b16 a[72:73], v3 offset:18432
    ds_read_b64_tr_b16 a[74:75], v3 offset:18944
    ds_read_b64_tr_b16 a[76:77], v3 offset:18496
    ds_read_b64_tr_b16 a[78:79], v3 offset:19008
    s_waitcnt lgkmcnt(0)
    s_add_u32 m0, s38, 0
    s_add_u32 s35, s44, 2097152
    buffer_load_dwordx4 v2, s[12:15], s35 offen lds
    s_add_u32 m0, s38, 1024
    s_add_u32 s35, s44, 2162688
    buffer_load_dwordx4 v2, s[12:15], s35 offen lds
    s_add_u32 m0, s38, 2048
    s_add_u32 s35, s44, 2228224
    buffer_load_dwordx4 v2, s[12:15], s35 offen lds
    s_add_u32 m0, s38, 3072
    s_add_u32 s35, s44, 2293760
    buffer_load_dwordx4 v2, s[12:15], s35 offen lds
    s_waitcnt vmcnt(12)
    ds_read_b64_tr_b16 a[80:81], v3 offset:20480
    ds_read_b64_tr_b16 a[82:83], v3 offset:20992
    ds_read_b64_tr_b16 a[84:85], v3 offset:20544
    ds_read_b64_tr_b16 a[86:87], v3 offset:21056
    ds_read_b64_tr_b16 a[88:89], v3 offset:22528
    ds_read_b64_tr_b16 a[90:91], v3 offset:23040
    ds_read_b64_tr_b16 a[92:93], v3 offset:22592
    ds_read_b64_tr_b16 a[94:95], v3 offset:23104
    s_waitcnt lgkmcnt(0)
    s_add_u32 m0, s38, 4096
    s_add_u32 s35, s44, 2359296
    buffer_load_dwordx4 v2, s[12:15], s35 offen lds
    s_add_u32 m0, s38, 5120
    s_add_u32 s35, s44, 2424832
    buffer_load_dwordx4 v2, s[12:15], s35 offen lds
    s_add_u32 m0, s38, 6144
    s_add_u32 s35, s44, 2490368
    buffer_load_dwordx4 v2, s[12:15], s35 offen lds
    s_add_u32 m0, s38, 7168
    s_add_u32 s35, s44, 2555904
    buffer_load_dwordx4 v2, s[12:15], s35 offen lds
    s_waitcnt vmcnt(12)
    ds_read_b64_tr_b16 a[96:97], v3 offset:24576
    ds_read_b64_tr_b16 a[98:99], v3 offset:25088
    ds_read_b64_tr_b16 a[100:101], v3 offset:24640
    ds_read_b64_tr_b16 a[102:103], v3 offset:25152
    ds_read_b64_tr_b16 a[104:105], v3 offset:26624
    ds_read_b64_tr_b16 a[106:107], v3 offset:27136
    ds_read_b64_tr_b16 a[108:109], v3 offset:26688
    ds_read_b64_tr_b16 a[110:111], v3 offset:27200
    s_waitcnt lgkmcnt(0)
    s_add_u32 m0, s38, 8192
    s_add_u32 s35, s44, 2621440
    buffer_load_dwordx4 v2, s[12:15], s35 offen lds
    s_add_u32 m0, s38, 9216
    s_add_u32 s35, s44, 2686976
    buffer_load_dwordx4 v2, s[12:15], s35 offen lds
    s_add_u32 m0, s38, 10240
    s_add_u32 s35, s44, 2752512
    buffer_load_dwordx4 v2, s[12:15], s35 offen lds
    s_add_u32 m0, s38, 11264
    s_add_u32 s35, s44, 2818048
    buffer_load_dwordx4 v2, s[12:15], s35 offen lds
    s_waitcnt vmcnt(12)
    ds_read_b64_tr_b16 a[112:113], v3 offset:28672
    ds_read_b64_tr_b16 a[114:115], v3 offset:29184
    ds_read_b64_tr_b16 a[116:117], v3 offset:28736
    ds_read_b64_tr_b16 a[118:119], v3 offset:29248
    ds_read_b64_tr_b16 a[120:121], v3 offset:30720
    ds_read_b64_tr_b16 a[122:123], v3 offset:31232
    ds_read_b64_tr_b16 a[124:125], v3 offset:30784
    ds_read_b64_tr_b16 a[126:127], v3 offset:31296
    s_waitcnt lgkmcnt(0)
    s_add_u32 m0, s38, 12288
    s_add_u32 s35, s44, 2883584
    buffer_load_dwordx4 v2, s[12:15], s35 offen lds
    s_add_u32 m0, s38, 13312
    s_add_u32 s35, s44, 2949120
    buffer_load_dwordx4 v2, s[12:15], s35 offen lds
    s_add_u32 m0, s38, 14336
    s_add_u32 s35, s44, 3014656
    buffer_load_dwordx4 v2, s[12:15], s35 offen lds
    s_add_u32 m0, s38, 15360
    s_add_u32 s35, s44, 3080192
    buffer_load_dwordx4 v2, s[12:15], s35 offen lds
    s_waitcnt vmcnt(12)
    ds_read_b64_tr_b16 a[128:129], v3 offset:0
    ds_read_b64_tr_b16 a[130:131], v3 offset:512
    ds_read_b64_tr_b16 a[132:133], v3 offset:64
    ds_read_b64_tr_b16 a[134:135], v3 offset:576
    ds_read_b64_tr_b16 a[136:137], v3 offset:2048
    ds_read_b64_tr_b16 a[138:139], v3 offset:2560
    ds_read_b64_tr_b16 a[140:141], v3 offset:2112
    ds_read_b64_tr_b16 a[142:143], v3 offset:2624
    s_waitcnt lgkmcnt(0)
    s_add_u32 m0, s38, 16384
    s_add_u32 s35, s44, 3145728
    buffer_load_dwordx4 v2, s[12:15], s35 offen lds
    s_add_u32 m0, s38, 17408
    s_add_u32 s35, s44, 3211264
    buffer_load_dwordx4 v2, s[12:15], s35 offen lds
    s_add_u32 m0, s38, 18432
    s_add_u32 s35, s44, 3276800
    buffer_load_dwordx4 v2, s[12:15], s35 offen lds
    s_add_u32 m0, s38, 19456
    s_add_u32 s35, s44, 3342336
    buffer_load_dwordx4 v2, s[12:15], s35 offen lds
    s_waitcnt vmcnt(12)
    ds_read_b64_tr_b16 a[144:145], v3 offset:4096
    ds_read_b64_tr_b16 a[146:147], v3 offset:4608
    ds_read_b64_tr_b16 a[148:149], v3 offset:4160
    ds_read_b64_tr_b16 a[150:151], v3 offset:4672
    ds_read_b64_tr_b16 a[152:153], v3 offset:6144
    ds_read_b64_tr_b16 a[154:155], v3 offset:6656
    ds_read_b64_tr_b16 a[156:157], v3 offset:6208
    ds_read_b64_tr_b16 a[158:159], v3 offset:6720
    s_waitcnt lgkmcnt(0)
    s_add_u32 m0, s38, 20480
    s_add_u32 s35, s44, 3407872
    buffer_load_dwordx4 v2, s[12:15], s35 offen lds
    s_add_u32 m0, s38, 21504
    s_add_u32 s35, s44, 3473408
    buffer_load_dwordx4 v2, s[12:15], s35 offen lds
    s_add_u32 m0, s38, 22528
    s_add_u32 s35, s44, 3538944
    buffer_load_dwordx4 v2, s[12:15], s35 offen lds
    s_add_u32 m0, s38, 23552
    s_add_u32 s35, s44, 3604480
    buffer_load_dwordx4 v2, s[12:15], s35 offen lds
    s_waitcnt vmcnt(12)
    ds_read_b64_tr_b16 a[160:161], v3 offset:8192
    ds_read_b64_tr_b16 a[162:163], v3 offset:8704
    ds_read_b64_tr_b16 a[164:165], v3 offset:8256
    ds_read_b64_tr_b16 a[166:167], v3 offset:8768
    ds_read_b64_tr_b16 a[168:169], v3 offset:10240
    ds_read_b64_tr_b16 a[170:171], v3 offset:10752
    ds_read_b64_tr_b16 a[172:173], v3 offset:10304
    ds_read_b64_tr_b16 a[174:175], v3 offset:10816
    s_waitcnt lgkmcnt(0)
    s_add_u32 m0, s38, 24576
    s_add_u32 s35, s44, 3670016
    buffer_load_dwordx4 v2, s[12:15], s35 offen lds
    s_add_u32 m0, s38, 25600
    s_add_u32 s35, s44, 3735552
    buffer_load_dwordx4 v2, s[12:15], s35 offen lds
    s_add_u32 m0, s38, 26624
    s_add_u32 s35, s44, 3801088
    buffer_load_dwordx4 v2, s[12:15], s35 offen lds
    s_add_u32 m0, s38, 27648
    s_add_u32 s35, s44, 3866624
    buffer_load_dwordx4 v2, s[12:15], s35 offen lds
    s_waitcnt vmcnt(12)
    ds_read_b64_tr_b16 a[176:177], v3 offset:12288
    ds_read_b64_tr_b16 a[178:179], v3 offset:12800
    ds_read_b64_tr_b16 a[180:181], v3 offset:12352
    ds_read_b64_tr_b16 a[182:183], v3 offset:12864
    ds_read_b64_tr_b16 a[184:185], v3 offset:14336
    ds_read_b64_tr_b16 a[186:187], v3 offset:14848
    ds_read_b64_tr_b16 a[188:189], v3 offset:14400
    ds_read_b64_tr_b16 a[190:191], v3 offset:14912
    s_waitcnt lgkmcnt(0)
    s_add_u32 m0, s38, 28672
    s_add_u32 s35, s44, 3932160
    buffer_load_dwordx4 v2, s[12:15], s35 offen lds
    s_add_u32 m0, s38, 29696
    s_add_u32 s35, s44, 3997696
    buffer_load_dwordx4 v2, s[12:15], s35 offen lds
    s_add_u32 m0, s38, 30720
    s_add_u32 s35, s44, 4063232
    buffer_load_dwordx4 v2, s[12:15], s35 offen lds
    s_add_u32 m0, s38, 31744
    s_add_u32 s35, s44, 4128768
    buffer_load_dwordx4 v2, s[12:15], s35 offen lds
    s_waitcnt vmcnt(12)
    ds_read_b64_tr_b16 a[192:193], v3 offset:16384
    ds_read_b64_tr_b16 a[194:195], v3 offset:16896
    ds_read_b64_tr_b16 a[196:197], v3 offset:16448
    ds_read_b64_tr_b16 a[198:199], v3 offset:16960
    ds_read_b64_tr_b16 a[200:201], v3 offset:18432
    ds_read_b64_tr_b16 a[202:203], v3 offset:18944
    ds_read_b64_tr_b16 a[204:205], v3 offset:18496
    ds_read_b64_tr_b16 a[206:207], v3 offset:19008
    s_waitcnt lgkmcnt(0)
    s_add_u32 m0, s38, 0
    s_add_u32 s35, s44, 4194304
    buffer_load_dwordx4 v2, s[12:15], s35 offen lds
    s_add_u32 m0, s38, 1024
    s_add_u32 s35, s44, 4259840
    buffer_load_dwordx4 v2, s[12:15], s35 offen lds
    s_add_u32 m0, s38, 2048
    s_add_u32 s35, s44, 4325376
    buffer_load_dwordx4 v2, s[12:15], s35 offen lds
    s_add_u32 m0, s38, 3072
    s_add_u32 s35, s44, 4390912
    buffer_load_dwordx4 v2, s[12:15], s35 offen lds
    s_waitcnt vmcnt(12)
    ds_read_b64_tr_b16 a[208:209], v3 offset:20480
    ds_read_b64_tr_b16 a[210:211], v3 offset:20992
    ds_read_b64_tr_b16 a[212:213], v3 offset:20544
    ds_read_b64_tr_b16 a[214:215], v3 offset:21056
    ds_read_b64_tr_b16 a[216:217], v3 offset:22528
    ds_read_b64_tr_b16 a[218:219], v3 offset:23040
    ds_read_b64_tr_b16 a[220:221], v3 offset:22592
    ds_read_b64_tr_b16 a[222:223], v3 offset:23104
    s_waitcnt lgkmcnt(0)
    s_add_u32 m0, s38, 4096
    s_add_u32 s35, s44, 4456448
    buffer_load_dwordx4 v2, s[12:15], s35 offen lds
    s_add_u32 m0, s38, 5120
    s_add_u32 s35, s44, 4521984
    buffer_load_dwordx4 v2, s[12:15], s35 offen lds
    s_add_u32 m0, s38, 6144
    s_add_u32 s35, s44, 4587520
    buffer_load_dwordx4 v2, s[12:15], s35 offen lds
    s_add_u32 m0, s38, 7168
    s_add_u32 s35, s44, 4653056
    buffer_load_dwordx4 v2, s[12:15], s35 offen lds
    s_waitcnt vmcnt(12)
    ds_read_b64_tr_b16 a[224:225], v3 offset:24576
    ds_read_b64_tr_b16 a[226:227], v3 offset:25088
    ds_read_b64_tr_b16 a[228:229], v3 offset:24640
    ds_read_b64_tr_b16 a[230:231], v3 offset:25152
    ds_read_b64_tr_b16 a[232:233], v3 offset:26624
    ds_read_b64_tr_b16 a[234:235], v3 offset:27136
    ds_read_b64_tr_b16 a[236:237], v3 offset:26688
    ds_read_b64_tr_b16 a[238:239], v3 offset:27200
    s_waitcnt lgkmcnt(0)
    s_waitcnt vmcnt(8)
    ds_read_b64_tr_b16 a[240:241], v3 offset:28672
    ds_read_b64_tr_b16 a[242:243], v3 offset:29184
    ds_read_b64_tr_b16 a[244:245], v3 offset:28736
    ds_read_b64_tr_b16 a[246:247], v3 offset:29248
    ds_read_b64_tr_b16 a[248:249], v3 offset:30720
    ds_read_b64_tr_b16 a[250:251], v3 offset:31232
    ds_read_b64_tr_b16 a[252:253], v3 offset:30784
    ds_read_b64_tr_b16 a[254:255], v3 offset:31296
    s_waitcnt lgkmcnt(0)
    s_waitcnt vmcnt(4)
    ds_read_b64_tr_b16 v[252:253], v3 offset:0
    ds_read_b64_tr_b16 v[254:255], v3 offset:512
    ds_read_b64_tr_b16 v[248:249], v3 offset:64
    ds_read_b64_tr_b16 v[250:251], v3 offset:576
    ds_read_b64_tr_b16 v[244:245], v3 offset:2048
    ds_read_b64_tr_b16 v[246:247], v3 offset:2560
    ds_read_b64_tr_b16 v[240:241], v3 offset:2112
    ds_read_b64_tr_b16 v[242:243], v3 offset:2624
    s_waitcnt lgkmcnt(0)
    s_waitcnt vmcnt(0)
    ds_read_b64_tr_b16 v[236:237], v3 offset:4096
    ds_read_b64_tr_b16 v[238:239], v3 offset:4608
    ds_read_b64_tr_b16 v[232:233], v3 offset:4160
    ds_read_b64_tr_b16 v[234:235], v3 offset:4672
    ds_read_b64_tr_b16 v[228:229], v3 offset:6144
    ds_read_b64_tr_b16 v[230:231], v3 offset:6656
    ds_read_b64_tr_b16 v[224:225], v3 offset:6208
    ds_read_b64_tr_b16 v[226:227], v3 offset:6720
    s_waitcnt lgkmcnt(0)
    s_and_b32 s35, s30, 15
    s_lshl_b32 s34, s35, 14
    s_lshl_b32 s36, s29, 12
    s_add_u32 s34, s34, s36
    s_mov_b32 s35, 37748736
    s_cmp_eq_u32 s43, 0
    s_cselect_b32 s35, 20971520, s35
    s_cmp_eq_u32 s43, 2
    s_cselect_b32 s35, 4194304, s35
    s_add_u32 s34, s34, s35
    s_mov_b32 s37, 262144
    s_branch Lga_go
Lga_h:
    s_mov_b64 s[12:13], s[50:51]
    s_mov_b32 s14, 5308416
    s_sub_u32 s35, s30, 48
    s_lshl_b32 s36, s35, 9
    s_lshl_b32 s44, s29, 7
    s_add_u32 s44, s44, s36
    v_lshrrev_b32 v4, 3, v1
    s_mov_b32 s35, 9216
    v_mul_lo_u32 v2, v4, s35
    v_and_b32 v4, 7, v1
    v_lshl_add_u32 v2, v4, 4, v2
    v_bfe_u32 v4, v1, 5, 1
    v_lshlrev_b32 v3, 10, v4
    v_bfe_u32 v4, v1, 2, 2
    v_lshl_add_u32 v3, v4, 7, v3
    v_bfe_u32 v4, v1, 4, 1
    v_lshl_add_u32 v3, v4, 5, v3
    v_bfe_u32 v4, v1, 0, 2
    v_lshl_add_u32 v3, v4, 3, v3
    v_add_u32 v3, s38, v3
    s_add_u32 m0, s38, 0
    s_add_u32 s35, s44, 0
    buffer_load_dwordx4 v2, s[12:15], s35 offen lds
    s_add_u32 m0, s38, 1024
    s_add_u32 s35, s44, 73728
    buffer_load_dwordx4 v2, s[12:15], s35 offen lds
    s_add_u32 m0, s38, 2048
    s_add_u32 s35, s44, 147456
    buffer_load_dwordx4 v2, s[12:15], s35 offen lds
    s_add_u32 m0, s38, 3072
    s_add_u32 s35, s44, 221184
    buffer_load_dwordx4 v2, s[12:15], s35 offen lds
    s_add_u32 m0, s38, 4096
    s_add_u32 s35, s44, 294912
    buffer_load_dwordx4 v2, s[12:15], s35 offen lds
    s_add_u32 m0, s38, 5120
    s_add_u32 s35, s44, 368640
    buffer_load_dwordx4 v2, s[12:15], s35 offen lds
    s_add_u32 m0, s38, 6144
    s_add_u32 s35, s44, 442368
    buffer_load_dwordx4 v2, s[12:15], s35 offen lds
    s_add_u32 m0, s38, 7168
    s_add_u32 s35, s44, 516096
    buffer_load_dwordx4 v2, s[12:15], s35 offen lds
    s_add_u32 m0, s38, 8192
    s_add_u32 s35, s44, 589824
    buffer_load_dwordx4 v2, s[12:15], s35 offen lds
    s_add_u32 m0, s38, 9216
    s_add_u32 s35, s44, 663552
    buffer_load_dwordx4 v2, s[12:15], s35 offen lds
    s_add_u32 m0, s38, 10240
    s_add_u32 s35, s44, 737280
    buffer_load_dwordx4 v2, s[12:15], s35 offen lds
    s_add_u32 m0, s38, 11264
    s_add_u32 s35, s44, 811008
    buffer_load_dwordx4 v2, s[12:15], s35 offen lds
    s_add_u32 m0, s38, 12288
    s_add_u32 s35, s44, 884736
    buffer_load_dwordx4 v2, s[12:15], s35 offen lds
    s_add_u32 m0, s38, 13312
    s_add_u32 s35, s44, 958464
    buffer_load_dwordx4 v2, s[12:15], s35 offen lds
    s_add_u32 m0, s38, 14336
    s_add_u32 s35, s44, 1032192
    buffer_load_dwordx4 v2, s[12:15], s35 offen lds
    s_add_u32 m0, s38, 15360
    s_add_u32 s35, s44, 1105920
    buffer_load_dwordx4 v2, s[12:15], s35 offen lds
    s_waitcnt vmcnt(12)
    ds_read_b64_tr_b16 a[0:1], v3 offset:0
    ds_read_b64_tr_b16 a[2:3], v3 offset:512
    ds_read_b64_tr_b16 a[4:5], v3 offset:64
    ds_read_b64_tr_b16 a[6:7], v3 offset:576
    ds_read_b64_tr_b16 a[8:9], v3 offset:2048
    ds_read_b64_tr_b16 a[10:11], v3 offset:2560
    ds_read_b64_tr_b16 a[12:13], v3 offset:2112
    ds_read_b64_tr_b16 a[14:15], v3 offset:2624
    s_waitcnt lgkmcnt(0)
    s_add_u32 m0, s38, 16384
    s_add_u32 s35, s44, 1179648
    buffer_load_dwordx4 v2, s[12:15], s35 offen lds
    s_add_u32 m0, s38, 17408
    s_add_u32 s35, s44, 1253376
    buffer_load_dwordx4 v2, s[12:15], s35 offen lds
    s_add_u32 m0, s38, 18432
    s_add_u32 s35, s44, 1327104
    buffer_load_dwordx4 v2, s[12:15], s35 offen lds
    s_add_u32 m0, s38, 19456
    s_add_u32 s35, s44, 1400832
    buffer_load_dwordx4 v2, s[12:15], s35 offen lds
    s_waitcnt vmcnt(12)
    ds_read_b64_tr_b16 a[16:17], v3 offset:4096
    ds_read_b64_tr_b16 a[18:19], v3 offset:4608
    ds_read_b64_tr_b16 a[20:21], v3 offset:4160
    ds_read_b64_tr_b16 a[22:23], v3 offset:4672
    ds_read_b64_tr_b16 a[24:25], v3 offset:6144
    ds_read_b64_tr_b16 a[26:27], v3 offset:6656
    ds_read_b64_tr_b16 a[28:29], v3 offset:6208
    ds_read_b64_tr_b16 a[30:31], v3 offset:6720
    s_waitcnt lgkmcnt(0)
    s_add_u32 m0, s38, 20480
    s_add_u32 s35, s44, 1474560
    buffer_load_dwordx4 v2, s[12:15], s35 offen lds
    s_add_u32 m0, s38, 21504
    s_add_u32 s35, s44, 1548288
    buffer_load_dwordx4 v2, s[12:15], s35 offen lds
    s_add_u32 m0, s38, 22528
    s_add_u32 s35, s44, 1622016
    buffer_load_dwordx4 v2, s[12:15], s35 offen lds
    s_add_u32 m0, s38, 23552
    s_add_u32 s35, s44, 1695744
    buffer_load_dwordx4 v2, s[12:15], s35 offen lds
    s_waitcnt vmcnt(12)
    ds_read_b64_tr_b16 a[32:33], v3 offset:8192
    ds_read_b64_tr_b16 a[34:35], v3 offset:8704
    ds_read_b64_tr_b16 a[36:37], v3 offset:8256
    ds_read_b64_tr_b16 a[38:39], v3 offset:8768
    ds_read_b64_tr_b16 a[40:41], v3 offset:10240
    ds_read_b64_tr_b16 a[42:43], v3 offset:10752
    ds_read_b64_tr_b16 a[44:45], v3 offset:10304
    ds_read_b64_tr_b16 a[46:47], v3 offset:10816
    s_waitcnt lgkmcnt(0)
    s_add_u32 m0, s38, 24576
    s_add_u32 s35, s44, 1769472
    buffer_load_dwordx4 v2, s[12:15], s35 offen lds
    s_add_u32 m0, s38, 25600
    s_add_u32 s35, s44, 1843200
    buffer_load_dwordx4 v2, s[12:15], s35 offen lds
    s_add_u32 m0, s38, 26624
    s_add_u32 s35, s44, 1916928
    buffer_load_dwordx4 v2, s[12:15], s35 offen lds
    s_add_u32 m0, s38, 27648
    s_add_u32 s35, s44, 1990656
    buffer_load_dwordx4 v2, s[12:15], s35 offen lds
    s_waitcnt vmcnt(12)
    ds_read_b64_tr_b16 a[48:49], v3 offset:12288
    ds_read_b64_tr_b16 a[50:51], v3 offset:12800
    ds_read_b64_tr_b16 a[52:53], v3 offset:12352
    ds_read_b64_tr_b16 a[54:55], v3 offset:12864
    ds_read_b64_tr_b16 a[56:57], v3 offset:14336
    ds_read_b64_tr_b16 a[58:59], v3 offset:14848
    ds_read_b64_tr_b16 a[60:61], v3 offset:14400
    ds_read_b64_tr_b16 a[62:63], v3 offset:14912
    s_waitcnt lgkmcnt(0)
    s_add_u32 m0, s38, 28672
    s_add_u32 s35, s44, 2064384
    buffer_load_dwordx4 v2, s[12:15], s35 offen lds
    s_add_u32 m0, s38, 29696
    s_add_u32 s35, s44, 2138112
    buffer_load_dwordx4 v2, s[12:15], s35 offen lds
    s_add_u32 m0, s38, 30720
    s_add_u32 s35, s44, 2211840
    buffer_load_dwordx4 v2, s[12:15], s35 offen lds
    s_add_u32 m0, s38, 31744
    s_add_u32 s35, s44, 2285568
    buffer_load_dwordx4 v2, s[12:15], s35 offen lds
    s_waitcnt vmcnt(12)
    ds_read_b64_tr_b16 a[64:65], v3 offset:16384
    ds_read_b64_tr_b16 a[66:67], v3 offset:16896
    ds_read_b64_tr_b16 a[68:69], v3 offset:16448
    ds_read_b64_tr_b16 a[70:71], v3 offset:16960
    ds_read_b64_tr_b16 a[72:73], v3 offset:18432
    ds_read_b64_tr_b16 a[74:75], v3 offset:18944
    ds_read_b64_tr_b16 a[76:77], v3 offset:18496
    ds_read_b64_tr_b16 a[78:79], v3 offset:19008
    s_waitcnt lgkmcnt(0)
    s_add_u32 m0, s38, 0
    s_add_u32 s35, s44, 2359296
    buffer_load_dwordx4 v2, s[12:15], s35 offen lds
    s_add_u32 m0, s38, 1024
    s_add_u32 s35, s44, 2433024
    buffer_load_dwordx4 v2, s[12:15], s35 offen lds
    s_add_u32 m0, s38, 2048
    s_add_u32 s35, s44, 2506752
    buffer_load_dwordx4 v2, s[12:15], s35 offen lds
    s_add_u32 m0, s38, 3072
    s_add_u32 s35, s44, 2580480
    buffer_load_dwordx4 v2, s[12:15], s35 offen lds
    s_waitcnt vmcnt(12)
    ds_read_b64_tr_b16 a[80:81], v3 offset:20480
    ds_read_b64_tr_b16 a[82:83], v3 offset:20992
    ds_read_b64_tr_b16 a[84:85], v3 offset:20544
    ds_read_b64_tr_b16 a[86:87], v3 offset:21056
    ds_read_b64_tr_b16 a[88:89], v3 offset:22528
    ds_read_b64_tr_b16 a[90:91], v3 offset:23040
    ds_read_b64_tr_b16 a[92:93], v3 offset:22592
    ds_read_b64_tr_b16 a[94:95], v3 offset:23104
    s_waitcnt lgkmcnt(0)
    s_add_u32 m0, s38, 4096
    s_add_u32 s35, s44, 2654208
    buffer_load_dwordx4 v2, s[12:15], s35 offen lds
    s_add_u32 m0, s38, 5120
    s_add_u32 s35, s44, 2727936
    buffer_load_dwordx4 v2, s[12:15], s35 offen lds
    s_add_u32 m0, s38, 6144
    s_add_u32 s35, s44, 2801664
    buffer_load_dwordx4 v2, s[12:15], s35 offen lds
    s_add_u32 m0, s38, 7168
    s_add_u32 s35, s44, 2875392
    buffer_load_dwordx4 v2, s[12:15], s35 offen lds
    s_waitcnt vmcnt(12)
    ds_read_b64_tr_b16 a[96:97], v3 offset:24576
    ds_read_b64_tr_b16 a[98:99], v3 offset:25088
    ds_read_b64_tr_b16 a[100:101], v3 offset:24640
    ds_read_b64_tr_b16 a[102:103], v3 offset:25152
    ds_read_b64_tr_b16 a[104:105], v3 offset:26624
    ds_read_b64_tr_b16 a[106:107], v3 offset:27136
    ds_read_b64_tr_b16 a[108:109], v3 offset:26688
    ds_read_b64_tr_b16 a[110:111], v3 offset:27200
    s_waitcnt lgkmcnt(0)
    s_add_u32 m0, s38, 8192
    s_add_u32 s35, s44, 2949120
    buffer_load_dwordx4 v2, s[12:15], s35 offen lds
    s_add_u32 m0, s38, 9216
    s_add_u32 s35, s44, 3022848
    buffer_load_dwordx4 v2, s[12:15], s35 offen lds
    s_add_u32 m0, s38, 10240
    s_add_u32 s35, s44, 3096576
    buffer_load_dwordx4 v2, s[12:15], s35 offen lds
    s_add_u32 m0, s38, 11264
    s_add_u32 s35, s44, 3170304
    buffer_load_dwordx4 v2, s[12:15], s35 offen lds
    s_waitcnt vmcnt(12)
    ds_read_b64_tr_b16 a[112:113], v3 offset:28672
    ds_read_b64_tr_b16 a[114:115], v3 offset:29184
    ds_read_b64_tr_b16 a[116:117], v3 offset:28736
    ds_read_b64_tr_b16 a[118:119], v3 offset:29248
    ds_read_b64_tr_b16 a[120:121], v3 offset:30720
    ds_read_b64_tr_b16 a[122:123], v3 offset:31232
    ds_read_b64_tr_b16 a[124:125], v3 offset:30784
    ds_read_b64_tr_b16 a[126:127], v3 offset:31296
    s_waitcnt lgkmcnt(0)
    s_add_u32 m0, s38, 12288
    s_add_u32 s35, s44, 3244032
    buffer_load_dwordx4 v2, s[12:15], s35 offen lds
    s_add_u32 m0, s38, 13312
    s_add_u32 s35, s44, 3317760
    buffer_load_dwordx4 v2, s[12:15], s35 offen lds
    s_add_u32 m0, s38, 14336
    s_add_u32 s35, s44, 3391488
    buffer_load_dwordx4 v2, s[12:15], s35 offen lds
    s_add_u32 m0, s38, 15360
    s_add_u32 s35, s44, 3465216
    buffer_load_dwordx4 v2, s[12:15], s35 offen lds
    s_waitcnt vmcnt(12)
    ds_read_b64_tr_b16 a[128:129], v3 offset:0
    ds_read_b64_tr_b16 a[130:131], v3 offset:512
    ds_read_b64_tr_b16 a[132:133], v3 offset:64
    ds_read_b64_tr_b16 a[134:135], v3 offset:576
    ds_read_b64_tr_b16 a[136:137], v3 offset:2048
    ds_read_b64_tr_b16 a[138:139], v3 offset:2560
    ds_read_b64_tr_b16 a[140:141], v3 offset:2112
    ds_read_b64_tr_b16 a[142:143], v3 offset:2624
    s_waitcnt lgkmcnt(0)
    s_add_u32 m0, s38, 16384
    s_add_u32 s35, s44, 3538944
    buffer_load_dwordx4 v2, s[12:15], s35 offen lds
    s_add_u32 m0, s38, 17408
    s_add_u32 s35, s44, 3612672
    buffer_load_dwordx4 v2, s[12:15], s35 offen lds
    s_add_u32 m0, s38, 18432
    s_add_u32 s35, s44, 3686400
    buffer_load_dwordx4 v2, s[12:15], s35 offen lds
    s_add_u32 m0, s38, 19456
    s_add_u32 s35, s44, 3760128
    buffer_load_dwordx4 v2, s[12:15], s35 offen lds
    s_waitcnt vmcnt(12)
    ds_read_b64_tr_b16 a[144:145], v3 offset:4096
    ds_read_b64_tr_b16 a[146:147], v3 offset:4608
    ds_read_b64_tr_b16 a[148:149], v3 offset:4160
    ds_read_b64_tr_b16 a[150:151], v3 offset:4672
    ds_read_b64_tr_b16 a[152:153], v3 offset:6144
    ds_read_b64_tr_b16 a[154:155], v3 offset:6656
    ds_read_b64_tr_b16 a[156:157], v3 offset:6208
    ds_read_b64_tr_b16 a[158:159], v3 offset:6720
    s_waitcnt lgkmcnt(0)
    s_add_u32 m0, s38, 20480
    s_add_u32 s35, s44, 3833856
    buffer_load_dwordx4 v2, s[12:15], s35 offen lds
    s_add_u32 m0, s38, 21504
    s_add_u32 s35, s44, 3907584
    buffer_load_dwordx4 v2, s[12:15], s35 offen lds
    s_add_u32 m0, s38, 22528
    s_add_u32 s35, s44, 3981312
    buffer_load_dwordx4 v2, s[12:15], s35 offen lds
    s_add_u32 m0, s38, 23552
    s_add_u32 s35, s44, 4055040
    buffer_load_dwordx4 v2, s[12:15], s35 offen lds
    s_waitcnt vmcnt(12)
    ds_read_b64_tr_b16 a[160:161], v3 offset:8192
    ds_read_b64_tr_b16 a[162:163], v3 offset:8704
    ds_read_b64_tr_b16 a[164:165], v3 offset:8256
    ds_read_b64_tr_b16 a[166:167], v3 offset:8768
    ds_read_b64_tr_b16 a[168:169], v3 offset:10240
    ds_read_b64_tr_b16 a[170:171], v3 offset:10752
    ds_read_b64_tr_b16 a[172:173], v3 offset:10304
    ds_read_b64_tr_b16 a[174:175], v3 offset:10816
    s_waitcnt lgkmcnt(0)
    s_add_u32 m0, s38, 24576
    s_add_u32 s35, s44, 4128768
    buffer_load_dwordx4 v2, s[12:15], s35 offen lds
    s_add_u32 m0, s38, 25600
    s_add_u32 s35, s44, 4202496
    buffer_load_dwordx4 v2, s[12:15], s35 offen lds
    s_add_u32 m0, s38, 26624
    s_add_u32 s35, s44, 4276224
    buffer_load_dwordx4 v2, s[12:15], s35 offen lds
    s_add_u32 m0, s38, 27648
    s_add_u32 s35, s44, 4349952
    buffer_load_dwordx4 v2, s[12:15], s35 offen lds
    s_waitcnt vmcnt(12)
    ds_read_b64_tr_b16 a[176:177], v3 offset:12288
    ds_read_b64_tr_b16 a[178:179], v3 offset:12800
    ds_read_b64_tr_b16 a[180:181], v3 offset:12352
    ds_read_b64_tr_b16 a[182:183], v3 offset:12864
    ds_read_b64_tr_b16 a[184:185], v3 offset:14336
    ds_read_b64_tr_b16 a[186:187], v3 offset:14848
    ds_read_b64_tr_b16 a[188:189], v3 offset:14400
    ds_read_b64_tr_b16 a[190:191], v3 offset:14912
    s_waitcnt lgkmcnt(0)
    s_add_u32 m0, s38, 28672
    s_add_u32 s35, s44, 4423680
    buffer_load_dwordx4 v2, s[12:15], s35 offen lds
    s_add_u32 m0, s38, 29696
    s_add_u32 s35, s44, 4497408
    buffer_load_dwordx4 v2, s[12:15], s35 offen lds
    s_add_u32 m0, s38, 30720
    s_add_u32 s35, s44, 4571136
    buffer_load_dwordx4 v2, s[12:15], s35 offen lds
    s_add_u32 m0, s38, 31744
    s_add_u32 s35, s44, 4644864
    buffer_load_dwordx4 v2, s[12:15], s35 offen lds
    s_waitcnt vmcnt(12)
    ds_read_b64_tr_b16 a[192:193], v3 offset:16384
    ds_read_b64_tr_b16 a[194:195], v3 offset:16896
    ds_read_b64_tr_b16 a[196:197], v3 offset:16448
    ds_read_b64_tr_b16 a[198:199], v3 offset:16960
    ds_read_b64_tr_b16 a[200:201], v3 offset:18432
    ds_read_b64_tr_b16 a[202:203], v3 offset:18944
    ds_read_b64_tr_b16 a[204:205], v3 offset:18496
    ds_read_b64_tr_b16 a[206:207], v3 offset:19008
    s_waitcnt lgkmcnt(0)
    s_add_u32 m0, s38, 0
    s_add_u32 s35, s44, 4718592
    buffer_load_dwordx4 v2, s[12:15], s35 offen lds
    s_add_u32 m0, s38, 1024
    s_add_u32 s35, s44, 4792320
    buffer_load_dwordx4 v2, s[12:15], s35 offen lds
    s_add_u32 m0, s38, 2048
    s_add_u32 s35, s44, 4866048
    buffer_load_dwordx4 v2, s[12:15], s35 offen lds
    s_add_u32 m0, s38, 3072
    s_add_u32 s35, s44, 4939776
    buffer_load_dwordx4 v2, s[12:15], s35 offen lds
    s_waitcnt vmcnt(12)
    ds_read_b64_tr_b16 a[208:209], v3 offset:20480
    ds_read_b64_tr_b16 a[210:211], v3 offset:20992
    ds_read_b64_tr_b16 a[212:213], v3 offset:20544
    ds_read_b64_tr_b16 a[214:215], v3 offset:21056
    ds_read_b64_tr_b16 a[216:217], v3 offset:22528
    ds_read_b64_tr_b16 a[218:219], v3 offset:23040
    ds_read_b64_tr_b16 a[220:221], v3 offset:22592
    ds_read_b64_tr_b16 a[222:223], v3 offset:23104
    s_waitcnt lgkmcnt(0)
    s_add_u32 m0, s38, 4096
    s_add_u32 s35, s44, 5013504
    buffer_load_dwordx4 v2, s[12:15], s35 offen lds
    s_add_u32 m0, s38, 5120
    s_add_u32 s35, s44, 5087232
    buffer_load_dwordx4 v2, s[12:15], s35 offen lds
    s_add_u32 m0, s38, 6144
    s_add_u32 s35, s44, 5160960
    buffer_load_dwordx4 v2, s[12:15], s35 offen lds
    s_add_u32 m0, s38, 7168
    s_add_u32 s35, s44, 5234688
    buffer_load_dwordx4 v2, s[12:15], s35 offen lds
    s_waitcnt vmcnt(12)
    ds_read_b64_tr_b16 a[224:225], v3 offset:24576
    ds_read_b64_tr_b16 a[226:227], v3 offset:25088
    ds_read_b64_tr_b16 a[228:229], v3 offset:24640
    ds_read_b64_tr_b16 a[230:231], v3 offset:25152
    ds_read_b64_tr_b16 a[232:233], v3 offset:26624
    ds_read_b64_tr_b16 a[234:235], v3 offset:27136
    ds_read_b64_tr_b16 a[236:237], v3 offset:26688
    ds_read_b64_tr_b16 a[238:239], v3 offset:27200
    s_waitcnt lgkmcnt(0)
    s_waitcnt vmcnt(8)
    ds_read_b64_tr_b16 a[240:241], v3 offset:28672
    ds_read_b64_tr_b16 a[242:243], v3 offset:29184
    ds_read_b64_tr_b16 a[244:245], v3 offset:28736
    ds_read_b64_tr_b16 a[246:247], v3 offset:29248
    ds_read_b64_tr_b16 a[248:249], v3 offset:30720
    ds_read_b64_tr_b16 a[250:251], v3 offset:31232
    ds_read_b64_tr_b16 a[252:253], v3 offset:30784
    ds_read_b64_tr_b16 a[254:255], v3 offset:31296
    s_waitcnt lgkmcnt(0)
    s_waitcnt vmcnt(4)
    ds_read_b64_tr_b16 v[252:253], v3 offset:0
    ds_read_b64_tr_b16 v[254:255], v3 offset:512
    ds_read_b64_tr_b16 v[248:249], v3 offset:64
    ds_read_b64_tr_b16 v[250:251], v3 offset:576
    ds_read_b64_tr_b16 v[244:245], v3 offset:2048
    ds_read_b64_tr_b16 v[246:247], v3 offset:2560
    ds_read_b64_tr_b16 v[240:241], v3 offset:2112
    ds_read_b64_tr_b16 v[242:243], v3 offset:2624
    s_waitcnt lgkmcnt(0)
    s_waitcnt vmcnt(0)
    ds_read_b64_tr_b16 v[236:237], v3 offset:4096
    ds_read_b64_tr_b16 v[238:239], v3 offset:4608
    ds_read_b64_tr_b16 v[232:233], v3 offset:4160
    ds_read_b64_tr_b16 v[234:235], v3 offset:4672
    ds_read_b64_tr_b16 v[228:229], v3 offset:6144
    ds_read_b64_tr_b16 v[230:231], v3 offset:6656
    ds_read_b64_tr_b16 v[224:225], v3 offset:6208
    ds_read_b64_tr_b16 v[226:227], v3 offset:6720
    s_waitcnt lgkmcnt(0)
    s_sub_u32 s35, s30, 48
    s_lshl_b32 s34, s35, 14
    s_lshl_b32 s36, s29, 12
    s_add_u32 s34, s34, s36
    s_add_u32 s34, s34, 71303168
    s_mov_b32 s37, 294912
Lga_go:
    v_bfe_u32 v4, v1, 5, 1
    v_lshlrev_b32 v3, 9, v4
    v_bfe_u32 v4, v1, 3, 1
    v_lshl_add_u32 v3, v4, 8, v3
    v_bfe_u32 v4, v1, 4, 1
    v_lshl_add_u32 v3, v4, 7, v3
    v_bfe_u32 v4, v1, 0, 3
    v_lshl_add_u32 v3, v4, 4, v3
    s_cmp_eq_u32 s43, 0
    s_cselect_b64 vcc, -1, 0
    v_cndmask_b32 v2, v0, v3, vcc
    s_mul_i32 s35, s31, s37
    s_add_u32 s34, s34, s35
    s_mul_i32 s37, s37, 3
    s_and_b32 s35, s30, 15
    s_lshl_b32 s35, s35, 11
    s_mul_i32 s36, s43, 384
    s_add_u32 s35, s35, s36
    s_add_u32 s35, s35, 102776832
    s_mul_i32 s36, s30, 384
    s_add_u32 s36, s36, 102750208
    s_cmp_eq_u32 s43, 3
    s_cselect_b32 s35, s36, s35
    s_lshl_b32 s41, s31, 7
    s_add_u32 s41, s41, s35
    s_mul_i32 s42, s29, 9216
    s_cmp_lg_u32 s29, 0
    s_cbranch_scc1 Lga_lnok
    v_mov_b32 v3, 0
Linit9:
    s_sleep 4
    global_load_dword v4, v3, s[6:7] offset:132 sc1
    s_sub_u32 s39, s39, 1
    s_cbranch_scc1 Lbail
    s_waitcnt vmcnt(0)
    v_cmp_eq_u32 vcc, 0, v4
    s_nop 0
    s_cbranch_vccnz Linit9
    v_lshlrev_b32 v3, 2, v1
    s_mov_b32 s35, 102760448
    s_nop 0
Lpoll10:
    buffer_load_dword v4, v3, s[8:11], s35 offen sc1
    s_sub_u32 s39, s39, 1
    s_cbranch_scc1 Lbail
    s_waitcnt vmcnt(0)
    v_cmp_gt_u32 vcc, 1, v4
    s_nop 0
    s_cbranch_vccz Lpoll10d
    s_sleep 8
    s_branch Lpoll10
Lpoll10d:
Lga_lnok:
    s_barrier
    s_mov_b32 s32, s31
    s_mov_b32 s40, 0
    s_mov_b32 s33, 0
    s_mul_i32 s35, s32, 36864
    s_add_u32 s35, s35, s42
    s_add_u32 s36, s40, s42
    s_mov_b32 m0, s36
    s_nop 0
    buffer_load_dwordx4 v0, s[8:11], s35 offen offset:0 sc1 lds
    buffer_load_dwordx4 v0, s[8:11], s35 offen offset:1024 sc1 lds
    buffer_load_dwordx4 v0, s[8:11], s35 offen offset:2048 sc1 lds
    buffer_load_dwordx4 v0, s[8:11], s35 offen offset:3072 sc1 lds
    s_add_u32 s35, s35, 4096
    s_add_u32 s36, s36, 4096
    s_mov_b32 m0, s36
    s_nop 0
    buffer_load_dwordx4 v0, s[8:11], s35 offen offset:0 sc1 lds
    buffer_load_dwordx4 v0, s[8:11], s35 offen offset:1024 sc1 lds
    buffer_load_dwordx4 v0, s[8:11], s35 offen offset:2048 sc1 lds
    buffer_load_dwordx4 v0, s[8:11], s35 offen offset:3072 sc1 lds
    s_add_u32 s35, s35, 4096
    s_add_u32 s36, s36, 4096
    s_mov_b32 m0, s36
    s_nop 0
    buffer_load_dwordx4 v0, s[8:11], s35 offen offset:0 sc1 lds
    s_add_u32 s45, s32, 3
    s_mov_b32 s46, 36864
    s_mul_i32 s35, s45, 36864
    s_add_u32 s35, s35, s42
    s_add_u32 s36, s46, s42
    s_mov_b32 m0, s36
    s_nop 0
    buffer_load_dwordx4 v0, s[8:11], s35 offen offset:0 sc1 lds
    buffer_load_dwordx4 v0, s[8:11], s35 offen offset:1024 sc1 lds
    buffer_load_dwordx4 v0, s[8:11], s35 offen offset:2048 sc1 lds
    buffer_load_dwordx4 v0, s[8:11], s35 offen offset:3072 sc1 lds
    s_add_u32 s35, s35, 4096
    s_add_u32 s36, s36, 4096
    s_mov_b32 m0, s36
    s_nop 0
    buffer_load_dwordx4 v0, s[8:11], s35 offen offset:0 sc1 lds
    buffer_load_dwordx4 v0, s[8:11], s35 offen offset:1024 sc1 lds
    buffer_load_dwordx4 v0, s[8:11], s35 offen offset:2048 sc1 lds
    buffer_load_dwordx4 v0, s[8:11], s35 offen offset:3072 sc1 lds
    s_add_u32 s35, s35, 4096
    s_add_u32 s36, s36, 4096
    s_mov_b32 m0, s36
    s_nop 0
    buffer_load_dwordx4 v0, s[8:11], s35 offen offset:0 sc1 lds
    s_mov_b32 s47, 268435456
    s_cmp_eq_u32 s43, 1
    s_cbranch_scc1 Lga_V
    s_cmp_eq_u32 s43, 3
    s_cbranch_scc1 Lga_H
Lga_QK:
    s_nop 15
    s_nop 3
Lga_QK0:
    s_waitcnt vmcnt(9)
    s_barrier
    s_cmp_lt_u32 s33, 2
    s_cbranch_scc1 Lga_QK0n
    s_cmp_lg_u32 s29, 0
    s_cbranch_scc1 Lga_QK0n
    s_sub_u32 s35, s33, 1
    v_mov_b32 v6, 0
    v_mov_b32 v7, s35
    s_mov_b64 exec, 1
    buffer_store_dword v7, v6, s[8:11], s41 offen sc0 sc1
    s_mov_b64 exec, -1
Lga_QK0n:
    v_add_u32 v5, s40, v0
    ds_read_b128 v[80:83], v5 offset:0
    ds_read_b128 v[84:87], v5 offset:1024
    ds_read_b128 v[88:91], v5 offset:2048
    ds_read_b128 v[92:95], v5 offset:3072
    ds_read_b128 v[96:99], v5 offset:4096
    s_add_u32 s45, s32, 6
    s_add_u32 s46, s40, 73728
    s_cmp_ge_u32 s46, 147456
    s_cselect_b32 s35, 147456, 0
    s_sub_u32 s46, s46, s35
    s_min_u32 s45, s45, 63
    s_waitcnt lgkmcnt(4)
    v_mfma_f32_32x32x16_bf16 v[16:31], a[0:3], v[80:83], 0
    ds_read_b128 v[100:103], v5 offset:5120
    v_mfma_f32_32x32x16_bf16 v[32:47], a[4:7], v[80:83], 0
    s_waitcnt lgkmcnt(4)
    v_mfma_f32_32x32x16_bf16 v[16:31], a[8:11], v[84:87], v[16:31]
    ds_read_b128 v[80:83], v5 offset:6144
    v_cvt_pk_bf16_f32 v112, v48, v49
    v_mfma_f32_32x32x16_bf16 v[32:47], a[12:15], v[84:87], v[32:47]
    s_waitcnt lgkmcnt(4)
    v_cvt_pk_bf16_f32 v113, v56, v57
    v_mfma_f32_32x32x16_bf16 v[16:31], a[16:19], v[88:91], v[16:31]
    ds_read_b128 v[84:87], v5 offset:7168
    v_cvt_pk_bf16_f32 v114, v50, v51
    v_mfma_f32_32x32x16_bf16 v[32:47], a[20:23], v[88:91], v[32:47]
    s_waitcnt lgkmcnt(4)
    v_cvt_pk_bf16_f32 v115, v58, v59
    v_mfma_f32_32x32x16_bf16 v[16:31], a[24:27], v[92:95], v[16:31]
    ds_read_b128 v[88:91], v5 offset:8192
    buffer_store_dwordx4 v[112:115], v2, s[8:11], s47 offen offset:0 sc0 sc1
    v_mfma_f32_32x32x16_bf16 v[32:47], a[28:31], v[92:95], v[32:47]
    s_waitcnt lgkmcnt(4)
    v_cvt_pk_bf16_f32 v116, v52, v53
    v_mfma_f32_32x32x16_bf16 v[16:31], a[32:35], v[96:99], v[16:31]
    ds_read_b128 v[92:95], v5 offset:9216
    v_cvt_pk_bf16_f32 v117, v60, v61
    v_mfma_f32_32x32x16_bf16 v[32:47], a[36:39], v[96:99], v[32:47]
    s_waitcnt lgkmcnt(4)
    v_cvt_pk_bf16_f32 v118, v54, v55
    v_mfma_f32_32x32x16_bf16 v[16:31], a[40:43], v[100:103], v[16:31]
    ds_read_b128 v[96:99], v5 offset:10240
    v_cvt_pk_bf16_f32 v119, v62, v63
    v_mfma_f32_32x32x16_bf16 v[32:47], a[44:47], v[100:103], v[32:47]
    buffer_store_dwordx4 v[116:119], v2, s[8:11], s47 offen offset:1024 sc0 sc1
    s_waitcnt lgkmcnt(4)
    v_mfma_f32_32x32x16_bf16 v[16:31], a[48:51], v[80:83], v[16:31]
    ds_read_b128 v[100:103], v5 offset:11264
    v_cvt_pk_bf16_f32 v112, v64, v65
    v_mfma_f32_32x32x16_bf16 v[32:47], a[52:55], v[80:83], v[32:47]
    s_waitcnt lgkmcnt(4)
    v_cvt_pk_bf16_f32 v113, v72, v73
    v_mfma_f32_32x32x16_bf16 v[16:31], a[56:59], v[84:87], v[16:31]
    ds_read_b128 v[80:83], v5 offset:12288
    v_cvt_pk_bf16_f32 v114, v66, v67
    v_mfma_f32_32x32x16_bf16 v[32:47], a[60:63], v[84:87], v[32:47]
    s_waitcnt lgkmcnt(4)
    v_cvt_pk_bf16_f32 v115, v74, v75
    v_mfma_f32_32x32x16_bf16 v[16:31], a[64:67], v[88:91], v[16:31]
    ds_read_b128 v[84:87], v5 offset:13312
    buffer_store_dwordx4 v[112:115], v2, s[8:11], s47 offen offset:2048 sc0 sc1
    v_mfma_f32_32x32x16_bf16 v[32:47], a[68:71], v[88:91], v[32:47]
    s_waitcnt lgkmcnt(4)
    v_cvt_pk_bf16_f32 v116, v68, v69
    v_mfma_f32_32x32x16_bf16 v[16:31], a[72:75], v[92:95], v[16:31]
    ds_read_b128 v[88:91], v5 offset:14336
    v_cvt_pk_bf16_f32 v117, v76, v77
    v_mfma_f32_32x32x16_bf16 v[32:47], a[76:79], v[92:95], v[32:47]
    s_waitcnt lgkmcnt(4)
    v_cvt_pk_bf16_f32 v118, v70, v71
    v_mfma_f32_32x32x16_bf16 v[16:31], a[80:83], v[96:99], v[16:31]
    ds_read_b128 v[92:95], v5 offset:15360
    v_cvt_pk_bf16_f32 v119, v78, v79
    v_mfma_f32_32x32x16_bf16 v[32:47], a[84:87], v[96:99], v[32:47]
    buffer_store_dwordx4 v[116:119], v2, s[8:11], s47 offen offset:3072 sc0 sc1
    s_waitcnt lgkmcnt(4)
    v_mfma_f32_32x32x16_bf16 v[16:31], a[88:91], v[100:103], v[16:31]
    ds_read_b128 v[96:99], v5 offset:16384
    s_mul_i32 s35, s45, 36864
    s_add_u32 s35, s35, s42
    s_add_u32 s36, s46, s42
    s_mov_b32 m0, s36
    s_nop 0
    buffer_load_dwordx4 v0, s[8:11], s35 offen offset:0 sc1 lds
    v_mfma_f32_32x32x16_bf16 v[32:47], a[92:95], v[100:103], v[32:47]
    buffer_load_dwordx4 v0, s[8:11], s35 offen offset:1024 sc1 lds
    s_waitcnt lgkmcnt(4)
    v_mfma_f32_32x32x16_bf16 v[16:31], a[96:99], v[80:83], v[16:31]
    ds_read_b128 v[100:103], v5 offset:17408
    buffer_load_dwordx4 v0, s[8:11], s35 offen offset:2048 sc1 lds
    v_mfma_f32_32x32x16_bf16 v[32:47], a[100:103], v[80:83], v[32:47]
    buffer_load_dwordx4 v0, s[8:11], s35 offen offset:3072 sc1 lds
    s_waitcnt lgkmcnt(4)
    v_mfma_f32_32x32x16_bf16 v[16:31], a[104:107], v[84:87], v[16:31]
    ds_read_b128 v[80:83], v5 offset:18432
    s_add_u32 s35, s35, 4096
    s_add_u32 s36, s36, 4096
    s_mov_b32 m0, s36
    s_nop 0
    buffer_load_dwordx4 v0, s[8:11], s35 offen offset:0 sc1 lds
    v_mfma_f32_32x32x16_bf16 v[32:47], a[108:111], v[84:87], v[32:47]
    buffer_load_dwordx4 v0, s[8:11], s35 offen offset:1024 sc1 lds
    s_waitcnt lgkmcnt(4)
    v_mfma_f32_32x32x16_bf16 v[16:31], a[112:115], v[88:91], v[16:31]
    ds_read_b128 v[84:87], v5 offset:19456
    buffer_load_dwordx4 v0, s[8:11], s35 offen offset:2048 sc1 lds
    v_mfma_f32_32x32x16_bf16 v[32:47], a[116:119], v[88:91], v[32:47]
    buffer_load_dwordx4 v0, s[8:11], s35 offen offset:3072 sc1 lds
    s_waitcnt lgkmcnt(4)
    v_mfma_f32_32x32x16_bf16 v[16:31], a[120:123], v[92:95], v[16:31]
    ds_read_b128 v[88:91], v5 offset:20480
    s_add_u32 s35, s35, 4096
    s_add_u32 s36, s36, 4096
    s_mov_b32 m0, s36
    s_nop 0
    buffer_load_dwordx4 v0, s[8:11], s35 offen offset:0 sc1 lds
    v_mfma_f32_32x32x16_bf16 v[32:47], a[124:127], v[92:95], v[32:47]
    s_waitcnt lgkmcnt(4)
    v_mfma_f32_32x32x16_bf16 v[16:31], a[128:131], v[96:99], v[16:31]
    ds_read_b128 v[92:95], v5 offset:21504
    v_mfma_f32_32x32x16_bf16 v[32:47], a[132:135], v[96:99], v[32:47]
    s_waitcnt lgkmcnt(4)
    v_mfma_f32_32x32x16_bf16 v[16:31], a[136:139], v[100:103], v[16:31]
    ds_read_b128 v[96:99], v5 offset:22528
    v_mfma_f32_32x32x16_bf16 v[32:47], a[140:143], v[100:103], v[32:47]
    s_waitcnt lgkmcnt(4)
    v_mfma_f32_32x32x16_bf16 v[16:31], a[144:147], v[80:83], v[16:31]
    ds_read_b128 v[100:103], v5 offset:23552
    v_mfma_f32_32x32x16_bf16 v[32:47], a[148:151], v[80:83], v[32:47]
    s_waitcnt lgkmcnt(4)
    v_mfma_f32_32x32x16_bf16 v[16:31], a[152:155], v[84:87], v[16:31]
    ds_read_b128 v[80:83], v5 offset:24576
    v_mfma_f32_32x32x16_bf16 v[32:47], a[156:159], v[84:87], v[32:47]
    s_waitcnt lgkmcnt(4)
    v_mfma_f32_32x32x16_bf16 v[16:31], a[160:163], v[88:91], v[16:31]
    ds_read_b128 v[84:87], v5 offset:25600
    v_mfma_f32_32x32x16_bf16 v[32:47], a[164:167], v[88:91], v[32:47]
    s_waitcnt lgkmcnt(4)
    v_mfma_f32_32x32x16_bf16 v[16:31], a[168:171], v[92:95], v[16:31]
    ds_read_b128 v[88:91], v5 offset:26624
    v_mfma_f32_32x32x16_bf16 v[32:47], a[172:175], v[92:95], v[32:47]
    s_waitcnt lgkmcnt(4)
    v_mfma_f32_32x32x16_bf16 v[16:31], a[176:179], v[96:99], v[16:31]
    ds_read_b128 v[92:95], v5 offset:27648
    v_mfma_f32_32x32x16_bf16 v[32:47], a[180:183], v[96:99], v[32:47]
    s_waitcnt lgkmcnt(4)
    v_mfma_f32_32x32x16_bf16 v[16:31], a[184:187], v[100:103], v[16:31]
    ds_read_b128 v[96:99], v5 offset:28672
    v_mfma_f32_32x32x16_bf16 v[32:47], a[188:191], v[100:103], v[32:47]
    s_waitcnt lgkmcnt(4)
    v_mfma_f32_32x32x16_bf16 v[16:31], a[192:195], v[80:83], v[16:31]
    ds_read_b128 v[100:103], v5 offset:29696
    v_mfma_f32_32x32x16_bf16 v[32:47], a[196:199], v[80:83], v[32:47]
    s_waitcnt lgkmcnt(4)
    v_mfma_f32_32x32x16_bf16 v[16:31], a[200:203], v[84:87], v[16:31]
    ds_read_b128 v[80:83], v5 offset:30720
    v_mfma_f32_32x32x16_bf16 v[32:47], a[204:207], v[84:87], v[32:47]
    s_waitcnt lgkmcnt(4)
    v_mfma_f32_32x32x16_bf16 v[16:31], a[208:211], v[88:91], v[16:31]
    ds_read_b128 v[84:87], v5 offset:31744
    v_mfma_f32_32x32x16_bf16 v[32:47], a[212:215], v[88:91], v[32:47]
    s_waitcnt lgkmcnt(4)
    v_mfma_f32_32x32x16_bf16 v[16:31], a[216:219], v[92:95], v[16:31]
    ds_read_b128 v[88:91], v5 offset:32768
    v_mfma_f32_32x32x16_bf16 v[32:47], a[220:223], v[92:95], v[32:47]
    s_waitcnt lgkmcnt(4)
    v_mfma_f32_32x32x16_bf16 v[16:31], a[224:227], v[96:99], v[16:31]
    ds_read_b128 v[92:95], v5 offset:33792
    v_mfma_f32_32x32x16_bf16 v[32:47], a[228:231], v[96:99], v[32:47]
    s_waitcnt lgkmcnt(4)
    v_mfma_f32_32x32x16_bf16 v[16:31], a[232:235], v[100:103], v[16:31]
    ds_read_b128 v[96:99], v5 offset:34816
    v_mfma_f32_32x32x16_bf16 v[32:47], a[236:239], v[100:103], v[32:47]
    s_waitcnt lgkmcnt(4)
    v_mfma_f32_32x32x16_bf16 v[16:31], a[240:243], v[80:83], v[16:31]
    ds_read_b128 v[100:103], v5 offset:35840
    v_mfma_f32_32x32x16_bf16 v[32:47], a[244:247], v[80:83], v[32:47]
    s_waitcnt lgkmcnt(4)
    v_mfma_f32_32x32x16_bf16 v[16:31], a[248:251], v[84:87], v[16:31]
    v_mfma_f32_32x32x16_bf16 v[32:47], a[252:255], v[84:87], v[32:47]
    s_waitcnt lgkmcnt(3)
    v_mfma_f32_32x32x16_bf16 v[16:31], v[252:255], v[88:91], v[16:31]
    v_mfma_f32_32x32x16_bf16 v[32:47], v[248:251], v[88:91], v[32:47]
    s_waitcnt lgkmcnt(2)
    v_mfma_f32_32x32x16_bf16 v[16:31], v[244:247], v[92:95], v[16:31]
    v_mfma_f32_32x32x16_bf16 v[32:47], v[240:243], v[92:95], v[32:47]
    s_waitcnt lgkmcnt(1)
    v_mfma_f32_32x32x16_bf16 v[16:31], v[236:239], v[96:99], v[16:31]
    v_mfma_f32_32x32x16_bf16 v[32:47], v[232:235], v[96:99], v[32:47]
    s_waitcnt lgkmcnt(0)
    v_mfma_f32_32x32x16_bf16 v[16:31], v[228:231], v[100:103], v[16:31]
    v_mfma_f32_32x32x16_bf16 v[32:47], v[224:227], v[100:103], v[32:47]
    s_mov_b32 s47, s34
    s_add_u32 s34, s34, s37
    s_add_u32 s40, s40, 36864
    s_cmp_ge_u32 s40, 147456
    s_cselect_b32 s40, 0, s40
    s_add_u32 s33, s33, 1
    s_add_u32 s32, s32, 3
    s_cmp_ge_u32 s32, 64
    s_cbranch_scc1 Lga_QK0e
Lga_QK1:
    s_waitcnt vmcnt(9)
    s_barrier
    s_cmp_lt_u32 s33, 2
    s_cbranch_scc1 Lga_QK1n
    s_cmp_lg_u32 s29, 0
    s_cbranch_scc1 Lga_QK1n
    s_sub_u32 s35, s33, 1
    v_mov_b32 v6, 0
    v_mov_b32 v7, s35
    s_mov_b64 exec, 1
    buffer_store_dword v7, v6, s[8:11], s41 offen sc0 sc1
    s_mov_b64 exec, -1
Lga_QK1n:
    v_add_u32 v5, s40, v0
    ds_read_b128 v[80:83], v5 offset:0
    ds_read_b128 v[84:87], v5 offset:1024
    ds_read_b128 v[88:91], v5 offset:2048
    ds_read_b128 v[92:95], v5 offset:3072
    ds_read_b128 v[96:99], v5 offset:4096
    s_add_u32 s45, s32, 6
    s_add_u32 s46, s40, 73728
    s_cmp_ge_u32 s46, 147456
    s_cselect_b32 s35, 147456, 0
    s_sub_u32 s46, s46, s35
    s_min_u32 s45, s45, 63
    s_waitcnt lgkmcnt(4)
    v_mfma_f32_32x32x16_bf16 v[48:63], a[0:3], v[80:83], 0
    ds_read_b128 v[100:103], v5 offset:5120
    v_mfma_f32_32x32x16_bf16 v[64:79], a[4:7], v[80:83], 0
    s_waitcnt lgkmcnt(4)
    v_mfma_f32_32x32x16_bf16 v[48:63], a[8:11], v[84:87], v[48:63]
    ds_read_b128 v[80:83], v5 offset:6144
    v_cvt_pk_bf16_f32 v112, v16, v17
    v_mfma_f32_32x32x16_bf16 v[64:79], a[12:15], v[84:87], v[64:79]
    s_waitcnt lgkmcnt(4)
    v_cvt_pk_bf16_f32 v113, v24, v25
    v_mfma_f32_32x32x16_bf16 v[48:63], a[16:19], v[88:91], v[48:63]
    ds_read_b128 v[84:87], v5 offset:7168
    v_cvt_pk_bf16_f32 v114, v18, v19
    v_mfma_f32_32x32x16_bf16 v[64:79], a[20:23], v[88:91], v[64:79]
    s_waitcnt lgkmcnt(4)
    v_cvt_pk_bf16_f32 v115, v26, v27
    v_mfma_f32_32x32x16_bf16 v[48:63], a[24:27], v[92:95], v[48:63]
    ds_read_b128 v[88:91], v5 offset:8192
    buffer_store_dwordx4 v[112:115], v2, s[8:11], s47 offen offset:0 sc0 sc1
    v_mfma_f32_32x32x16_bf16 v[64:79], a[28:31], v[92:95], v[64:79]
    s_waitcnt lgkmcnt(4)
    v_cvt_pk_bf16_f32 v116, v20, v21
    v_mfma_f32_32x32x16_bf16 v[48:63], a[32:35], v[96:99], v[48:63]
    ds_read_b128 v[92:95], v5 offset:9216
    v_cvt_pk_bf16_f32 v117, v28, v29
    v_mfma_f32_32x32x16_bf16 v[64:79], a[36:39], v[96:99], v[64:79]
    s_waitcnt lgkmcnt(4)
    v_cvt_pk_bf16_f32 v118, v22, v23
    v_mfma_f32_32x32x16_bf16 v[48:63], a[40:43], v[100:103], v[48:63]
    ds_read_b128 v[96:99], v5 offset:10240
    v_cvt_pk_bf16_f32 v119, v30, v31
    v_mfma_f32_32x32x16_bf16 v[64:79], a[44:47], v[100:103], v[64:79]
    buffer_store_dwordx4 v[116:119], v2, s[8:11], s47 offen offset:1024 sc0 sc1
    s_waitcnt lgkmcnt(4)
    v_mfma_f32_32x32x16_bf16 v[48:63], a[48:51], v[80:83], v[48:63]
    ds_read_b128 v[100:103], v5 offset:11264
    v_cvt_pk_bf16_f32 v112, v32, v33
    v_mfma_f32_32x32x16_bf16 v[64:79], a[52:55], v[80:83], v[64:79]
    s_waitcnt lgkmcnt(4)
    v_cvt_pk_bf16_f32 v113, v40, v41
    v_mfma_f32_32x32x16_bf16 v[48:63], a[56:59], v[84:87], v[48:63]
    ds_read_b128 v[80:83], v5 offset:12288
    v_cvt_pk_bf16_f32 v114, v34, v35
    v_mfma_f32_32x32x16_bf16 v[64:79], a[60:63], v[84:87], v[64:79]
    s_waitcnt lgkmcnt(4)
    v_cvt_pk_bf16_f32 v115, v42, v43
    v_mfma_f32_32x32x16_bf16 v[48:63], a[64:67], v[88:91], v[48:63]
    ds_read_b128 v[84:87], v5 offset:13312
    buffer_store_dwordx4 v[112:115], v2, s[8:11], s47 offen offset:2048 sc0 sc1
    v_mfma_f32_32x32x16_bf16 v[64:79], a[68:71], v[88:91], v[64:79]
    s_waitcnt lgkmcnt(4)
    v_cvt_pk_bf16_f32 v116, v36, v37
    v_mfma_f32_32x32x16_bf16 v[48:63], a[72:75], v[92:95], v[48:63]
    ds_read_b128 v[88:91], v5 offset:14336
    v_cvt_pk_bf16_f32 v117, v44, v45
    v_mfma_f32_32x32x16_bf16 v[64:79], a[76:79], v[92:95], v[64:79]
    s_waitcnt lgkmcnt(4)
    v_cvt_pk_bf16_f32 v118, v38, v39
    v_mfma_f32_32x32x16_bf16 v[48:63], a[80:83], v[96:99], v[48:63]
    ds_read_b128 v[92:95], v5 offset:15360
    v_cvt_pk_bf16_f32 v119, v46, v47
    v_mfma_f32_32x32x16_bf16 v[64:79], a[84:87], v[96:99], v[64:79]
    buffer_store_dwordx4 v[116:119], v2, s[8:11], s47 offen offset:3072 sc0 sc1
    s_waitcnt lgkmcnt(4)
    v_mfma_f32_32x32x16_bf16 v[48:63], a[88:91], v[100:103], v[48:63]
    ds_read_b128 v[96:99], v5 offset:16384
    s_mul_i32 s35, s45, 36864
    s_add_u32 s35, s35, s42
    s_add_u32 s36, s46, s42
    s_mov_b32 m0, s36
    s_nop 0
    buffer_load_dwordx4 v0, s[8:11], s35 offen offset:0 sc1 lds
    v_mfma_f32_32x32x16_bf16 v[64:79], a[92:95], v[100:103], v[64:79]
    buffer_load_dwordx4 v0, s[8:11], s35 offen offset:1024 sc1 lds
    s_waitcnt lgkmcnt(4)
    v_mfma_f32_32x32x16_bf16 v[48:63], a[96:99], v[80:83], v[48:63]
    ds_read_b128 v[100:103], v5 offset:17408
    buffer_load_dwordx4 v0, s[8:11], s35 offen offset:2048 sc1 lds
    v_mfma_f32_32x32x16_bf16 v[64:79], a[100:103], v[80:83], v[64:79]
    buffer_load_dwordx4 v0, s[8:11], s35 offen offset:3072 sc1 lds
    s_waitcnt lgkmcnt(4)
    v_mfma_f32_32x32x16_bf16 v[48:63], a[104:107], v[84:87], v[48:63]
    ds_read_b128 v[80:83], v5 offset:18432
    s_add_u32 s35, s35, 4096
    s_add_u32 s36, s36, 4096
    s_mov_b32 m0, s36
    s_nop 0
    buffer_load_dwordx4 v0, s[8:11], s35 offen offset:0 sc1 lds
    v_mfma_f32_32x32x16_bf16 v[64:79], a[108:111], v[84:87], v[64:79]
    buffer_load_dwordx4 v0, s[8:11], s35 offen offset:1024 sc1 lds
    s_waitcnt lgkmcnt(4)
    v_mfma_f32_32x32x16_bf16 v[48:63], a[112:115], v[88:91], v[48:63]
    ds_read_b128 v[84:87], v5 offset:19456
    buffer_load_dwordx4 v0, s[8:11], s35 offen offset:2048 sc1 lds
    v_mfma_f32_32x32x16_bf16 v[64:79], a[116:119], v[88:91], v[64:79]
    buffer_load_dwordx4 v0, s[8:11], s35 offen offset:3072 sc1 lds
    s_waitcnt lgkmcnt(4)
    v_mfma_f32_32x32x16_bf16 v[48:63], a[120:123], v[92:95], v[48:63]
    ds_read_b128 v[88:91], v5 offset:20480
    s_add_u32 s35, s35, 4096
    s_add_u32 s36, s36, 4096
    s_mov_b32 m0, s36
    s_nop 0
    buffer_load_dwordx4 v0, s[8:11], s35 offen offset:0 sc1 lds
    v_mfma_f32_32x32x16_bf16 v[64:79], a[124:127], v[92:95], v[64:79]
    s_waitcnt lgkmcnt(4)
    v_mfma_f32_32x32x16_bf16 v[48:63], a[128:131], v[96:99], v[48:63]
    ds_read_b128 v[92:95], v5 offset:21504
    v_mfma_f32_32x32x16_bf16 v[64:79], a[132:135], v[96:99], v[64:79]
    s_waitcnt lgkmcnt(4)
    v_mfma_f32_32x32x16_bf16 v[48:63], a[136:139], v[100:103], v[48:63]
    ds_read_b128 v[96:99], v5 offset:22528
    v_mfma_f32_32x32x16_bf16 v[64:79], a[140:143], v[100:103], v[64:79]
    s_waitcnt lgkmcnt(4)
    v_mfma_f32_32x32x16_bf16 v[48:63], a[144:147], v[80:83], v[48:63]
    ds_read_b128 v[100:103], v5 offset:23552
    v_mfma_f32_32x32x16_bf16 v[64:79], a[148:151], v[80:83], v[64:79]
    s_waitcnt lgkmcnt(4)
    v_mfma_f32_32x32x16_bf16 v[48:63], a[152:155], v[84:87], v[48:63]
    ds_read_b128 v[80:83], v5 offset:24576
    v_mfma_f32_32x32x16_bf16 v[64:79], a[156:159], v[84:87], v[64:79]
    s_waitcnt lgkmcnt(4)
    v_mfma_f32_32x32x16_bf16 v[48:63], a[160:163], v[88:91], v[48:63]
    ds_read_b128 v[84:87], v5 offset:25600
    v_mfma_f32_32x32x16_bf16 v[64:79], a[164:167], v[88:91], v[64:79]
    s_waitcnt lgkmcnt(4)
    v_mfma_f32_32x32x16_bf16 v[48:63], a[168:171], v[92:95], v[48:63]
    ds_read_b128 v[88:91], v5 offset:26624
    v_mfma_f32_32x32x16_bf16 v[64:79], a[172:175], v[92:95], v[64:79]
    s_waitcnt lgkmcnt(4)
    v_mfma_f32_32x32x16_bf16 v[48:63], a[176:179], v[96:99], v[48:63]
    ds_read_b128 v[92:95], v5 offset:27648
    v_mfma_f32_32x32x16_bf16 v[64:79], a[180:183], v[96:99], v[64:79]
    s_waitcnt lgkmcnt(4)
    v_mfma_f32_32x32x16_bf16 v[48:63], a[184:187], v[100:103], v[48:63]
    ds_read_b128 v[96:99], v5 offset:28672
    v_mfma_f32_32x32x16_bf16 v[64:79], a[188:191], v[100:103], v[64:79]
    s_waitcnt lgkmcnt(4)
    v_mfma_f32_32x32x16_bf16 v[48:63], a[192:195], v[80:83], v[48:63]
    ds_read_b128 v[100:103], v5 offset:29696
    v_mfma_f32_32x32x16_bf16 v[64:79], a[196:199], v[80:83], v[64:79]
    s_waitcnt lgkmcnt(4)
    v_mfma_f32_32x32x16_bf16 v[48:63], a[200:203], v[84:87], v[48:63]
    ds_read_b128 v[80:83], v5 offset:30720
    v_mfma_f32_32x32x16_bf16 v[64:79], a[204:207], v[84:87], v[64:79]
    s_waitcnt lgkmcnt(4)
    v_mfma_f32_32x32x16_bf16 v[48:63], a[208:211], v[88:91], v[48:63]
    ds_read_b128 v[84:87], v5 offset:31744
    v_mfma_f32_32x32x16_bf16 v[64:79], a[212:215], v[88:91], v[64:79]
    s_waitcnt lgkmcnt(4)
    v_mfma_f32_32x32x16_bf16 v[48:63], a[216:219], v[92:95], v[48:63]
    ds_read_b128 v[88:91], v5 offset:32768
    v_mfma_f32_32x32x16_bf16 v[64:79], a[220:223], v[92:95], v[64:79]
    s_waitcnt lgkmcnt(4)
    v_mfma_f32_32x32x16_bf16 v[48:63], a[224:227], v[96:99], v[48:63]
    ds_read_b128 v[92:95], v5 offset:33792
    v_mfma_f32_32x32x16_bf16 v[64:79], a[228:231], v[96:99], v[64:79]
    s_waitcnt lgkmcnt(4)
    v_mfma_f32_32x32x16_bf16 v[48:63], a[232:235], v[100:103], v[48:63]
    ds_read_b128 v[96:99], v5 offset:34816
    v_mfma_f32_32x32x16_bf16 v[64:79], a[236:239], v[100:103], v[64:79]
    s_waitcnt lgkmcnt(4)
    v_mfma_f32_32x32x16_bf16 v[48:63], a[240:243], v[80:83], v[48:63]
    ds_read_b128 v[100:103], v5 offset:35840
    v_mfma_f32_32x32x16_bf16 v[64:79], a[244:247], v[80:83], v[64:79]
    s_waitcnt lgkmcnt(4)
    v_mfma_f32_32x32x16_bf16 v[48:63], a[248:251], v[84:87], v[48:63]
    v_mfma_f32_32x32x16_bf16 v[64:79], a[252:255], v[84:87], v[64:79]
    s_waitcnt lgkmcnt(3)
    v_mfma_f32_32x32x16_bf16 v[48:63], v[252:255], v[88:91], v[48:63]
    v_mfma_f32_32x32x16_bf16 v[64:79], v[248:251], v[88:91], v[64:79]
    s_waitcnt lgkmcnt(2)
    v_mfma_f32_32x32x16_bf16 v[48:63], v[244:247], v[92:95], v[48:63]
    v_mfma_f32_32x32x16_bf16 v[64:79], v[240:243], v[92:95], v[64:79]
    s_waitcnt lgkmcnt(1)
    v_mfma_f32_32x32x16_bf16 v[48:63], v[236:239], v[96:99], v[48:63]
    v_mfma_f32_32x32x16_bf16 v[64:79], v[232:235], v[96:99], v[64:79]
    s_waitcnt lgkmcnt(0)
    v_mfma_f32_32x32x16_bf16 v[48:63], v[228:231], v[100:103], v[48:63]
    v_mfma_f32_32x32x16_bf16 v[64:79], v[224:227], v[100:103], v[64:79]
    s_mov_b32 s47, s34
    s_add_u32 s34, s34, s37
    s_add_u32 s40, s40, 36864
    s_cmp_ge_u32 s40, 147456
    s_cselect_b32 s40, 0, s40
    s_add_u32 s33, s33, 1
    s_add_u32 s32, s32, 3
    s_cmp_ge_u32 s32, 64
    s_cbranch_scc1 Lga_QK1e
    s_branch Lga_QK0
Lga_QK0e:
    s_nop 15
    s_nop 3
    v_cvt_pk_bf16_f32 v112, v16, v17
    v_cvt_pk_bf16_f32 v113, v24, v25
    v_cvt_pk_bf16_f32 v114, v18, v19
    v_cvt_pk_bf16_f32 v115, v26, v27
    buffer_store_dwordx4 v[112:115], v2, s[8:11], s47 offen offset:0 sc0 sc1
    v_cvt_pk_bf16_f32 v116, v20, v21
    v_cvt_pk_bf16_f32 v117, v28, v29
    v_cvt_pk_bf16_f32 v118, v22, v23
    v_cvt_pk_bf16_f32 v119, v30, v31
    buffer_store_dwordx4 v[116:119], v2, s[8:11], s47 offen offset:1024 sc0 sc1
    v_cvt_pk_bf16_f32 v112, v32, v33
    v_cvt_pk_bf16_f32 v113, v40, v41
    v_cvt_pk_bf16_f32 v114, v34, v35
    v_cvt_pk_bf16_f32 v115, v42, v43
    buffer_store_dwordx4 v[112:115], v2, s[8:11], s47 offen offset:2048 sc0 sc1
    v_cvt_pk_bf16_f32 v116, v36, v37
    v_cvt_pk_bf16_f32 v117, v44, v45
    v_cvt_pk_bf16_f32 v118, v38, v39
    v_cvt_pk_bf16_f32 v119, v46, v47
    buffer_store_dwordx4 v[116:119], v2, s[8:11], s47 offen offset:3072 sc0 sc1
    s_branch Lga_end
Lga_QK1e:
    s_nop 15
    s_nop 3
    v_cvt_pk_bf16_f32 v112, v48, v49
    v_cvt_pk_bf16_f32 v113, v56, v57
    v_cvt_pk_bf16_f32 v114, v50, v51
    v_cvt_pk_bf16_f32 v115, v58, v59
    buffer_store_dwordx4 v[112:115], v2, s[8:11], s47 offen offset:0 sc0 sc1
    v_cvt_pk_bf16_f32 v116, v52, v53
    v_cvt_pk_bf16_f32 v117, v60, v61
    v_cvt_pk_bf16_f32 v118, v54, v55
    v_cvt_pk_bf16_f32 v119, v62, v63
    buffer_store_dwordx4 v[116:119], v2, s[8:11], s47 offen offset:1024 sc0 sc1
    v_cvt_pk_bf16_f32 v112, v64, v65
    v_cvt_pk_bf16_f32 v113, v72, v73
    v_cvt_pk_bf16_f32 v114, v66, v67
    v_cvt_pk_bf16_f32 v115, v74, v75
    buffer_store_dwordx4 v[112:115], v2, s[8:11], s47 offen offset:2048 sc0 sc1
    v_cvt_pk_bf16_f32 v116, v68, v69
    v_cvt_pk_bf16_f32 v117, v76, v77
    v_cvt_pk_bf16_f32 v118, v70, v71
    v_cvt_pk_bf16_f32 v119, v78, v79
    buffer_store_dwordx4 v[116:119], v2, s[8:11], s47 offen offset:3072 sc0 sc1
    s_branch Lga_end
Lga_V:
    s_nop 15
    s_nop 3
Lga_V0:
    s_waitcnt vmcnt(9)
    s_barrier
    s_cmp_lt_u32 s33, 2
    s_cbranch_scc1 Lga_V0n
    s_cmp_lg_u32 s29, 0
    s_cbranch_scc1 Lga_V0n
    s_sub_u32 s35, s33, 1
    v_mov_b32 v6, 0
    v_mov_b32 v7, s35
    s_mov_b64 exec, 1
    buffer_store_dword v7, v6, s[8:11], s41 offen sc0 sc1
    s_mov_b64 exec, -1
Lga_V0n:
    v_add_u32 v5, s40, v0
    ds_read_b128 v[80:83], v5 offset:0
    ds_read_b128 v[84:87], v5 offset:1024
    ds_read_b128 v[88:91], v5 offset:2048
    ds_read_b128 v[92:95], v5 offset:3072
    ds_read_b128 v[96:99], v5 offset:4096
    s_add_u32 s45, s32, 6
    s_add_u32 s46, s40, 73728
    s_cmp_ge_u32 s46, 147456
    s_cselect_b32 s35, 147456, 0
    s_sub_u32 s46, s46, s35
    s_min_u32 s45, s45, 63
    s_waitcnt lgkmcnt(4)
    v_mfma_f32_32x32x16_bf16 v[16:31], v[80:83], a[0:3], 0
    ds_read_b128 v[100:103], v5 offset:5120
    v_mfma_f32_32x32x16_bf16 v[32:47], v[80:83], a[4:7], 0
    s_waitcnt lgkmcnt(4)
    v_mfma_f32_32x32x16_bf16 v[16:31], v[84:87], a[8:11], v[16:31]
    ds_read_b128 v[80:83], v5 offset:6144
    v_cvt_pk_bf16_f32 v112, v48, v49
    v_mfma_f32_32x32x16_bf16 v[32:47], v[84:87], a[12:15], v[32:47]
    s_waitcnt lgkmcnt(4)
    v_cvt_pk_bf16_f32 v113, v50, v51
    v_mfma_f32_32x32x16_bf16 v[16:31], v[88:91], a[16:19], v[16:31]
    ds_read_b128 v[84:87], v5 offset:7168
    v_cvt_pk_bf16_f32 v114, v52, v53
    v_mfma_f32_32x32x16_bf16 v[32:47], v[88:91], a[20:23], v[32:47]
    s_waitcnt lgkmcnt(4)
    v_cvt_pk_bf16_f32 v115, v54, v55
    v_mfma_f32_32x32x16_bf16 v[16:31], v[92:95], a[24:27], v[16:31]
    ds_read_b128 v[88:91], v5 offset:8192
    buffer_store_dwordx4 v[112:115], v2, s[8:11], s47 offen offset:0 sc0 sc1
    v_mfma_f32_32x32x16_bf16 v[32:47], v[92:95], a[28:31], v[32:47]
    s_waitcnt lgkmcnt(4)
    v_cvt_pk_bf16_f32 v116, v56, v57
    v_mfma_f32_32x32x16_bf16 v[16:31], v[96:99], a[32:35], v[16:31]
    ds_read_b128 v[92:95], v5 offset:9216
    v_cvt_pk_bf16_f32 v117, v58, v59
    v_mfma_f32_32x32x16_bf16 v[32:47], v[96:99], a[36:39], v[32:47]
    s_waitcnt lgkmcnt(4)
    v_cvt_pk_bf16_f32 v118, v60, v61
    v_mfma_f32_32x32x16_bf16 v[16:31], v[100:103], a[40:43], v[16:31]
    ds_read_b128 v[96:99], v5 offset:10240
    v_cvt_pk_bf16_f32 v119, v62, v63
    v_mfma_f32_32x32x16_bf16 v[32:47], v[100:103], a[44:47], v[32:47]
    buffer_store_dwordx4 v[116:119], v2, s[8:11], s47 offen offset:1024 sc0 sc1
    s_waitcnt lgkmcnt(4)
    v_mfma_f32_32x32x16_bf16 v[16:31], v[80:83], a[48:51], v[16:31]
    ds_read_b128 v[100:103], v5 offset:11264
    v_cvt_pk_bf16_f32 v112, v64, v65
    v_mfma_f32_32x32x16_bf16 v[32:47], v[80:83], a[52:55], v[32:47]
    s_waitcnt lgkmcnt(4)
    v_cvt_pk_bf16_f32 v113, v66, v67
    v_mfma_f32_32x32x16_bf16 v[16:31], v[84:87], a[56:59], v[16:31]
    ds_read_b128 v[80:83], v5 offset:12288
    v_cvt_pk_bf16_f32 v114, v68, v69
    v_mfma_f32_32x32x16_bf16 v[32:47], v[84:87], a[60:63], v[32:47]
    s_waitcnt lgkmcnt(4)
    v_cvt_pk_bf16_f32 v115, v70, v71
    v_mfma_f32_32x32x16_bf16 v[16:31], v[88:91], a[64:67], v[16:31]
    ds_read_b128 v[84:87], v5 offset:13312
    buffer_store_dwordx4 v[112:115], v2, s[8:11], s47 offen offset:2048 sc0 sc1
    v_mfma_f32_32x32x16_bf16 v[32:47], v[88:91], a[68:71], v[32:47]
    s_waitcnt lgkmcnt(4)
    v_cvt_pk_bf16_f32 v116, v72, v73
    v_mfma_f32_32x32x16_bf16 v[16:31], v[92:95], a[72:75], v[16:31]
    ds_read_b128 v[88:91], v5 offset:14336
    v_cvt_pk_bf16_f32 v117, v74, v75
    v_mfma_f32_32x32x16_bf16 v[32:47], v[92:95], a[76:79], v[32:47]
    s_waitcnt lgkmcnt(4)
    v_cvt_pk_bf16_f32 v118, v76, v77
    v_mfma_f32_32x32x16_bf16 v[16:31], v[96:99], a[80:83], v[16:31]
    ds_read_b128 v[92:95], v5 offset:15360
    v_cvt_pk_bf16_f32 v119, v78, v79
    v_mfma_f32_32x32x16_bf16 v[32:47], v[96:99], a[84:87], v[32:47]
    buffer_store_dwordx4 v[116:119], v2, s[8:11], s47 offen offset:3072 sc0 sc1
    s_waitcnt lgkmcnt(4)
    v_mfma_f32_32x32x16_bf16 v[16:31], v[100:103], a[88:91], v[16:31]
    ds_read_b128 v[96:99], v5 offset:16384
    s_mul_i32 s35, s45, 36864
    s_add_u32 s35, s35, s42
    s_add_u32 s36, s46, s42
    s_mov_b32 m0, s36
    s_nop 0
    buffer_load_dwordx4 v0, s[8:11], s35 offen offset:0 sc1 lds
    v_mfma_f32_32x32x16_bf16 v[32:47], v[100:103], a[92:95], v[32:47]
    buffer_load_dwordx4 v0, s[8:11], s35 offen offset:1024 sc1 lds
    s_waitcnt lgkmcnt(4)
    v_mfma_f32_32x32x16_bf16 v[16:31], v[80:83], a[96:99], v[16:31]
    ds_read_b128 v[100:103], v5 offset:17408
    buffer_load_dwordx4 v0, s[8:11], s35 offen offset:2048 sc1 lds
    v_mfma_f32_32x32x16_bf16 v[32:47], v[80:83], a[100:103], v[32:47]
    buffer_load_dwordx4 v0, s[8:11], s35 offen offset:3072 sc1 lds
    s_waitcnt lgkmcnt(4)
    v_mfma_f32_32x32x16_bf16 v[16:31], v[84:87], a[104:107], v[16:31]
    ds_read_b128 v[80:83], v5 offset:18432
    s_add_u32 s35, s35, 4096
    s_add_u32 s36, s36, 4096
    s_mov_b32 m0, s36
    s_nop 0
    buffer_load_dwordx4 v0, s[8:11], s35 offen offset:0 sc1 lds
    v_mfma_f32_32x32x16_bf16 v[32:47], v[84:87], a[108:111], v[32:47]
    buffer_load_dwordx4 v0, s[8:11], s35 offen offset:1024 sc1 lds
    s_waitcnt lgkmcnt(4)
    v_mfma_f32_32x32x16_bf16 v[16:31], v[88:91], a[112:115], v[16:31]
    ds_read_b128 v[84:87], v5 offset:19456
    buffer_load_dwordx4 v0, s[8:11], s35 offen offset:2048 sc1 lds
    v_mfma_f32_32x32x16_bf16 v[32:47], v[88:91], a[116:119], v[32:47]
    buffer_load_dwordx4 v0, s[8:11], s35 offen offset:3072 sc1 lds
    s_waitcnt lgkmcnt(4)
    v_mfma_f32_32x32x16_bf16 v[16:31], v[92:95], a[120:123], v[16:31]
    ds_read_b128 v[88:91], v5 offset:20480
    s_add_u32 s35, s35, 4096
    s_add_u32 s36, s36, 4096
    s_mov_b32 m0, s36
    s_nop 0
    buffer_load_dwordx4 v0, s[8:11], s35 offen offset:0 sc1 lds
    v_mfma_f32_32x32x16_bf16 v[32:47], v[92:95], a[124:127], v[32:47]
    s_waitcnt lgkmcnt(4)
    v_mfma_f32_32x32x16_bf16 v[16:31], v[96:99], a[128:131], v[16:31]
    ds_read_b128 v[92:95], v5 offset:21504
    v_mfma_f32_32x32x16_bf16 v[32:47], v[96:99], a[132:135], v[32:47]
    s_waitcnt lgkmcnt(4)
    v_mfma_f32_32x32x16_bf16 v[16:31], v[100:103], a[136:139], v[16:31]
    ds_read_b128 v[96:99], v5 offset:22528
    v_mfma_f32_32x32x16_bf16 v[32:47], v[100:103], a[140:143], v[32:47]
    s_waitcnt lgkmcnt(4)
    v_mfma_f32_32x32x16_bf16 v[16:31], v[80:83], a[144:147], v[16:31]
    ds_read_b128 v[100:103], v5 offset:23552
    v_mfma_f32_32x32x16_bf16 v[32:47], v[80:83], a[148:151], v[32:47]
    s_waitcnt lgkmcnt(4)
    v_mfma_f32_32x32x16_bf16 v[16:31], v[84:87], a[152:155], v[16:31]
    ds_read_b128 v[80:83], v5 offset:24576
    v_mfma_f32_32x32x16_bf16 v[32:47], v[84:87], a[156:159], v[32:47]
    s_waitcnt lgkmcnt(4)
    v_mfma_f32_32x32x16_bf16 v[16:31], v[88:91], a[160:163], v[16:31]
    ds_read_b128 v[84:87], v5 offset:25600
    v_mfma_f32_32x32x16_bf16 v[32:47], v[88:91], a[164:167], v[32:47]
    s_waitcnt lgkmcnt(4)
    v_mfma_f32_32x32x16_bf16 v[16:31], v[92:95], a[168:171], v[16:31]
    ds_read_b128 v[88:91], v5 offset:26624
    v_mfma_f32_32x32x16_bf16 v[32:47], v[92:95], a[172:175], v[32:47]
    s_waitcnt lgkmcnt(4)
    v_mfma_f32_32x32x16_bf16 v[16:31], v[96:99], a[176:179], v[16:31]
    ds_read_b128 v[92:95], v5 offset:27648
    v_mfma_f32_32x32x16_bf16 v[32:47], v[96:99], a[180:183], v[32:47]
    s_waitcnt lgkmcnt(4)
    v_mfma_f32_32x32x16_bf16 v[16:31], v[100:103], a[184:187], v[16:31]
    ds_read_b128 v[96:99], v5 offset:28672
    v_mfma_f32_32x32x16_bf16 v[32:47], v[100:103], a[188:191], v[32:47]
    s_waitcnt lgkmcnt(4)
    v_mfma_f32_32x32x16_bf16 v[16:31], v[80:83], a[192:195], v[16:31]
    ds_read_b128 v[100:103], v5 offset:29696
    v_mfma_f32_32x32x16_bf16 v[32:47], v[80:83], a[196:199], v[32:47]
    s_waitcnt lgkmcnt(4)
    v_mfma_f32_32x32x16_bf16 v[16:31], v[84:87], a[200:203], v[16:31]
    ds_read_b128 v[80:83], v5 offset:30720
    v_mfma_f32_32x32x16_bf16 v[32:47], v[84:87], a[204:207], v[32:47]
    s_waitcnt lgkmcnt(4)
    v_mfma_f32_32x32x16_bf16 v[16:31], v[88:91], a[208:211], v[16:31]
    ds_read_b128 v[84:87], v5 offset:31744
    v_mfma_f32_32x32x16_bf16 v[32:47], v[88:91], a[212:215], v[32:47]
    s_waitcnt lgkmcnt(4)
    v_mfma_f32_32x32x16_bf16 v[16:31], v[92:95], a[216:219], v[16:31]
    ds_read_b128 v[88:91], v5 offset:32768
    v_mfma_f32_32x32x16_bf16 v[32:47], v[92:95], a[220:223], v[32:47]
    s_waitcnt lgkmcnt(4)
    v_mfma_f32_32x32x16_bf16 v[16:31], v[96:99], a[224:227], v[16:31]
    ds_read_b128 v[92:95], v5 offset:33792
    v_mfma_f32_32x32x16_bf16 v[32:47], v[96:99], a[228:231], v[32:47]
    s_waitcnt lgkmcnt(4)
    v_mfma_f32_32x32x16_bf16 v[16:31], v[100:103], a[232:235], v[16:31]
    ds_read_b128 v[96:99], v5 offset:34816
    v_mfma_f32_32x32x16_bf16 v[32:47], v[100:103], a[236:239], v[32:47]
    s_waitcnt lgkmcnt(4)
    v_mfma_f32_32x32x16_bf16 v[16:31], v[80:83], a[240:243], v[16:31]
    ds_read_b128 v[100:103], v5 offset:35840
    v_mfma_f32_32x32x16_bf16 v[32:47], v[80:83], a[244:247], v[32:47]
    s_waitcnt lgkmcnt(4)
    v_mfma_f32_32x32x16_bf16 v[16:31], v[84:87], a[248:251], v[16:31]
    v_mfma_f32_32x32x16_bf16 v[32:47], v[84:87], a[252:255], v[32:47]
    s_waitcnt lgkmcnt(3)
    v_mfma_f32_32x32x16_bf16 v[16:31], v[88:91], v[252:255], v[16:31]
    v_mfma_f32_32x32x16_bf16 v[32:47], v[88:91], v[248:251], v[32:47]
    s_waitcnt lgkmcnt(2)
    v_mfma_f32_32x32x16_bf16 v[16:31], v[92:95], v[244:247], v[16:31]
    v_mfma_f32_32x32x16_bf16 v[32:47], v[92:95], v[240:243], v[32:47]
    s_waitcnt lgkmcnt(1)
    v_mfma_f32_32x32x16_bf16 v[16:31], v[96:99], v[236:239], v[16:31]
    v_mfma_f32_32x32x16_bf16 v[32:47], v[96:99], v[232:235], v[32:47]
    s_waitcnt lgkmcnt(0)
    v_mfma_f32_32x32x16_bf16 v[16:31], v[100:103], v[228:231], v[16:31]
    v_mfma_f32_32x32x16_bf16 v[32:47], v[100:103], v[224:227], v[32:47]
    s_mov_b32 s47, s34
    s_add_u32 s34, s34, s37
    s_add_u32 s40, s40, 36864
    s_cmp_ge_u32 s40, 147456
    s_cselect_b32 s40, 0, s40
    s_add_u32 s33, s33, 1
    s_add_u32 s32, s32, 3
    s_cmp_ge_u32 s32, 64
    s_cbranch_scc1 Lga_V0e
Lga_V1:
    s_waitcnt vmcnt(9)
    s_barrier
    s_cmp_lt_u32 s33, 2
    s_cbranch_scc1 Lga_V1n
    s_cmp_lg_u32 s29, 0
    s_cbranch_scc1 Lga_V1n
    s_sub_u32 s35, s33, 1
    v_mov_b32 v6, 0
    v_mov_b32 v7, s35
    s_mov_b64 exec, 1
    buffer_store_dword v7, v6, s[8:11], s41 offen sc0 sc1
    s_mov_b64 exec, -1
Lga_V1n:
    v_add_u32 v5, s40, v0
    ds_read_b128 v[80:83], v5 offset:0
    ds_read_b128 v[84:87], v5 offset:1024
    ds_read_b128 v[88:91], v5 offset:2048
    ds_read_b128 v[92:95], v5 offset:3072
    ds_read_b128 v[96:99], v5 offset:4096
    s_add_u32 s45, s32, 6
    s_add_u32 s46, s40, 73728
    s_cmp_ge_u32 s46, 147456
    s_cselect_b32 s35, 147456, 0
    s_sub_u32 s46, s46, s35
    s_min_u32 s45, s45, 63
    s_waitcnt lgkmcnt(4)
    v_mfma_f32_32x32x16_bf16 v[48:63], v[80:83], a[0:3], 0
    ds_read_b128 v[100:103], v5 offset:5120
    v_mfma_f32_32x32x16_bf16 v[64:79], v[80:83], a[4:7], 0
    s_waitcnt lgkmcnt(4)
    v_mfma_f32_32x32x16_bf16 v[48:63], v[84:87], a[8:11], v[48:63]
    ds_read_b128 v[80:83], v5 offset:6144
    v_cvt_pk_bf16_f32 v112, v16, v17
    v_mfma_f32_32x32x16_bf16 v[64:79], v[84:87], a[12:15], v[64:79]
    s_waitcnt lgkmcnt(4)
    v_cvt_pk_bf16_f32 v113, v18, v19
    v_mfma_f32_32x32x16_bf16 v[48:63], v[88:91], a[16:19], v[48:63]
    ds_read_b128 v[84:87], v5 offset:7168
    v_cvt_pk_bf16_f32 v114, v20, v21
    v_mfma_f32_32x32x16_bf16 v[64:79], v[88:91], a[20:23], v[64:79]
    s_waitcnt lgkmcnt(4)
    v_cvt_pk_bf16_f32 v115, v22, v23
    v_mfma_f32_32x32x16_bf16 v[48:63], v[92:95], a[24:27], v[48:63]
    ds_read_b128 v[88:91], v5 offset:8192
    buffer_store_dwordx4 v[112:115], v2, s[8:11], s47 offen offset:0 sc0 sc1
    v_mfma_f32_32x32x16_bf16 v[64:79], v[92:95], a[28:31], v[64:79]
    s_waitcnt lgkmcnt(4)
    v_cvt_pk_bf16_f32 v116, v24, v25
    v_mfma_f32_32x32x16_bf16 v[48:63], v[96:99], a[32:35], v[48:63]
    ds_read_b128 v[92:95], v5 offset:9216
    v_cvt_pk_bf16_f32 v117, v26, v27
    v_mfma_f32_32x32x16_bf16 v[64:79], v[96:99], a[36:39], v[64:79]
    s_waitcnt lgkmcnt(4)
    v_cvt_pk_bf16_f32 v118, v28, v29
    v_mfma_f32_32x32x16_bf16 v[48:63], v[100:103], a[40:43], v[48:63]
    ds_read_b128 v[96:99], v5 offset:10240
    v_cvt_pk_bf16_f32 v119, v30, v31
    v_mfma_f32_32x32x16_bf16 v[64:79], v[100:103], a[44:47], v[64:79]
    buffer_store_dwordx4 v[116:119], v2, s[8:11], s47 offen offset:1024 sc0 sc1
    s_waitcnt lgkmcnt(4)
    v_mfma_f32_32x32x16_bf16 v[48:63], v[80:83], a[48:51], v[48:63]
    ds_read_b128 v[100:103], v5 offset:11264
    v_cvt_pk_bf16_f32 v112, v32, v33
    v_mfma_f32_32x32x16_bf16 v[64:79], v[80:83], a[52:55], v[64:79]
    s_waitcnt lgkmcnt(4)
    v_cvt_pk_bf16_f32 v113, v34, v35
    v_mfma_f32_32x32x16_bf16 v[48:63], v[84:87], a[56:59], v[48:63]
    ds_read_b128 v[80:83], v5 offset:12288
    v_cvt_pk_bf16_f32 v114, v36, v37
    v_mfma_f32_32x32x16_bf16 v[64:79], v[84:87], a[60:63], v[64:79]
    s_waitcnt lgkmcnt(4)
    v_cvt_pk_bf16_f32 v115, v38, v39
    v_mfma_f32_32x32x16_bf16 v[48:63], v[88:91], a[64:67], v[48:63]
    ds_read_b128 v[84:87], v5 offset:13312
    buffer_store_dwordx4 v[112:115], v2, s[8:11], s47 offen offset:2048 sc0 sc1
    v_mfma_f32_32x32x16_bf16 v[64:79], v[88:91], a[68:71], v[64:79]
    s_waitcnt lgkmcnt(4)
    v_cvt_pk_bf16_f32 v116, v40, v41
    v_mfma_f32_32x32x16_bf16 v[48:63], v[92:95], a[72:75], v[48:63]
    ds_read_b128 v[88:91], v5 offset:14336
    v_cvt_pk_bf16_f32 v117, v42, v43
    v_mfma_f32_32x32x16_bf16 v[64:79], v[92:95], a[76:79], v[64:79]
    s_waitcnt lgkmcnt(4)
    v_cvt_pk_bf16_f32 v118, v44, v45
    v_mfma_f32_32x32x16_bf16 v[48:63], v[96:99], a[80:83], v[48:63]
    ds_read_b128 v[92:95], v5 offset:15360
    v_cvt_pk_bf16_f32 v119, v46, v47
    v_mfma_f32_32x32x16_bf16 v[64:79], v[96:99], a[84:87], v[64:79]
    buffer_store_dwordx4 v[116:119], v2, s[8:11], s47 offen offset:3072 sc0 sc1
    s_waitcnt lgkmcnt(4)
    v_mfma_f32_32x32x16_bf16 v[48:63], v[100:103], a[88:91], v[48:63]
    ds_read_b128 v[96:99], v5 offset:16384
    s_mul_i32 s35, s45, 36864
    s_add_u32 s35, s35, s42
    s_add_u32 s36, s46, s42
    s_mov_b32 m0, s36
    s_nop 0
    buffer_load_dwordx4 v0, s[8:11], s35 offen offset:0 sc1 lds
    v_mfma_f32_32x32x16_bf16 v[64:79], v[100:103], a[92:95], v[64:79]
    buffer_load_dwordx4 v0, s[8:11], s35 offen offset:1024 sc1 lds
    s_waitcnt lgkmcnt(4)
    v_mfma_f32_32x32x16_bf16 v[48:63], v[80:83], a[96:99], v[48:63]
    ds_read_b128 v[100:103], v5 offset:17408
    buffer_load_dwordx4 v0, s[8:11], s35 offen offset:2048 sc1 lds
    v_mfma_f32_32x32x16_bf16 v[64:79], v[80:83], a[100:103], v[64:79]
    buffer_load_dwordx4 v0, s[8:11], s35 offen offset:3072 sc1 lds
    s_waitcnt lgkmcnt(4)
    v_mfma_f32_32x32x16_bf16 v[48:63], v[84:87], a[104:107], v[48:63]
    ds_read_b128 v[80:83], v5 offset:18432
    s_add_u32 s35, s35, 4096
    s_add_u32 s36, s36, 4096
    s_mov_b32 m0, s36
    s_nop 0
    buffer_load_dwordx4 v0, s[8:11], s35 offen offset:0 sc1 lds
    v_mfma_f32_32x32x16_bf16 v[64:79], v[84:87], a[108:111], v[64:79]
    buffer_load_dwordx4 v0, s[8:11], s35 offen offset:1024 sc1 lds
    s_waitcnt lgkmcnt(4)
    v_mfma_f32_32x32x16_bf16 v[48:63], v[88:91], a[112:115], v[48:63]
    ds_read_b128 v[84:87], v5 offset:19456
    buffer_load_dwordx4 v0, s[8:11], s35 offen offset:2048 sc1 lds
    v_mfma_f32_32x32x16_bf16 v[64:79], v[88:91], a[116:119], v[64:79]
    buffer_load_dwordx4 v0, s[8:11], s35 offen offset:3072 sc1 lds
    s_waitcnt lgkmcnt(4)
    v_mfma_f32_32x32x16_bf16 v[48:63], v[92:95], a[120:123], v[48:63]
    ds_read_b128 v[88:91], v5 offset:20480
    s_add_u32 s35, s35, 4096
    s_add_u32 s36, s36, 4096
    s_mov_b32 m0, s36
    s_nop 0
    buffer_load_dwordx4 v0, s[8:11], s35 offen offset:0 sc1 lds
    v_mfma_f32_32x32x16_bf16 v[64:79], v[92:95], a[124:127], v[64:79]
    s_waitcnt lgkmcnt(4)
    v_mfma_f32_32x32x16_bf16 v[48:63], v[96:99], a[128:131], v[48:63]
    ds_read_b128 v[92:95], v5 offset:21504
    v_mfma_f32_32x32x16_bf16 v[64:79], v[96:99], a[132:135], v[64:79]
    s_waitcnt lgkmcnt(4)
    v_mfma_f32_32x32x16_bf16 v[48:63], v[100:103], a[136:139], v[48:63]
    ds_read_b128 v[96:99], v5 offset:22528
    v_mfma_f32_32x32x16_bf16 v[64:79], v[100:103], a[140:143], v[64:79]
    s_waitcnt lgkmcnt(4)
    v_mfma_f32_32x32x16_bf16 v[48:63], v[80:83], a[144:147], v[48:63]
    ds_read_b128 v[100:103], v5 offset:23552
    v_mfma_f32_32x32x16_bf16 v[64:79], v[80:83], a[148:151], v[64:79]
    s_waitcnt lgkmcnt(4)
    v_mfma_f32_32x32x16_bf16 v[48:63], v[84:87], a[152:155], v[48:63]
    ds_read_b128 v[80:83], v5 offset:24576
    v_mfma_f32_32x32x16_bf16 v[64:79], v[84:87], a[156:159], v[64:79]
    s_waitcnt lgkmcnt(4)
    v_mfma_f32_32x32x16_bf16 v[48:63], v[88:91], a[160:163], v[48:63]
    ds_read_b128 v[84:87], v5 offset:25600
    v_mfma_f32_32x32x16_bf16 v[64:79], v[88:91], a[164:167], v[64:79]
    s_waitcnt lgkmcnt(4)
    v_mfma_f32_32x32x16_bf16 v[48:63], v[92:95], a[168:171], v[48:63]
    ds_read_b128 v[88:91], v5 offset:26624
    v_mfma_f32_32x32x16_bf16 v[64:79], v[92:95], a[172:175], v[64:79]
    s_waitcnt lgkmcnt(4)
    v_mfma_f32_32x32x16_bf16 v[48:63], v[96:99], a[176:179], v[48:63]
    ds_read_b128 v[92:95], v5 offset:27648
    v_mfma_f32_32x32x16_bf16 v[64:79], v[96:99], a[180:183], v[64:79]
    s_waitcnt lgkmcnt(4)
    v_mfma_f32_32x32x16_bf16 v[48:63], v[100:103], a[184:187], v[48:63]
    ds_read_b128 v[96:99], v5 offset:28672
    v_mfma_f32_32x32x16_bf16 v[64:79], v[100:103], a[188:191], v[64:79]
    s_waitcnt lgkmcnt(4)
    v_mfma_f32_32x32x16_bf16 v[48:63], v[80:83], a[192:195], v[48:63]
    ds_read_b128 v[100:103], v5 offset:29696
    v_mfma_f32_32x32x16_bf16 v[64:79], v[80:83], a[196:199], v[64:79]
    s_waitcnt lgkmcnt(4)
    v_mfma_f32_32x32x16_bf16 v[48:63], v[84:87], a[200:203], v[48:63]
    ds_read_b128 v[80:83], v5 offset:30720
    v_mfma_f32_32x32x16_bf16 v[64:79], v[84:87], a[204:207], v[64:79]
    s_waitcnt lgkmcnt(4)
    v_mfma_f32_32x32x16_bf16 v[48:63], v[88:91], a[208:211], v[48:63]
    ds_read_b128 v[84:87], v5 offset:31744
    v_mfma_f32_32x32x16_bf16 v[64:79], v[88:91], a[212:215], v[64:79]
    s_waitcnt lgkmcnt(4)
    v_mfma_f32_32x32x16_bf16 v[48:63], v[92:95], a[216:219], v[48:63]
    ds_read_b128 v[88:91], v5 offset:32768
    v_mfma_f32_32x32x16_bf16 v[64:79], v[92:95], a[220:223], v[64:79]
    s_waitcnt lgkmcnt(4)
    v_mfma_f32_32x32x16_bf16 v[48:63], v[96:99], a[224:227], v[48:63]
    ds_read_b128 v[92:95], v5 offset:33792
    v_mfma_f32_32x32x16_bf16 v[64:79], v[96:99], a[228:231], v[64:79]
    s_waitcnt lgkmcnt(4)
    v_mfma_f32_32x32x16_bf16 v[48:63], v[100:103], a[232:235], v[48:63]
    ds_read_b128 v[96:99], v5 offset:34816
    v_mfma_f32_32x32x16_bf16 v[64:79], v[100:103], a[236:239], v[64:79]
    s_waitcnt lgkmcnt(4)
    v_mfma_f32_32x32x16_bf16 v[48:63], v[80:83], a[240:243], v[48:63]
    ds_read_b128 v[100:103], v5 offset:35840
    v_mfma_f32_32x32x16_bf16 v[64:79], v[80:83], a[244:247], v[64:79]
    s_waitcnt lgkmcnt(4)
    v_mfma_f32_32x32x16_bf16 v[48:63], v[84:87], a[248:251], v[48:63]
    v_mfma_f32_32x32x16_bf16 v[64:79], v[84:87], a[252:255], v[64:79]
    s_waitcnt lgkmcnt(3)
    v_mfma_f32_32x32x16_bf16 v[48:63], v[88:91], v[252:255], v[48:63]
    v_mfma_f32_32x32x16_bf16 v[64:79], v[88:91], v[248:251], v[64:79]
    s_waitcnt lgkmcnt(2)
    v_mfma_f32_32x32x16_bf16 v[48:63], v[92:95], v[244:247], v[48:63]
    v_mfma_f32_32x32x16_bf16 v[64:79], v[92:95], v[240:243], v[64:79]
    s_waitcnt lgkmcnt(1)
    v_mfma_f32_32x32x16_bf16 v[48:63], v[96:99], v[236:239], v[48:63]
    v_mfma_f32_32x32x16_bf16 v[64:79], v[96:99], v[232:235], v[64:79]
    s_waitcnt lgkmcnt(0)
    v_mfma_f32_32x32x16_bf16 v[48:63], v[100:103], v[228:231], v[48:63]
    v_mfma_f32_32x32x16_bf16 v[64:79], v[100:103], v[224:227], v[64:79]
    s_mov_b32 s47, s34
    s_add_u32 s34, s34, s37
    s_add_u32 s40, s40, 36864
    s_cmp_ge_u32 s40, 147456
    s_cselect_b32 s40, 0, s40
    s_add_u32 s33, s33, 1
    s_add_u32 s32, s32, 3
    s_cmp_ge_u32 s32, 64
    s_cbranch_scc1 Lga_V1e
    s_branch Lga_V0
Lga_V0e:
    s_nop 15
    s_nop 3
    v_cvt_pk_bf16_f32 v112, v16, v17
    v_cvt_pk_bf16_f32 v113, v18, v19
    v_cvt_pk_bf16_f32 v114, v20, v21
    v_cvt_pk_bf16_f32 v115, v22, v23
    buffer_store_dwordx4 v[112:115], v2, s[8:11], s47 offen offset:0 sc0 sc1
    v_cvt_pk_bf16_f32 v116, v24, v25
    v_cvt_pk_bf16_f32 v117, v26, v27
    v_cvt_pk_bf16_f32 v118, v28, v29
    v_cvt_pk_bf16_f32 v119, v30, v31
    buffer_store_dwordx4 v[116:119], v2, s[8:11], s47 offen offset:1024 sc0 sc1
    v_cvt_pk_bf16_f32 v112, v32, v33
    v_cvt_pk_bf16_f32 v113, v34, v35
    v_cvt_pk_bf16_f32 v114, v36, v37
    v_cvt_pk_bf16_f32 v115, v38, v39
    buffer_store_dwordx4 v[112:115], v2, s[8:11], s47 offen offset:2048 sc0 sc1
    v_cvt_pk_bf16_f32 v116, v40, v41
    v_cvt_pk_bf16_f32 v117, v42, v43
    v_cvt_pk_bf16_f32 v118, v44, v45
    v_cvt_pk_bf16_f32 v119, v46, v47
    buffer_store_dwordx4 v[116:119], v2, s[8:11], s47 offen offset:3072 sc0 sc1
    s_branch Lga_end
Lga_V1e:
    s_nop 15
    s_nop 3
    v_cvt_pk_bf16_f32 v112, v48, v49
    v_cvt_pk_bf16_f32 v113, v50, v51
    v_cvt_pk_bf16_f32 v114, v52, v53
    v_cvt_pk_bf16_f32 v115, v54, v55
    buffer_store_dwordx4 v[112:115], v2, s[8:11], s47 offen offset:0 sc0 sc1
    v_cvt_pk_bf16_f32 v116, v56, v57
    v_cvt_pk_bf16_f32 v117, v58, v59
    v_cvt_pk_bf16_f32 v118, v60, v61
    v_cvt_pk_bf16_f32 v119, v62, v63
    buffer_store_dwordx4 v[116:119], v2, s[8:11], s47 offen offset:1024 sc0 sc1
    v_cvt_pk_bf16_f32 v112, v64, v65
    v_cvt_pk_bf16_f32 v113, v66, v67
    v_cvt_pk_bf16_f32 v114, v68, v69
    v_cvt_pk_bf16_f32 v115, v70, v71
    buffer_store_dwordx4 v[112:115], v2, s[8:11], s47 offen offset:2048 sc0 sc1
    v_cvt_pk_bf16_f32 v116, v72, v73
    v_cvt_pk_bf16_f32 v117, v74, v75
    v_cvt_pk_bf16_f32 v118, v76, v77
    v_cvt_pk_bf16_f32 v119, v78, v79
    buffer_store_dwordx4 v[116:119], v2, s[8:11], s47 offen offset:3072 sc0 sc1
    s_branch Lga_end
Lga_H:
    s_nop 15
    s_nop 3
Lga_H0:
    s_waitcnt vmcnt(9)
    s_barrier
    s_cmp_lt_u32 s33, 2
    s_cbranch_scc1 Lga_H0n
    s_cmp_lg_u32 s29, 0
    s_cbranch_scc1 Lga_H0n
    s_sub_u32 s35, s33, 1
    v_mov_b32 v6, 0
    v_mov_b32 v7, s35
    s_mov_b64 exec, 1
    buffer_store_dword v7, v6, s[8:11], s41 offen sc0 sc1
    s_mov_b64 exec, -1
Lga_H0n:
    v_add_u32 v5, s40, v0
    ds_read_b128 v[80:83], v5 offset:0
    ds_read_b128 v[84:87], v5 offset:1024
    ds_read_b128 v[88:91], v5 offset:2048
    ds_read_b128 v[92:95], v5 offset:3072
    ds_read_b128 v[96:99], v5 offset:4096
    s_add_u32 s45, s32, 6
    s_add_u32 s46, s40, 73728
    s_cmp_ge_u32 s46, 147456
    s_cselect_b32 s35, 147456, 0
    s_sub_u32 s46, s46, s35
    s_min_u32 s45, s45, 63
    s_waitcnt lgkmcnt(4)
    v_mfma_f32_32x32x16_bf16 v[16:31], a[0:3], v[80:83], 0
    ds_read_b128 v[100:103], v5 offset:5120
    v_cvt_pk_bf16_f32 v49, v48, v49
    v_lshlrev_b32 v48, 16, v49
    v_mfma_f32_32x32x16_bf16 v[32:47], a[4:7], v[80:83], 0
    v_and_b32 v49, 0xffff0000, v49
    v_cvt_pk_bf16_f32 v51, v50, v51
    v_lshlrev_b32 v50, 16, v51
    v_and_b32 v51, 0xffff0000, v51
    s_waitcnt lgkmcnt(4)
    v_mfma_f32_32x32x16_bf16 v[16:31], a[8:11], v[84:87], v[16:31]
    ds_read_b128 v[80:83], v5 offset:6144
    v_mul_f32 v104, 0xbfb8aa3b, v48
    v_mul_f32 v105, 0xbfb8aa3b, v49
    v_mul_f32 v106, 0xbfb8aa3b, v50
    v_mul_f32 v107, 0xbfb8aa3b, v51
    v_mfma_f32_32x32x16_bf16 v[32:47], a[12:15], v[84:87], v[32:47]
    v_exp_f32 v104, v104
    v_exp_f32 v105, v105
    v_exp_f32 v106, v106
    v_exp_f32 v107, v107
    s_waitcnt lgkmcnt(4)
    v_mfma_f32_32x32x16_bf16 v[16:31], a[16:19], v[88:91], v[16:31]
    ds_read_b128 v[84:87], v5 offset:7168
    v_add_f32 v104, 1.0, v104
    v_add_f32 v105, 1.0, v105
    v_add_f32 v106, 1.0, v106
    v_add_f32 v107, 1.0, v107
    v_mfma_f32_32x32x16_bf16 v[32:47], a[20:23], v[88:91], v[32:47]
    v_rcp_f32 v104, v104
    v_rcp_f32 v105, v105
    v_rcp_f32 v106, v106
    v_rcp_f32 v107, v107
    s_waitcnt lgkmcnt(4)
    v_mfma_f32_32x32x16_bf16 v[16:31], a[24:27], v[92:95], v[16:31]
    ds_read_b128 v[88:91], v5 offset:8192
    v_mul_f32 v48, v48, v104
    v_mul_f32 v49, v49, v105
    v_mul_f32 v50, v50, v106
    v_mul_f32 v51, v51, v107
    v_mfma_f32_32x32x16_bf16 v[32:47], a[28:31], v[92:95], v[32:47]
    v_cvt_pk_bf16_f32 v53, v52, v53
    v_lshlrev_b32 v52, 16, v53
    v_and_b32 v53, 0xffff0000, v53
    v_cvt_pk_bf16_f32 v55, v54, v55
    s_waitcnt lgkmcnt(4)
    v_mfma_f32_32x32x16_bf16 v[16:31], a[32:35], v[96:99], v[16:31]
    ds_read_b128 v[92:95], v5 offset:9216
    v_lshlrev_b32 v54, 16, v55
    v_and_b32 v55, 0xffff0000, v55
    v_mul_f32 v104, 0xbfb8aa3b, v52
    v_mul_f32 v105, 0xbfb8aa3b, v53
    v_mfma_f32_32x32x16_bf16 v[32:47], a[36:39], v[96:99], v[32:47]
    v_mul_f32 v106, 0xbfb8aa3b, v54
    v_mul_f32 v107, 0xbfb8aa3b, v55
    v_exp_f32 v104, v104
    v_exp_f32 v105, v105
    s_waitcnt lgkmcnt(4)
    v_mfma_f32_32x32x16_bf16 v[16:31], a[40:43], v[100:103], v[16:31]
    ds_read_b128 v[96:99], v5 offset:10240
    v_exp_f32 v106, v106
    v_exp_f32 v107, v107
    v_add_f32 v104, 1.0, v104
    v_add_f32 v105, 1.0, v105
    v_mfma_f32_32x32x16_bf16 v[32:47], a[44:47], v[100:103], v[32:47]
    v_add_f32 v106, 1.0, v106
    v_add_f32 v107, 1.0, v107
    v_rcp_f32 v104, v104
    v_rcp_f32 v105, v105
    s_waitcnt lgkmcnt(4)
    v_mfma_f32_32x32x16_bf16 v[16:31], a[48:51], v[80:83], v[16:31]
    ds_read_b128 v[100:103], v5 offset:11264
    v_rcp_f32 v106, v106
    v_rcp_f32 v107, v107
    v_mul_f32 v52, v52, v104
    v_mul_f32 v53, v53, v105
    v_mfma_f32_32x32x16_bf16 v[32:47], a[52:55], v[80:83], v[32:47]
    v_mul_f32 v54, v54, v106
    v_mul_f32 v55, v55, v107
    v_cvt_pk_bf16_f32 v57, v56, v57
    v_lshlrev_b32 v56, 16, v57
    s_waitcnt lgkmcnt(4)
    v_mfma_f32_32x32x16_bf16 v[16:31], a[56:59], v[84:87], v[16:31]
    ds_read_b128 v[80:83], v5 offset:12288
    v_and_b32 v57, 0xffff0000, v57
    v_cvt_pk_bf16_f32 v59, v58, v59
    v_lshlrev_b32 v58, 16, v59
    v_and_b32 v59, 0xffff0000, v59
    v_mfma_f32_32x32x16_bf16 v[32:47], a[60:63], v[84:87], v[32:47]
    v_mul_f32 v104, 0xbfb8aa3b, v56
    v_mul_f32 v105, 0xbfb8aa3b, v57
    v_mul_f32 v106, 0xbfb8aa3b, v58
    v_mul_f32 v107, 0xbfb8aa3b, v59
    s_waitcnt lgkmcnt(4)
    v_mfma_f32_32x32x16_bf16 v[16:31], a[64:67], v[88:91], v[16:31]
    ds_read_b128 v[84:87], v5 offset:13312
    v_exp_f32 v104, v104
    v_exp_f32 v105, v105
    v_exp_f32 v106, v106
    v_exp_f32 v107, v107
    v_mfma_f32_32x32x16_bf16 v[32:47], a[68:71], v[88:91], v[32:47]
    v_add_f32 v104, 1.0, v104
    v_add_f32 v105, 1.0, v105
    v_add_f32 v106, 1.0, v106
    v_add_f32 v107, 1.0, v107
    s_waitcnt lgkmcnt(4)
    v_mfma_f32_32x32x16_bf16 v[16:31], a[72:75], v[92:95], v[16:31]
    ds_read_b128 v[88:91], v5 offset:14336
    v_rcp_f32 v104, v104
    v_rcp_f32 v105, v105
    v_rcp_f32 v106, v106
    v_rcp_f32 v107, v107
    v_mfma_f32_32x32x16_bf16 v[32:47], a[76:79], v[92:95], v[32:47]
    v_mul_f32 v56, v56, v104
    v_mul_f32 v57, v57, v105
    v_mul_f32 v58, v58, v106
    v_mul_f32 v59, v59, v107
    s_waitcnt lgkmcnt(4)
    v_mfma_f32_32x32x16_bf16 v[16:31], a[80:83], v[96:99], v[16:31]
    ds_read_b128 v[92:95], v5 offset:15360
    v_cvt_pk_bf16_f32 v61, v60, v61
    v_lshlrev_b32 v60, 16, v61
    v_and_b32 v61, 0xffff0000, v61
    v_cvt_pk_bf16_f32 v63, v62, v63
    v_mfma_f32_32x32x16_bf16 v[32:47], a[84:87], v[96:99], v[32:47]
    v_lshlrev_b32 v62, 16, v63
    v_and_b32 v63, 0xffff0000, v63
    v_mul_f32 v104, 0xbfb8aa3b, v60
    v_mul_f32 v105, 0xbfb8aa3b, v61
    s_waitcnt lgkmcnt(4)
    v_mfma_f32_32x32x16_bf16 v[16:31], a[88:91], v[100:103], v[16:31]
    ds_read_b128 v[96:99], v5 offset:16384
    v_mul_f32 v106, 0xbfb8aa3b, v62
    v_mul_f32 v107, 0xbfb8aa3b, v63
    v_exp_f32 v104, v104
    v_exp_f32 v105, v105
    v_mfma_f32_32x32x16_bf16 v[32:47], a[92:95], v[100:103], v[32:47]
    v_exp_f32 v106, v106
    v_exp_f32 v107, v107
    v_add_f32 v104, 1.0, v104
    v_add_f32 v105, 1.0, v105
    s_waitcnt lgkmcnt(4)
    v_mfma_f32_32x32x16_bf16 v[16:31], a[96:99], v[80:83], v[16:31]
    ds_read_b128 v[100:103], v5 offset:17408
    v_add_f32 v106, 1.0, v106
    v_add_f32 v107, 1.0, v107
    v_rcp_f32 v104, v104
    v_rcp_f32 v105, v105
    v_mfma_f32_32x32x16_bf16 v[32:47], a[100:103], v[80:83], v[32:47]
    v_rcp_f32 v106, v106
    v_rcp_f32 v107, v107
    v_mul_f32 v60, v60, v104
    v_mul_f32 v61, v61, v105
    s_waitcnt lgkmcnt(4)
    v_mfma_f32_32x32x16_bf16 v[16:31], a[104:107], v[84:87], v[16:31]
    ds_read_b128 v[80:83], v5 offset:18432
    v_mul_f32 v62, v62, v106
    v_mul_f32 v63, v63, v107
    v_cvt_pk_bf16_f32 v112, v48, v49
    v_cvt_pk_bf16_f32 v113, v50, v51
    v_mfma_f32_32x32x16_bf16 v[32:47], a[108:111], v[84:87], v[32:47]
    v_cvt_pk_bf16_f32 v114, v52, v53
    v_cvt_pk_bf16_f32 v115, v54, v55
    buffer_store_dwordx4 v[112:115], v2, s[8:11], s47 offen offset:0 sc0 sc1
    s_waitcnt lgkmcnt(4)
    v_cvt_pk_bf16_f32 v116, v56, v57
    v_mfma_f32_32x32x16_bf16 v[16:31], a[112:115], v[88:91], v[16:31]
    ds_read_b128 v[84:87], v5 offset:19456
    v_cvt_pk_bf16_f32 v117, v58, v59
    v_cvt_pk_bf16_f32 v118, v60, v61
    v_cvt_pk_bf16_f32 v119, v62, v63
    buffer_store_dwordx4 v[116:119], v2, s[8:11], s47 offen offset:1024 sc0 sc1
    v_mfma_f32_32x32x16_bf16 v[32:47], a[116:119], v[88:91], v[32:47]
    v_cvt_pk_bf16_f32 v65, v64, v65
    v_lshlrev_b32 v64, 16, v65
    v_and_b32 v65, 0xffff0000, v65
    v_cvt_pk_bf16_f32 v67, v66, v67
    s_waitcnt lgkmcnt(4)
    v_mfma_f32_32x32x16_bf16 v[16:31], a[120:123], v[92:95], v[16:31]
    ds_read_b128 v[88:91], v5 offset:20480
    v_lshlrev_b32 v66, 16, v67
    v_and_b32 v67, 0xffff0000, v67
    v_mul_f32 v104, 0xbfb8aa3b, v64
    v_mul_f32 v105, 0xbfb8aa3b, v65
    v_mfma_f32_32x32x16_bf16 v[32:47], a[124:127], v[92:95], v[32:47]
    v_mul_f32 v106, 0xbfb8aa3b, v66
    v_mul_f32 v107, 0xbfb8aa3b, v67
    v_exp_f32 v104, v104
    v_exp_f32 v105, v105
    s_waitcnt lgkmcnt(4)
    v_mfma_f32_32x32x16_bf16 v[16:31], a[128:131], v[96:99], v[16:31]
    ds_read_b128 v[92:95], v5 offset:21504
    v_exp_f32 v106, v106
    v_exp_f32 v107, v107
    v_add_f32 v104, 1.0, v104
    v_add_f32 v105, 1.0, v105
    v_mfma_f32_32x32x16_bf16 v[32:47], a[132:135], v[96:99], v[32:47]
    v_add_f32 v106, 1.0, v106
    v_add_f32 v107, 1.0, v107
    v_rcp_f32 v104, v104
    v_rcp_f32 v105, v105
    s_waitcnt lgkmcnt(4)
    v_mfma_f32_32x32x16_bf16 v[16:31], a[136:139], v[100:103], v[16:31]
    ds_read_b128 v[96:99], v5 offset:22528
    v_rcp_f32 v106, v106
    v_rcp_f32 v107, v107
    v_mul_f32 v64, v64, v104
    v_mul_f32 v65, v65, v105
    v_mfma_f32_32x32x16_bf16 v[32:47], a[140:143], v[100:103], v[32:47]
    v_mul_f32 v66, v66, v106
    v_mul_f32 v67, v67, v107
    v_cvt_pk_bf16_f32 v69, v68, v69
    v_lshlrev_b32 v68, 16, v69
    s_waitcnt lgkmcnt(4)
    v_mfma_f32_32x32x16_bf16 v[16:31], a[144:147], v[80:83], v[16:31]
    ds_read_b128 v[100:103], v5 offset:23552
    v_and_b32 v69, 0xffff0000, v69
    v_cvt_pk_bf16_f32 v71, v70, v71
    v_lshlrev_b32 v70, 16, v71
    v_and_b32 v71, 0xffff0000, v71
    v_mfma_f32_32x32x16_bf16 v[32:47], a[148:151], v[80:83], v[32:47]
    v_mul_f32 v104, 0xbfb8aa3b, v68
    v_mul_f32 v105, 0xbfb8aa3b, v69
    v_mul_f32 v106, 0xbfb8aa3b, v70
    v_mul_f32 v107, 0xbfb8aa3b, v71
    s_waitcnt lgkmcnt(4)
    v_mfma_f32_32x32x16_bf16 v[16:31], a[152:155], v[84:87], v[16:31]
    ds_read_b128 v[80:83], v5 offset:24576
    v_exp_f32 v104, v104
    v_exp_f32 v105, v105
    v_exp_f32 v106, v106
    v_exp_f32 v107, v107
    v_mfma_f32_32x32x16_bf16 v[32:47], a[156:159], v[84:87], v[32:47]
    v_add_f32 v104, 1.0, v104
    v_add_f32 v105, 1.0, v105
    v_add_f32 v106, 1.0, v106
    v_add_f32 v107, 1.0, v107
    s_waitcnt lgkmcnt(4)
    v_mfma_f32_32x32x16_bf16 v[16:31], a[160:163], v[88:91], v[16:31]
    ds_read_b128 v[84:87], v5 offset:25600
    v_rcp_f32 v104, v104
    v_rcp_f32 v105, v105
    v_rcp_f32 v106, v106
    v_rcp_f32 v107, v107
    v_mfma_f32_32x32x16_bf16 v[32:47], a[164:167], v[88:91], v[32:47]
    v_mul_f32 v68, v68, v104
    v_mul_f32 v69, v69, v105
    v_mul_f32 v70, v70, v106
    v_mul_f32 v71, v71, v107
    s_waitcnt lgkmcnt(4)
    v_mfma_f32_32x32x16_bf16 v[16:31], a[168:171], v[92:95], v[16:31]
    ds_read_b128 v[88:91], v5 offset:26624
    v_cvt_pk_bf16_f32 v73, v72, v73
    v_lshlrev_b32 v72, 16, v73
    v_and_b32 v73, 0xffff0000, v73
    v_cvt_pk_bf16_f32 v75, v74, v75
    v_mfma_f32_32x32x16_bf16 v[32:47], a[172:175], v[92:95], v[32:47]
    v_lshlrev_b32 v74, 16, v75
    v_and_b32 v75, 0xffff0000, v75
    v_mul_f32 v104, 0xbfb8aa3b, v72
    v_mul_f32 v105, 0xbfb8aa3b, v73
    s_waitcnt lgkmcnt(4)
    v_mfma_f32_32x32x16_bf16 v[16:31], a[176:179], v[96:99], v[16:31]
    ds_read_b128 v[92:95], v5 offset:27648
    v_mul_f32 v106, 0xbfb8aa3b, v74
    v_mul_f32 v107, 0xbfb8aa3b, v75
    v_exp_f32 v104, v104
    v_exp_f32 v105, v105
    v_mfma_f32_32x32x16_bf16 v[32:47], a[180:183], v[96:99], v[32:47]
    v_exp_f32 v106, v106
    v_exp_f32 v107, v107
    v_add_f32 v104, 1.0, v104
    v_add_f32 v105, 1.0, v105
    s_waitcnt lgkmcnt(4)
    v_mfma_f32_32x32x16_bf16 v[16:31], a[184:187], v[100:103], v[16:31]
    ds_read_b128 v[96:99], v5 offset:28672
    v_add_f32 v106, 1.0, v106
    v_add_f32 v107, 1.0, v107
    v_rcp_f32 v104, v104
    v_rcp_f32 v105, v105
    v_mfma_f32_32x32x16_bf16 v[32:47], a[188:191], v[100:103], v[32:47]
    v_rcp_f32 v106, v106
    v_rcp_f32 v107, v107
    v_mul_f32 v72, v72, v104
    v_mul_f32 v73, v73, v105
    s_waitcnt lgkmcnt(4)
    v_mfma_f32_32x32x16_bf16 v[16:31], a[192:195], v[80:83], v[16:31]
    ds_read_b128 v[100:103], v5 offset:29696
    v_mul_f32 v74, v74, v106
    v_mul_f32 v75, v75, v107
    v_cvt_pk_bf16_f32 v77, v76, v77
    v_lshlrev_b32 v76, 16, v77
    v_mfma_f32_32x32x16_bf16 v[32:47], a[196:199], v[80:83], v[32:47]
    v_and_b32 v77, 0xffff0000, v77
    v_cvt_pk_bf16_f32 v79, v78, v79
    v_lshlrev_b32 v78, 16, v79
    v_and_b32 v79, 0xffff0000, v79
    s_waitcnt lgkmcnt(4)
    v_mfma_f32_32x32x16_bf16 v[16:31], a[200:203], v[84:87], v[16:31]
    ds_read_b128 v[80:83], v5 offset:30720
    v_mul_f32 v104, 0xbfb8aa3b, v76
    v_mul_f32 v105, 0xbfb8aa3b, v77
    v_mul_f32 v106, 0xbfb8aa3b, v78
    v_mul_f32 v107, 0xbfb8aa3b, v79
    v_mfma_f32_32x32x16_bf16 v[32:47], a[204:207], v[84:87], v[32:47]
    v_exp_f32 v104, v104
    v_exp_f32 v105, v105
    v_exp_f32 v106, v106
    v_exp_f32 v107, v107
    s_waitcnt lgkmcnt(4)
    v_mfma_f32_32x32x16_bf16 v[16:31], a[208:211], v[88:91], v[16:31]
    ds_read_b128 v[84:87], v5 offset:31744
    v_add_f32 v104, 1.0, v104
    v_add_f32 v105, 1.0, v105
    v_add_f32 v106, 1.0, v106
    v_add_f32 v107, 1.0, v107
    v_mfma_f32_32x32x16_bf16 v[32:47], a[212:215], v[88:91], v[32:47]
    v_rcp_f32 v104, v104
    v_rcp_f32 v105, v105
    v_rcp_f32 v106, v106
    v_rcp_f32 v107, v107
    s_waitcnt lgkmcnt(4)
    v_mfma_f32_32x32x16_bf16 v[16:31], a[216:219], v[92:95], v[16:31]
    ds_read_b128 v[88:91], v5 offset:32768
    v_mul_f32 v76, v76, v104
    v_mul_f32 v77, v77, v105
    v_mul_f32 v78, v78, v106
    v_mul_f32 v79, v79, v107
    v_mfma_f32_32x32x16_bf16 v[32:47], a[220:223], v[92:95], v[32:47]
    v_cvt_pk_bf16_f32 v112, v64, v65
    v_cvt_pk_bf16_f32 v113, v66, v67
    v_cvt_pk_bf16_f32 v114, v68, v69
    v_cvt_pk_bf16_f32 v115, v70, v71
    s_waitcnt lgkmcnt(4)
    v_mfma_f32_32x32x16_bf16 v[16:31], a[224:227], v[96:99], v[16:31]
    ds_read_b128 v[92:95], v5 offset:33792
    buffer_store_dwordx4 v[112:115], v2, s[8:11], s47 offen offset:2048 sc0 sc1
    v_cvt_pk_bf16_f32 v116, v72, v73
    v_cvt_pk_bf16_f32 v117, v74, v75
    v_cvt_pk_bf16_f32 v118, v76, v77
    v_mfma_f32_32x32x16_bf16 v[32:47], a[228:231], v[96:99], v[32:47]
    v_cvt_pk_bf16_f32 v119, v78, v79
    buffer_store_dwordx4 v[116:119], v2, s[8:11], s47 offen offset:3072 sc0 sc1
    s_mul_i32 s35, s45, 36864
    s_add_u32 s35, s35, s42
    s_add_u32 s36, s46, s42
    s_mov_b32 m0, s36
    s_nop 0
    buffer_load_dwordx4 v0, s[8:11], s35 offen offset:0 sc1 lds
    buffer_load_dwordx4 v0, s[8:11], s35 offen offset:1024 sc1 lds
    s_waitcnt lgkmcnt(4)
    v_mfma_f32_32x32x16_bf16 v[16:31], a[232:235], v[100:103], v[16:31]
    ds_read_b128 v[96:99], v5 offset:34816
    buffer_load_dwordx4 v0, s[8:11], s35 offen offset:2048 sc1 lds
    buffer_load_dwordx4 v0, s[8:11], s35 offen offset:3072 sc1 lds
    s_add_u32 s35, s35, 4096
    s_add_u32 s36, s36, 4096
    s_mov_b32 m0, s36
    s_nop 0
    buffer_load_dwordx4 v0, s[8:11], s35 offen offset:0 sc1 lds
    buffer_load_dwordx4 v0, s[8:11], s35 offen offset:1024 sc1 lds
    v_mfma_f32_32x32x16_bf16 v[32:47], a[236:239], v[100:103], v[32:47]
    buffer_load_dwordx4 v0, s[8:11], s35 offen offset:2048 sc1 lds
    buffer_load_dwordx4 v0, s[8:11], s35 offen offset:3072 sc1 lds
    s_add_u32 s35, s35, 4096
    s_add_u32 s36, s36, 4096
    s_mov_b32 m0, s36
    s_nop 0
    buffer_load_dwordx4 v0, s[8:11], s35 offen offset:0 sc1 lds
    s_waitcnt lgkmcnt(4)
    v_mfma_f32_32x32x16_bf16 v[16:31], a[240:243], v[80:83], v[16:31]
    ds_read_b128 v[100:103], v5 offset:35840
    v_mfma_f32_32x32x16_bf16 v[32:47], a[244:247], v[80:83], v[32:47]
    s_waitcnt lgkmcnt(4)
    v_mfma_f32_32x32x16_bf16 v[16:31], a[248:251], v[84:87], v[16:31]
    v_mfma_f32_32x32x16_bf16 v[32:47], a[252:255], v[84:87], v[32:47]
    s_waitcnt lgkmcnt(3)
    v_mfma_f32_32x32x16_bf16 v[16:31], v[252:255], v[88:91], v[16:31]
    v_mfma_f32_32x32x16_bf16 v[32:47], v[248:251], v[88:91], v[32:47]
    s_waitcnt lgkmcnt(2)
    v_mfma_f32_32x32x16_bf16 v[16:31], v[244:247], v[92:95], v[16:31]
    v_mfma_f32_32x32x16_bf16 v[32:47], v[240:243], v[92:95], v[32:47]
    s_waitcnt lgkmcnt(1)
    v_mfma_f32_32x32x16_bf16 v[16:31], v[236:239], v[96:99], v[16:31]
    v_mfma_f32_32x32x16_bf16 v[32:47], v[232:235], v[96:99], v[32:47]
    s_waitcnt lgkmcnt(0)
    v_mfma_f32_32x32x16_bf16 v[16:31], v[228:231], v[100:103], v[16:31]
    v_mfma_f32_32x32x16_bf16 v[32:47], v[224:227], v[100:103], v[32:47]
    s_mov_b32 s47, s34
    s_add_u32 s34, s34, s37
    s_add_u32 s40, s40, 36864
    s_cmp_ge_u32 s40, 147456
    s_cselect_b32 s40, 0, s40
    s_add_u32 s33, s33, 1
    s_add_u32 s32, s32, 3
    s_cmp_ge_u32 s32, 64
    s_cbranch_scc1 Lga_H0e
Lga_H1:
    s_waitcnt vmcnt(9)
    s_barrier
    s_cmp_lt_u32 s33, 2
    s_cbranch_scc1 Lga_H1n
    s_cmp_lg_u32 s29, 0
    s_cbranch_scc1 Lga_H1n
    s_sub_u32 s35, s33, 1
    v_mov_b32 v6, 0
    v_mov_b32 v7, s35
    s_mov_b64 exec, 1
    buffer_store_dword v7, v6, s[8:11], s41 offen sc0 sc1
    s_mov_b64 exec, -1
Lga_H1n:
    v_add_u32 v5, s40, v0
    ds_read_b128 v[80:83], v5 offset:0
    ds_read_b128 v[84:87], v5 offset:1024
    ds_read_b128 v[88:91], v5 offset:2048
    ds_read_b128 v[92:95], v5 offset:3072
    ds_read_b128 v[96:99], v5 offset:4096
    s_add_u32 s45, s32, 6
    s_add_u32 s46, s40, 73728
    s_cmp_ge_u32 s46, 147456
    s_cselect_b32 s35, 147456, 0
    s_sub_u32 s46, s46, s35
    s_min_u32 s45, s45, 63
    s_waitcnt lgkmcnt(4)
    v_mfma_f32_32x32x16_bf16 v[48:63], a[0:3], v[80:83], 0
    ds_read_b128 v[100:103], v5 offset:5120
    v_cvt_pk_bf16_f32 v17, v16, v17
    v_lshlrev_b32 v16, 16, v17
    v_mfma_f32_32x32x16_bf16 v[64:79], a[4:7], v[80:83], 0
    v_and_b32 v17, 0xffff0000, v17
    v_cvt_pk_bf16_f32 v19, v18, v19
    v_lshlrev_b32 v18, 16, v19
    v_and_b32 v19, 0xffff0000, v19
    s_waitcnt lgkmcnt(4)
    v_mfma_f32_32x32x16_bf16 v[48:63], a[8:11], v[84:87], v[48:63]
    ds_read_b128 v[80:83], v5 offset:6144
    v_mul_f32 v104, 0xbfb8aa3b, v16
    v_mul_f32 v105, 0xbfb8aa3b, v17
    v_mul_f32 v106, 0xbfb8aa3b, v18
    v_mul_f32 v107, 0xbfb8aa3b, v19
    v_mfma_f32_32x32x16_bf16 v[64:79], a[12:15], v[84:87], v[64:79]
    v_exp_f32 v104, v104
    v_exp_f32 v105, v105
    v_exp_f32 v106, v106
    v_exp_f32 v107, v107
    s_waitcnt lgkmcnt(4)
    v_mfma_f32_32x32x16_bf16 v[48:63], a[16:19], v[88:91], v[48:63]
    ds_read_b128 v[84:87], v5 offset:7168
    v_add_f32 v104, 1.0, v104
    v_add_f32 v105, 1.0, v105
    v_add_f32 v106, 1.0, v106
    v_add_f32 v107, 1.0, v107
    v_mfma_f32_32x32x16_bf16 v[64:79], a[20:23], v[88:91], v[64:79]
    v_rcp_f32 v104, v104
    v_rcp_f32 v105, v105
    v_rcp_f32 v106, v106
    v_rcp_f32 v107, v107
    s_waitcnt lgkmcnt(4)
    v_mfma_f32_32x32x16_bf16 v[48:63], a[24:27], v[92:95], v[48:63]
    ds_read_b128 v[88:91], v5 offset:8192
    v_mul_f32 v16, v16, v104
    v_mul_f32 v17, v17, v105
    v_mul_f32 v18, v18, v106
    v_mul_f32 v19, v19, v107
    v_mfma_f32_32x32x16_bf16 v[64:79], a[28:31], v[92:95], v[64:79]
    v_cvt_pk_bf16_f32 v21, v20, v21
    v_lshlrev_b32 v20, 16, v21
    v_and_b32 v21, 0xffff0000, v21
    v_cvt_pk_bf16_f32 v23, v22, v23
    s_waitcnt lgkmcnt(4)
    v_mfma_f32_32x32x16_bf16 v[48:63], a[32:35], v[96:99], v[48:63]
    ds_read_b128 v[92:95], v5 offset:9216
    v_lshlrev_b32 v22, 16, v23
    v_and_b32 v23, 0xffff0000, v23
    v_mul_f32 v104, 0xbfb8aa3b, v20
    v_mul_f32 v105, 0xbfb8aa3b, v21
    v_mfma_f32_32x32x16_bf16 v[64:79], a[36:39], v[96:99], v[64:79]
    v_mul_f32 v106, 0xbfb8aa3b, v22
    v_mul_f32 v107, 0xbfb8aa3b, v23
    v_exp_f32 v104, v104
    v_exp_f32 v105, v105
    s_waitcnt lgkmcnt(4)
    v_mfma_f32_32x32x16_bf16 v[48:63], a[40:43], v[100:103], v[48:63]
    ds_read_b128 v[96:99], v5 offset:10240
    v_exp_f32 v106, v106
    v_exp_f32 v107, v107
    v_add_f32 v104, 1.0, v104
    v_add_f32 v105, 1.0, v105
    v_mfma_f32_32x32x16_bf16 v[64:79], a[44:47], v[100:103], v[64:79]
    v_add_f32 v106, 1.0, v106
    v_add_f32 v107, 1.0, v107
    v_rcp_f32 v104, v104
    v_rcp_f32 v105, v105
    s_waitcnt lgkmcnt(4)
    v_mfma_f32_32x32x16_bf16 v[48:63], a[48:51], v[80:83], v[48:63]
    ds_read_b128 v[100:103], v5 offset:11264
    v_rcp_f32 v106, v106
    v_rcp_f32 v107, v107
    v_mul_f32 v20, v20, v104
    v_mul_f32 v21, v21, v105
    v_mfma_f32_32x32x16_bf16 v[64:79], a[52:55], v[80:83], v[64:79]
    v_mul_f32 v22, v22, v106
    v_mul_f32 v23, v23, v107
    v_cvt_pk_bf16_f32 v25, v24, v25
    v_lshlrev_b32 v24, 16, v25
    s_waitcnt lgkmcnt(4)
    v_mfma_f32_32x32x16_bf16 v[48:63], a[56:59], v[84:87], v[48:63]
    ds_read_b128 v[80:83], v5 offset:12288
    v_and_b32 v25, 0xffff0000, v25
    v_cvt_pk_bf16_f32 v27, v26, v27
    v_lshlrev_b32 v26, 16, v27
    v_and_b32 v27, 0xffff0000, v27
    v_mfma_f32_32x32x16_bf16 v[64:79], a[60:63], v[84:87], v[64:79]
    v_mul_f32 v104, 0xbfb8aa3b, v24
    v_mul_f32 v105, 0xbfb8aa3b, v25
    v_mul_f32 v106, 0xbfb8aa3b, v26
    v_mul_f32 v107, 0xbfb8aa3b, v27
    s_waitcnt lgkmcnt(4)
    v_mfma_f32_32x32x16_bf16 v[48:63], a[64:67], v[88:91], v[48:63]
    ds_read_b128 v[84:87], v5 offset:13312
    v_exp_f32 v104, v104
    v_exp_f32 v105, v105
    v_exp_f32 v106, v106
    v_exp_f32 v107, v107
    v_mfma_f32_32x32x16_bf16 v[64:79], a[68:71], v[88:91], v[64:79]
    v_add_f32 v104, 1.0, v104
    v_add_f32 v105, 1.0, v105
    v_add_f32 v106, 1.0, v106
    v_add_f32 v107, 1.0, v107
    s_waitcnt lgkmcnt(4)
    v_mfma_f32_32x32x16_bf16 v[48:63], a[72:75], v[92:95], v[48:63]
    ds_read_b128 v[88:91], v5 offset:14336
    v_rcp_f32 v104, v104
    v_rcp_f32 v105, v105
    v_rcp_f32 v106, v106
    v_rcp_f32 v107, v107
    v_mfma_f32_32x32x16_bf16 v[64:79], a[76:79], v[92:95], v[64:79]
    v_mul_f32 v24, v24, v104
    v_mul_f32 v25, v25, v105
    v_mul_f32 v26, v26, v106
    v_mul_f32 v27, v27, v107
    s_waitcnt lgkmcnt(4)
    v_mfma_f32_32x32x16_bf16 v[48:63], a[80:83], v[96:99], v[48:63]
    ds_read_b128 v[92:95], v5 offset:15360
    v_cvt_pk_bf16_f32 v29, v28, v29
    v_lshlrev_b32 v28, 16, v29
    v_and_b32 v29, 0xffff0000, v29
    v_cvt_pk_bf16_f32 v31, v30, v31
    v_mfma_f32_32x32x16_bf16 v[64:79], a[84:87], v[96:99], v[64:79]
    v_lshlrev_b32 v30, 16, v31
    v_and_b32 v31, 0xffff0000, v31
    v_mul_f32 v104, 0xbfb8aa3b, v28
    v_mul_f32 v105, 0xbfb8aa3b, v29
    s_waitcnt lgkmcnt(4)
    v_mfma_f32_32x32x16_bf16 v[48:63], a[88:91], v[100:103], v[48:63]
    ds_read_b128 v[96:99], v5 offset:16384
    v_mul_f32 v106, 0xbfb8aa3b, v30
    v_mul_f32 v107, 0xbfb8aa3b, v31
    v_exp_f32 v104, v104
    v_exp_f32 v105, v105
    v_mfma_f32_32x32x16_bf16 v[64:79], a[92:95], v[100:103], v[64:79]
    v_exp_f32 v106, v106
    v_exp_f32 v107, v107
    v_add_f32 v104, 1.0, v104
    v_add_f32 v105, 1.0, v105
    s_waitcnt lgkmcnt(4)
    v_mfma_f32_32x32x16_bf16 v[48:63], a[96:99], v[80:83], v[48:63]
    ds_read_b128 v[100:103], v5 offset:17408
    v_add_f32 v106, 1.0, v106
    v_add_f32 v107, 1.0, v107
    v_rcp_f32 v104, v104
    v_rcp_f32 v105, v105
    v_mfma_f32_32x32x16_bf16 v[64:79], a[100:103], v[80:83], v[64:79]
    v_rcp_f32 v106, v106
    v_rcp_f32 v107, v107
    v_mul_f32 v28, v28, v104
    v_mul_f32 v29, v29, v105
    s_waitcnt lgkmcnt(4)
    v_mfma_f32_32x32x16_bf16 v[48:63], a[104:107], v[84:87], v[48:63]
    ds_read_b128 v[80:83], v5 offset:18432
    v_mul_f32 v30, v30, v106
    v_mul_f32 v31, v31, v107
    v_cvt_pk_bf16_f32 v112, v16, v17
    v_cvt_pk_bf16_f32 v113, v18, v19
    v_mfma_f32_32x32x16_bf16 v[64:79], a[108:111], v[84:87], v[64:79]
    v_cvt_pk_bf16_f32 v114, v20, v21
    v_cvt_pk_bf16_f32 v115, v22, v23
    buffer_store_dwordx4 v[112:115], v2, s[8:11], s47 offen offset:0 sc0 sc1
    s_waitcnt lgkmcnt(4)
    v_cvt_pk_bf16_f32 v116, v24, v25
    v_mfma_f32_32x32x16_bf16 v[48:63], a[112:115], v[88:91], v[48:63]
    ds_read_b128 v[84:87], v5 offset:19456
    v_cvt_pk_bf16_f32 v117, v26, v27
    v_cvt_pk_bf16_f32 v118, v28, v29
    v_cvt_pk_bf16_f32 v119, v30, v31
    buffer_store_dwordx4 v[116:119], v2, s[8:11], s47 offen offset:1024 sc0 sc1
    v_mfma_f32_32x32x16_bf16 v[64:79], a[116:119], v[88:91], v[64:79]
    v_cvt_pk_bf16_f32 v33, v32, v33
    v_lshlrev_b32 v32, 16, v33
    v_and_b32 v33, 0xffff0000, v33
    v_cvt_pk_bf16_f32 v35, v34, v35
    s_waitcnt lgkmcnt(4)
    v_mfma_f32_32x32x16_bf16 v[48:63], a[120:123], v[92:95], v[48:63]
    ds_read_b128 v[88:91], v5 offset:20480
    v_lshlrev_b32 v34, 16, v35
    v_and_b32 v35, 0xffff0000, v35
    v_mul_f32 v104, 0xbfb8aa3b, v32
    v_mul_f32 v105, 0xbfb8aa3b, v33
    v_mfma_f32_32x32x16_bf16 v[64:79], a[124:127], v[92:95], v[64:79]
    v_mul_f32 v106, 0xbfb8aa3b, v34
    v_mul_f32 v107, 0xbfb8aa3b, v35
    v_exp_f32 v104, v104
    v_exp_f32 v105, v105
    s_waitcnt lgkmcnt(4)
    v_mfma_f32_32x32x16_bf16 v[48:63], a[128:131], v[96:99], v[48:63]
    ds_read_b128 v[92:95], v5 offset:21504
    v_exp_f32 v106, v106
    v_exp_f32 v107, v107
    v_add_f32 v104, 1.0, v104
    v_add_f32 v105, 1.0, v105
    v_mfma_f32_32x32x16_bf16 v[64:79], a[132:135], v[96:99], v[64:79]
    v_add_f32 v106, 1.0, v106
    v_add_f32 v107, 1.0, v107
    v_rcp_f32 v104, v104
    v_rcp_f32 v105, v105
    s_waitcnt lgkmcnt(4)
    v_mfma_f32_32x32x16_bf16 v[48:63], a[136:139], v[100:103], v[48:63]
    ds_read_b128 v[96:99], v5 offset:22528
    v_rcp_f32 v106, v106
    v_rcp_f32 v107, v107
    v_mul_f32 v32, v32, v104
    v_mul_f32 v33, v33, v105
    v_mfma_f32_32x32x16_bf16 v[64:79], a[140:143], v[100:103], v[64:79]
    v_mul_f32 v34, v34, v106
    v_mul_f32 v35, v35, v107
    v_cvt_pk_bf16_f32 v37, v36, v37
    v_lshlrev_b32 v36, 16, v37
    s_waitcnt lgkmcnt(4)
    v_mfma_f32_32x32x16_bf16 v[48:63], a[144:147], v[80:83], v[48:63]
    ds_read_b128 v[100:103], v5 offset:23552
    v_and_b32 v37, 0xffff0000, v37
    v_cvt_pk_bf16_f32 v39, v38, v39
    v_lshlrev_b32 v38, 16, v39
    v_and_b32 v39, 0xffff0000, v39
    v_mfma_f32_32x32x16_bf16 v[64:79], a[148:151], v[80:83], v[64:79]
    v_mul_f32 v104, 0xbfb8aa3b, v36
    v_mul_f32 v105, 0xbfb8aa3b, v37
    v_mul_f32 v106, 0xbfb8aa3b, v38
    v_mul_f32 v107, 0xbfb8aa3b, v39
    s_waitcnt lgkmcnt(4)
    v_mfma_f32_32x32x16_bf16 v[48:63], a[152:155], v[84:87], v[48:63]
    ds_read_b128 v[80:83], v5 offset:24576
    v_exp_f32 v104, v104
    v_exp_f32 v105, v105
    v_exp_f32 v106, v106
    v_exp_f32 v107, v107
    v_mfma_f32_32x32x16_bf16 v[64:79], a[156:159], v[84:87], v[64:79]
    v_add_f32 v104, 1.0, v104
    v_add_f32 v105, 1.0, v105
    v_add_f32 v106, 1.0, v106
    v_add_f32 v107, 1.0, v107
    s_waitcnt lgkmcnt(4)
    v_mfma_f32_32x32x16_bf16 v[48:63], a[160:163], v[88:91], v[48:63]
    ds_read_b128 v[84:87], v5 offset:25600
    v_rcp_f32 v104, v104
    v_rcp_f32 v105, v105
    v_rcp_f32 v106, v106
    v_rcp_f32 v107, v107
    v_mfma_f32_32x32x16_bf16 v[64:79], a[164:167], v[88:91], v[64:79]
    v_mul_f32 v36, v36, v104
    v_mul_f32 v37, v37, v105
    v_mul_f32 v38, v38, v106
    v_mul_f32 v39, v39, v107
    s_waitcnt lgkmcnt(4)
    v_mfma_f32_32x32x16_bf16 v[48:63], a[168:171], v[92:95], v[48:63]
    ds_read_b128 v[88:91], v5 offset:26624
    v_cvt_pk_bf16_f32 v41, v40, v41
    v_lshlrev_b32 v40, 16, v41
    v_and_b32 v41, 0xffff0000, v41
    v_cvt_pk_bf16_f32 v43, v42, v43
    v_mfma_f32_32x32x16_bf16 v[64:79], a[172:175], v[92:95], v[64:79]
    v_lshlrev_b32 v42, 16, v43
    v_and_b32 v43, 0xffff0000, v43
    v_mul_f32 v104, 0xbfb8aa3b, v40
    v_mul_f32 v105, 0xbfb8aa3b, v41
    s_waitcnt lgkmcnt(4)
    v_mfma_f32_32x32x16_bf16 v[48:63], a[176:179], v[96:99], v[48:63]
    ds_read_b128 v[92:95], v5 offset:27648
    v_mul_f32 v106, 0xbfb8aa3b, v42
    v_mul_f32 v107, 0xbfb8aa3b, v43
    v_exp_f32 v104, v104
    v_exp_f32 v105, v105
    v_mfma_f32_32x32x16_bf16 v[64:79], a[180:183], v[96:99], v[64:79]
    v_exp_f32 v106, v106
    v_exp_f32 v107, v107
    v_add_f32 v104, 1.0, v104
    v_add_f32 v105, 1.0, v105
    s_waitcnt lgkmcnt(4)
    v_mfma_f32_32x32x16_bf16 v[48:63], a[184:187], v[100:103], v[48:63]
    ds_read_b128 v[96:99], v5 offset:28672
    v_add_f32 v106, 1.0, v106
    v_add_f32 v107, 1.0, v107
    v_rcp_f32 v104, v104
    v_rcp_f32 v105, v105
    v_mfma_f32_32x32x16_bf16 v[64:79], a[188:191], v[100:103], v[64:79]
    v_rcp_f32 v106, v106
    v_rcp_f32 v107, v107
    v_mul_f32 v40, v40, v104
    v_mul_f32 v41, v41, v105
    s_waitcnt lgkmcnt(4)
    v_mfma_f32_32x32x16_bf16 v[48:63], a[192:195], v[80:83], v[48:63]
    ds_read_b128 v[100:103], v5 offset:29696
    v_mul_f32 v42, v42, v106
    v_mul_f32 v43, v43, v107
    v_cvt_pk_bf16_f32 v45, v44, v45
    v_lshlrev_b32 v44, 16, v45
    v_mfma_f32_32x32x16_bf16 v[64:79], a[196:199], v[80:83], v[64:79]
    v_and_b32 v45, 0xffff0000, v45
    v_cvt_pk_bf16_f32 v47, v46, v47
    v_lshlrev_b32 v46, 16, v47
    v_and_b32 v47, 0xffff0000, v47
    s_waitcnt lgkmcnt(4)
    v_mfma_f32_32x32x16_bf16 v[48:63], a[200:203], v[84:87], v[48:63]
    ds_read_b128 v[80:83], v5 offset:30720
    v_mul_f32 v104, 0xbfb8aa3b, v44
    v_mul_f32 v105, 0xbfb8aa3b, v45
    v_mul_f32 v106, 0xbfb8aa3b, v46
    v_mul_f32 v107, 0xbfb8aa3b, v47
    v_mfma_f32_32x32x16_bf16 v[64:79], a[204:207], v[84:87], v[64:79]
    v_exp_f32 v104, v104
    v_exp_f32 v105, v105
    v_exp_f32 v106, v106
    v_exp_f32 v107, v107
    s_waitcnt lgkmcnt(4)
    v_mfma_f32_32x32x16_bf16 v[48:63], a[208:211], v[88:91], v[48:63]
    ds_read_b128 v[84:87], v5 offset:31744
    v_add_f32 v104, 1.0, v104
    v_add_f32 v105, 1.0, v105
    v_add_f32 v106, 1.0, v106
    v_add_f32 v107, 1.0, v107
    v_mfma_f32_32x32x16_bf16 v[64:79], a[212:215], v[88:91], v[64:79]
    v_rcp_f32 v104, v104
    v_rcp_f32 v105, v105
    v_rcp_f32 v106, v106
    v_rcp_f32 v107, v107
    s_waitcnt lgkmcnt(4)
    v_mfma_f32_32x32x16_bf16 v[48:63], a[216:219], v[92:95], v[48:63]
    ds_read_b128 v[88:91], v5 offset:32768
    v_mul_f32 v44, v44, v104
    v_mul_f32 v45, v45, v105
    v_mul_f32 v46, v46, v106
    v_mul_f32 v47, v47, v107
    v_mfma_f32_32x32x16_bf16 v[64:79], a[220:223], v[92:95], v[64:79]
    v_cvt_pk_bf16_f32 v112, v32, v33
    v_cvt_pk_bf16_f32 v113, v34, v35
    v_cvt_pk_bf16_f32 v114, v36, v37
    v_cvt_pk_bf16_f32 v115, v38, v39
    s_waitcnt lgkmcnt(4)
    v_mfma_f32_32x32x16_bf16 v[48:63], a[224:227], v[96:99], v[48:63]
    ds_read_b128 v[92:95], v5 offset:33792
    buffer_store_dwordx4 v[112:115], v2, s[8:11], s47 offen offset:2048 sc0 sc1
    v_cvt_pk_bf16_f32 v116, v40, v41
    v_cvt_pk_bf16_f32 v117, v42, v43
    v_cvt_pk_bf16_f32 v118, v44, v45
    v_mfma_f32_32x32x16_bf16 v[64:79], a[228:231], v[96:99], v[64:79]
    v_cvt_pk_bf16_f32 v119, v46, v47
    buffer_store_dwordx4 v[116:119], v2, s[8:11], s47 offen offset:3072 sc0 sc1
    s_mul_i32 s35, s45, 36864
    s_add_u32 s35, s35, s42
    s_add_u32 s36, s46, s42
    s_mov_b32 m0, s36
    s_nop 0
    buffer_load_dwordx4 v0, s[8:11], s35 offen offset:0 sc1 lds
    buffer_load_dwordx4 v0, s[8:11], s35 offen offset:1024 sc1 lds
    s_waitcnt lgkmcnt(4)
    v_mfma_f32_32x32x16_bf16 v[48:63], a[232:235], v[100:103], v[48:63]
    ds_read_b128 v[96:99], v5 offset:34816
    buffer_load_dwordx4 v0, s[8:11], s35 offen offset:2048 sc1 lds
    buffer_load_dwordx4 v0, s[8:11], s35 offen offset:3072 sc1 lds
    s_add_u32 s35, s35, 4096
    s_add_u32 s36, s36, 4096
    s_mov_b32 m0, s36
    s_nop 0
    buffer_load_dwordx4 v0, s[8:11], s35 offen offset:0 sc1 lds
    buffer_load_dwordx4 v0, s[8:11], s35 offen offset:1024 sc1 lds
    v_mfma_f32_32x32x16_bf16 v[64:79], a[236:239], v[100:103], v[64:79]
    buffer_load_dwordx4 v0, s[8:11], s35 offen offset:2048 sc1 lds
    buffer_load_dwordx4 v0, s[8:11], s35 offen offset:3072 sc1 lds
    s_add_u32 s35, s35, 4096
    s_add_u32 s36, s36, 4096
    s_mov_b32 m0, s36
    s_nop 0
    buffer_load_dwordx4 v0, s[8:11], s35 offen offset:0 sc1 lds
    s_waitcnt lgkmcnt(4)
    v_mfma_f32_32x32x16_bf16 v[48:63], a[240:243], v[80:83], v[48:63]
    ds_read_b128 v[100:103], v5 offset:35840
    v_mfma_f32_32x32x16_bf16 v[64:79], a[244:247], v[80:83], v[64:79]
    s_waitcnt lgkmcnt(4)
    v_mfma_f32_32x32x16_bf16 v[48:63], a[248:251], v[84:87], v[48:63]
    v_mfma_f32_32x32x16_bf16 v[64:79], a[252:255], v[84:87], v[64:79]
    s_waitcnt lgkmcnt(3)
    v_mfma_f32_32x32x16_bf16 v[48:63], v[252:255], v[88:91], v[48:63]
    v_mfma_f32_32x32x16_bf16 v[64:79], v[248:251], v[88:91], v[64:79]
    s_waitcnt lgkmcnt(2)
    v_mfma_f32_32x32x16_bf16 v[48:63], v[244:247], v[92:95], v[48:63]
    v_mfma_f32_32x32x16_bf16 v[64:79], v[240:243], v[92:95], v[64:79]
    s_waitcnt lgkmcnt(1)
    v_mfma_f32_32x32x16_bf16 v[48:63], v[236:239], v[96:99], v[48:63]
    v_mfma_f32_32x32x16_bf16 v[64:79], v[232:235], v[96:99], v[64:79]
    s_waitcnt lgkmcnt(0)
    v_mfma_f32_32x32x16_bf16 v[48:63], v[228:231], v[100:103], v[48:63]
    v_mfma_f32_32x32x16_bf16 v[64:79], v[224:227], v[100:103], v[64:79]
    s_mov_b32 s47, s34
    s_add_u32 s34, s34, s37
    s_add_u32 s40, s40, 36864
    s_cmp_ge_u32 s40, 147456
    s_cselect_b32 s40, 0, s40
    s_add_u32 s33, s33, 1
    s_add_u32 s32, s32, 3
    s_cmp_ge_u32 s32, 64
    s_cbranch_scc1 Lga_H1e
    s_branch Lga_H0
Lga_H0e:
    s_nop 15
    s_nop 3
    v_cvt_pk_bf16_f32 v17, v16, v17
    v_lshlrev_b32 v16, 16, v17
    v_and_b32 v17, 0xffff0000, v17
    v_cvt_pk_bf16_f32 v19, v18, v19
    v_lshlrev_b32 v18, 16, v19
    v_and_b32 v19, 0xffff0000, v19
    v_mul_f32 v104, 0xbfb8aa3b, v16
    v_mul_f32 v105, 0xbfb8aa3b, v17
    v_mul_f32 v106, 0xbfb8aa3b, v18
    v_mul_f32 v107, 0xbfb8aa3b, v19
    v_exp_f32 v104, v104
    v_exp_f32 v105, v105
    v_exp_f32 v106, v106
    v_exp_f32 v107, v107
    v_add_f32 v104, 1.0, v104
    v_add_f32 v105, 1.0, v105
    v_add_f32 v106, 1.0, v106
    v_add_f32 v107, 1.0, v107
    v_rcp_f32 v104, v104
    v_rcp_f32 v105, v105
    v_rcp_f32 v106, v106
    v_rcp_f32 v107, v107
    v_mul_f32 v16, v16, v104
    v_mul_f32 v17, v17, v105
    v_mul_f32 v18, v18, v106
    v_mul_f32 v19, v19, v107
    v_cvt_pk_bf16_f32 v21, v20, v21
    v_lshlrev_b32 v20, 16, v21
    v_and_b32 v21, 0xffff0000, v21
    v_cvt_pk_bf16_f32 v23, v22, v23
    v_lshlrev_b32 v22, 16, v23
    v_and_b32 v23, 0xffff0000, v23
    v_mul_f32 v104, 0xbfb8aa3b, v20
    v_mul_f32 v105, 0xbfb8aa3b, v21
    v_mul_f32 v106, 0xbfb8aa3b, v22
    v_mul_f32 v107, 0xbfb8aa3b, v23
    v_exp_f32 v104, v104
    v_exp_f32 v105, v105
    v_exp_f32 v106, v106
    v_exp_f32 v107, v107
    v_add_f32 v104, 1.0, v104
    v_add_f32 v105, 1.0, v105
    v_add_f32 v106, 1.0, v106
    v_add_f32 v107, 1.0, v107
    v_rcp_f32 v104, v104
    v_rcp_f32 v105, v105
    v_rcp_f32 v106, v106
    v_rcp_f32 v107, v107
    v_mul_f32 v20, v20, v104
    v_mul_f32 v21, v21, v105
    v_mul_f32 v22, v22, v106
    v_mul_f32 v23, v23, v107
    v_cvt_pk_bf16_f32 v25, v24, v25
    v_lshlrev_b32 v24, 16, v25
    v_and_b32 v25, 0xffff0000, v25
    v_cvt_pk_bf16_f32 v27, v26, v27
    v_lshlrev_b32 v26, 16, v27
    v_and_b32 v27, 0xffff0000, v27
    v_mul_f32 v104, 0xbfb8aa3b, v24
    v_mul_f32 v105, 0xbfb8aa3b, v25
    v_mul_f32 v106, 0xbfb8aa3b, v26
    v_mul_f32 v107, 0xbfb8aa3b, v27
    v_exp_f32 v104, v104
    v_exp_f32 v105, v105
    v_exp_f32 v106, v106
    v_exp_f32 v107, v107
    v_add_f32 v104, 1.0, v104
    v_add_f32 v105, 1.0, v105
    v_add_f32 v106, 1.0, v106
    v_add_f32 v107, 1.0, v107
    v_rcp_f32 v104, v104
    v_rcp_f32 v105, v105
    v_rcp_f32 v106, v106
    v_rcp_f32 v107, v107
    v_mul_f32 v24, v24, v104
    v_mul_f32 v25, v25, v105
    v_mul_f32 v26, v26, v106
    v_mul_f32 v27, v27, v107
    v_cvt_pk_bf16_f32 v29, v28, v29
    v_lshlrev_b32 v28, 16, v29
    v_and_b32 v29, 0xffff0000, v29
    v_cvt_pk_bf16_f32 v31, v30, v31
    v_lshlrev_b32 v30, 16, v31
    v_and_b32 v31, 0xffff0000, v31
    v_mul_f32 v104, 0xbfb8aa3b, v28
    v_mul_f32 v105, 0xbfb8aa3b, v29
    v_mul_f32 v106, 0xbfb8aa3b, v30
    v_mul_f32 v107, 0xbfb8aa3b, v31
    v_exp_f32 v104, v104
    v_exp_f32 v105, v105
    v_exp_f32 v106, v106
    v_exp_f32 v107, v107
    v_add_f32 v104, 1.0, v104
    v_add_f32 v105, 1.0, v105
    v_add_f32 v106, 1.0, v106
    v_add_f32 v107, 1.0, v107
    v_rcp_f32 v104, v104
    v_rcp_f32 v105, v105
    v_rcp_f32 v106, v106
    v_rcp_f32 v107, v107
    v_mul_f32 v28, v28, v104
    v_mul_f32 v29, v29, v105
    v_mul_f32 v30, v30, v106
    v_mul_f32 v31, v31, v107
    v_cvt_pk_bf16_f32 v112, v16, v17
    v_cvt_pk_bf16_f32 v113, v18, v19
    v_cvt_pk_bf16_f32 v114, v20, v21
    v_cvt_pk_bf16_f32 v115, v22, v23
    buffer_store_dwordx4 v[112:115], v2, s[8:11], s47 offen offset:0 sc0 sc1
    v_cvt_pk_bf16_f32 v116, v24, v25
    v_cvt_pk_bf16_f32 v117, v26, v27
    v_cvt_pk_bf16_f32 v118, v28, v29
    v_cvt_pk_bf16_f32 v119, v30, v31
    buffer_store_dwordx4 v[116:119], v2, s[8:11], s47 offen offset:1024 sc0 sc1
    v_cvt_pk_bf16_f32 v33, v32, v33
    v_lshlrev_b32 v32, 16, v33
    v_and_b32 v33, 0xffff0000, v33
    v_cvt_pk_bf16_f32 v35, v34, v35
    v_lshlrev_b32 v34, 16, v35
    v_and_b32 v35, 0xffff0000, v35
    v_mul_f32 v104, 0xbfb8aa3b, v32
    v_mul_f32 v105, 0xbfb8aa3b, v33
    v_mul_f32 v106, 0xbfb8aa3b, v34
    v_mul_f32 v107, 0xbfb8aa3b, v35
    v_exp_f32 v104, v104
    v_exp_f32 v105, v105
    v_exp_f32 v106, v106
    v_exp_f32 v107, v107
    v_add_f32 v104, 1.0, v104
    v_add_f32 v105, 1.0, v105
    v_add_f32 v106, 1.0, v106
    v_add_f32 v107, 1.0, v107
    v_rcp_f32 v104, v104
    v_rcp_f32 v105, v105
    v_rcp_f32 v106, v106
    v_rcp_f32 v107, v107
    v_mul_f32 v32, v32, v104
    v_mul_f32 v33, v33, v105
    v_mul_f32 v34, v34, v106
    v_mul_f32 v35, v35, v107
    v_cvt_pk_bf16_f32 v37, v36, v37
    v_lshlrev_b32 v36, 16, v37
    v_and_b32 v37, 0xffff0000, v37
    v_cvt_pk_bf16_f32 v39, v38, v39
    v_lshlrev_b32 v38, 16, v39
    v_and_b32 v39, 0xffff0000, v39
    v_mul_f32 v104, 0xbfb8aa3b, v36
    v_mul_f32 v105, 0xbfb8aa3b, v37
    v_mul_f32 v106, 0xbfb8aa3b, v38
    v_mul_f32 v107, 0xbfb8aa3b, v39
    v_exp_f32 v104, v104
    v_exp_f32 v105, v105
    v_exp_f32 v106, v106
    v_exp_f32 v107, v107
    v_add_f32 v104, 1.0, v104
    v_add_f32 v105, 1.0, v105
    v_add_f32 v106, 1.0, v106
    v_add_f32 v107, 1.0, v107
    v_rcp_f32 v104, v104
    v_rcp_f32 v105, v105
    v_rcp_f32 v106, v106
    v_rcp_f32 v107, v107
    v_mul_f32 v36, v36, v104
    v_mul_f32 v37, v37, v105
    v_mul_f32 v38, v38, v106
    v_mul_f32 v39, v39, v107
    v_cvt_pk_bf16_f32 v41, v40, v41
    v_lshlrev_b32 v40, 16, v41
    v_and_b32 v41, 0xffff0000, v41
    v_cvt_pk_bf16_f32 v43, v42, v43
    v_lshlrev_b32 v42, 16, v43
    v_and_b32 v43, 0xffff0000, v43
    v_mul_f32 v104, 0xbfb8aa3b, v40
    v_mul_f32 v105, 0xbfb8aa3b, v41
    v_mul_f32 v106, 0xbfb8aa3b, v42
    v_mul_f32 v107, 0xbfb8aa3b, v43
    v_exp_f32 v104, v104
    v_exp_f32 v105, v105
    v_exp_f32 v106, v106
    v_exp_f32 v107, v107
    v_add_f32 v104, 1.0, v104
    v_add_f32 v105, 1.0, v105
    v_add_f32 v106, 1.0, v106
    v_add_f32 v107, 1.0, v107
    v_rcp_f32 v104, v104
    v_rcp_f32 v105, v105
    v_rcp_f32 v106, v106
    v_rcp_f32 v107, v107
    v_mul_f32 v40, v40, v104
    v_mul_f32 v41, v41, v105
    v_mul_f32 v42, v42, v106
    v_mul_f32 v43, v43, v107
    v_cvt_pk_bf16_f32 v45, v44, v45
    v_lshlrev_b32 v44, 16, v45
    v_and_b32 v45, 0xffff0000, v45
    v_cvt_pk_bf16_f32 v47, v46, v47
    v_lshlrev_b32 v46, 16, v47
    v_and_b32 v47, 0xffff0000, v47
    v_mul_f32 v104, 0xbfb8aa3b, v44
    v_mul_f32 v105, 0xbfb8aa3b, v45
    v_mul_f32 v106, 0xbfb8aa3b, v46
    v_mul_f32 v107, 0xbfb8aa3b, v47
    v_exp_f32 v104, v104
    v_exp_f32 v105, v105
    v_exp_f32 v106, v106
    v_exp_f32 v107, v107
    v_add_f32 v104, 1.0, v104
    v_add_f32 v105, 1.0, v105
    v_add_f32 v106, 1.0, v106
    v_add_f32 v107, 1.0, v107
    v_rcp_f32 v104, v104
    v_rcp_f32 v105, v105
    v_rcp_f32 v106, v106
    v_rcp_f32 v107, v107
    v_mul_f32 v44, v44, v104
    v_mul_f32 v45, v45, v105
    v_mul_f32 v46, v46, v106
    v_mul_f32 v47, v47, v107
    v_cvt_pk_bf16_f32 v112, v32, v33
    v_cvt_pk_bf16_f32 v113, v34, v35
    v_cvt_pk_bf16_f32 v114, v36, v37
    v_cvt_pk_bf16_f32 v115, v38, v39
    buffer_store_dwordx4 v[112:115], v2, s[8:11], s47 offen offset:2048 sc0 sc1
    v_cvt_pk_bf16_f32 v116, v40, v41
    v_cvt_pk_bf16_f32 v117, v42, v43
    v_cvt_pk_bf16_f32 v118, v44, v45
    v_cvt_pk_bf16_f32 v119, v46, v47
    buffer_store_dwordx4 v[116:119], v2, s[8:11], s47 offen offset:3072 sc0 sc1
    s_branch Lga_end
Lga_H1e:
    s_nop 15
    s_nop 3
    v_cvt_pk_bf16_f32 v49, v48, v49
    v_lshlrev_b32 v48, 16, v49
    v_and_b32 v49, 0xffff0000, v49
    v_cvt_pk_bf16_f32 v51, v50, v51
    v_lshlrev_b32 v50, 16, v51
    v_and_b32 v51, 0xffff0000, v51
    v_mul_f32 v104, 0xbfb8aa3b, v48
    v_mul_f32 v105, 0xbfb8aa3b, v49
    v_mul_f32 v106, 0xbfb8aa3b, v50
    v_mul_f32 v107, 0xbfb8aa3b, v51
    v_exp_f32 v104, v104
    v_exp_f32 v105, v105
    v_exp_f32 v106, v106
    v_exp_f32 v107, v107
    v_add_f32 v104, 1.0, v104
    v_add_f32 v105, 1.0, v105
    v_add_f32 v106, 1.0, v106
    v_add_f32 v107, 1.0, v107
    v_rcp_f32 v104, v104
    v_rcp_f32 v105, v105
    v_rcp_f32 v106, v106
    v_rcp_f32 v107, v107
    v_mul_f32 v48, v48, v104
    v_mul_f32 v49, v49, v105
    v_mul_f32 v50, v50, v106
    v_mul_f32 v51, v51, v107
    v_cvt_pk_bf16_f32 v53, v52, v53
    v_lshlrev_b32 v52, 16, v53
    v_and_b32 v53, 0xffff0000, v53
    v_cvt_pk_bf16_f32 v55, v54, v55
    v_lshlrev_b32 v54, 16, v55
    v_and_b32 v55, 0xffff0000, v55
    v_mul_f32 v104, 0xbfb8aa3b, v52
    v_mul_f32 v105, 0xbfb8aa3b, v53
    v_mul_f32 v106, 0xbfb8aa3b, v54
    v_mul_f32 v107, 0xbfb8aa3b, v55
    v_exp_f32 v104, v104
    v_exp_f32 v105, v105
    v_exp_f32 v106, v106
    v_exp_f32 v107, v107
    v_add_f32 v104, 1.0, v104
    v_add_f32 v105, 1.0, v105
    v_add_f32 v106, 1.0, v106
    v_add_f32 v107, 1.0, v107
    v_rcp_f32 v104, v104
    v_rcp_f32 v105, v105
    v_rcp_f32 v106, v106
    v_rcp_f32 v107, v107
    v_mul_f32 v52, v52, v104
    v_mul_f32 v53, v53, v105
    v_mul_f32 v54, v54, v106
    v_mul_f32 v55, v55, v107
    v_cvt_pk_bf16_f32 v57, v56, v57
    v_lshlrev_b32 v56, 16, v57
    v_and_b32 v57, 0xffff0000, v57
    v_cvt_pk_bf16_f32 v59, v58, v59
    v_lshlrev_b32 v58, 16, v59
    v_and_b32 v59, 0xffff0000, v59
    v_mul_f32 v104, 0xbfb8aa3b, v56
    v_mul_f32 v105, 0xbfb8aa3b, v57
    v_mul_f32 v106, 0xbfb8aa3b, v58
    v_mul_f32 v107, 0xbfb8aa3b, v59
    v_exp_f32 v104, v104
    v_exp_f32 v105, v105
    v_exp_f32 v106, v106
    v_exp_f32 v107, v107
    v_add_f32 v104, 1.0, v104
    v_add_f32 v105, 1.0, v105
    v_add_f32 v106, 1.0, v106
    v_add_f32 v107, 1.0, v107
    v_rcp_f32 v104, v104
    v_rcp_f32 v105, v105
    v_rcp_f32 v106, v106
    v_rcp_f32 v107, v107
    v_mul_f32 v56, v56, v104
    v_mul_f32 v57, v57, v105
    v_mul_f32 v58, v58, v106
    v_mul_f32 v59, v59, v107
    v_cvt_pk_bf16_f32 v61, v60, v61
    v_lshlrev_b32 v60, 16, v61
    v_and_b32 v61, 0xffff0000, v61
    v_cvt_pk_bf16_f32 v63, v62, v63
    v_lshlrev_b32 v62, 16, v63
    v_and_b32 v63, 0xffff0000, v63
    v_mul_f32 v104, 0xbfb8aa3b, v60
    v_mul_f32 v105, 0xbfb8aa3b, v61
    v_mul_f32 v106, 0xbfb8aa3b, v62
    v_mul_f32 v107, 0xbfb8aa3b, v63
    v_exp_f32 v104, v104
    v_exp_f32 v105, v105
    v_exp_f32 v106, v106
    v_exp_f32 v107, v107
    v_add_f32 v104, 1.0, v104
    v_add_f32 v105, 1.0, v105
    v_add_f32 v106, 1.0, v106
    v_add_f32 v107, 1.0, v107
    v_rcp_f32 v104, v104
    v_rcp_f32 v105, v105
    v_rcp_f32 v106, v106
    v_rcp_f32 v107, v107
    v_mul_f32 v60, v60, v104
    v_mul_f32 v61, v61, v105
    v_mul_f32 v62, v62, v106
    v_mul_f32 v63, v63, v107
    v_cvt_pk_bf16_f32 v112, v48, v49
    v_cvt_pk_bf16_f32 v113, v50, v51
    v_cvt_pk_bf16_f32 v114, v52, v53
    v_cvt_pk_bf16_f32 v115, v54, v55
    buffer_store_dwordx4 v[112:115], v2, s[8:11], s47 offen offset:0 sc0 sc1
    v_cvt_pk_bf16_f32 v116, v56, v57
    v_cvt_pk_bf16_f32 v117, v58, v59
    v_cvt_pk_bf16_f32 v118, v60, v61
    v_cvt_pk_bf16_f32 v119, v62, v63
    buffer_store_dwordx4 v[116:119], v2, s[8:11], s47 offen offset:1024 sc0 sc1
    v_cvt_pk_bf16_f32 v65, v64, v65
    v_lshlrev_b32 v64, 16, v65
    v_and_b32 v65, 0xffff0000, v65
    v_cvt_pk_bf16_f32 v67, v66, v67
    v_lshlrev_b32 v66, 16, v67
    v_and_b32 v67, 0xffff0000, v67
    v_mul_f32 v104, 0xbfb8aa3b, v64
    v_mul_f32 v105, 0xbfb8aa3b, v65
    v_mul_f32 v106, 0xbfb8aa3b, v66
    v_mul_f32 v107, 0xbfb8aa3b, v67
    v_exp_f32 v104, v104
    v_exp_f32 v105, v105
    v_exp_f32 v106, v106
    v_exp_f32 v107, v107
    v_add_f32 v104, 1.0, v104
    v_add_f32 v105, 1.0, v105
    v_add_f32 v106, 1.0, v106
    v_add_f32 v107, 1.0, v107
    v_rcp_f32 v104, v104
    v_rcp_f32 v105, v105
    v_rcp_f32 v106, v106
    v_rcp_f32 v107, v107
    v_mul_f32 v64, v64, v104
    v_mul_f32 v65, v65, v105
    v_mul_f32 v66, v66, v106
    v_mul_f32 v67, v67, v107
    v_cvt_pk_bf16_f32 v69, v68, v69
    v_lshlrev_b32 v68, 16, v69
    v_and_b32 v69, 0xffff0000, v69
    v_cvt_pk_bf16_f32 v71, v70, v71
    v_lshlrev_b32 v70, 16, v71
    v_and_b32 v71, 0xffff0000, v71
    v_mul_f32 v104, 0xbfb8aa3b, v68
    v_mul_f32 v105, 0xbfb8aa3b, v69
    v_mul_f32 v106, 0xbfb8aa3b, v70
    v_mul_f32 v107, 0xbfb8aa3b, v71
    v_exp_f32 v104, v104
    v_exp_f32 v105, v105
    v_exp_f32 v106, v106
    v_exp_f32 v107, v107
    v_add_f32 v104, 1.0, v104
    v_add_f32 v105, 1.0, v105
    v_add_f32 v106, 1.0, v106
    v_add_f32 v107, 1.0, v107
    v_rcp_f32 v104, v104
    v_rcp_f32 v105, v105
    v_rcp_f32 v106, v106
    v_rcp_f32 v107, v107
    v_mul_f32 v68, v68, v104
    v_mul_f32 v69, v69, v105
    v_mul_f32 v70, v70, v106
    v_mul_f32 v71, v71, v107
    v_cvt_pk_bf16_f32 v73, v72, v73
    v_lshlrev_b32 v72, 16, v73
    v_and_b32 v73, 0xffff0000, v73
    v_cvt_pk_bf16_f32 v75, v74, v75
    v_lshlrev_b32 v74, 16, v75
    v_and_b32 v75, 0xffff0000, v75
    v_mul_f32 v104, 0xbfb8aa3b, v72
    v_mul_f32 v105, 0xbfb8aa3b, v73
    v_mul_f32 v106, 0xbfb8aa3b, v74
    v_mul_f32 v107, 0xbfb8aa3b, v75
    v_exp_f32 v104, v104
    v_exp_f32 v105, v105
    v_exp_f32 v106, v106
    v_exp_f32 v107, v107
    v_add_f32 v104, 1.0, v104
    v_add_f32 v105, 1.0, v105
    v_add_f32 v106, 1.0, v106
    v_add_f32 v107, 1.0, v107
    v_rcp_f32 v104, v104
    v_rcp_f32 v105, v105
    v_rcp_f32 v106, v106
    v_rcp_f32 v107, v107
    v_mul_f32 v72, v72, v104
    v_mul_f32 v73, v73, v105
    v_mul_f32 v74, v74, v106
    v_mul_f32 v75, v75, v107
    v_cvt_pk_bf16_f32 v77, v76, v77
    v_lshlrev_b32 v76, 16, v77
    v_and_b32 v77, 0xffff0000, v77
    v_cvt_pk_bf16_f32 v79, v78, v79
    v_lshlrev_b32 v78, 16, v79
    v_and_b32 v79, 0xffff0000, v79
    v_mul_f32 v104, 0xbfb8aa3b, v76
    v_mul_f32 v105, 0xbfb8aa3b, v77
    v_mul_f32 v106, 0xbfb8aa3b, v78
    v_mul_f32 v107, 0xbfb8aa3b, v79
    v_exp_f32 v104, v104
    v_exp_f32 v105, v105
    v_exp_f32 v106, v106
    v_exp_f32 v107, v107
    v_add_f32 v104, 1.0, v104
    v_add_f32 v105, 1.0, v105
    v_add_f32 v106, 1.0, v106
    v_add_f32 v107, 1.0, v107
    v_rcp_f32 v104, v104
    v_rcp_f32 v105, v105
    v_rcp_f32 v106, v106
    v_rcp_f32 v107, v107
    v_mul_f32 v76, v76, v104
    v_mul_f32 v77, v77, v105
    v_mul_f32 v78, v78, v106
    v_mul_f32 v79, v79, v107
    v_cvt_pk_bf16_f32 v112, v64, v65
    v_cvt_pk_bf16_f32 v113, v66, v67
    v_cvt_pk_bf16_f32 v114, v68, v69
    v_cvt_pk_bf16_f32 v115, v70, v71
    buffer_store_dwordx4 v[112:115], v2, s[8:11], s47 offen offset:2048 sc0 sc1
    v_cvt_pk_bf16_f32 v116, v72, v73
    v_cvt_pk_bf16_f32 v117, v74, v75
    v_cvt_pk_bf16_f32 v118, v76, v77
    v_cvt_pk_bf16_f32 v119, v78, v79
    buffer_store_dwordx4 v[116:119], v2, s[8:11], s47 offen offset:3072 sc0 sc1
    s_branch Lga_end
Lga_end:
    s_waitcnt vmcnt(0)
    s_barrier
    s_cmp_lg_u32 s29, 0
    s_cbranch_scc1 Lga_done
    v_mov_b32 v6, 0
    v_mov_b32 v7, 64
    s_mov_b64 exec, 1
    buffer_store_dword v7, v6, s[8:11], s41 offen sc0 sc1
    s_mov_b64 exec, -1
Lga_done:
    s_mul_hi_u32 s30, s28, 238609295
    s_mul_i32 s35, s30, 18
    s_sub_u32 s31, s28, s35
    s_lshl_b32 s38, s29, 15
    s_load_dwordx2 s[12:13], s[0:1], 72
    s_mov_b32 s14, 5308416
    s_mov_b32 s15, 0x20000
    s_waitcnt lgkmcnt(0)
    s_mul_i32 s44, s29, 1327104
    s_lshl_b32 s35, s31, 6
    s_add_u32 s44, s44, s35
    s_barrier
    v_lshrrev_b32 v4, 2, v1
    s_mov_b32 s35, 1152
    v_mul_lo_u32 v2, v4, s35
    v_and_b32 v4, 3, v1
    v_lshl_add_u32 v2, v4, 4, v2
    v_bfe_u32 v4, v1, 5, 1
    v_lshlrev_b32 v3, 10, v4
    v_bfe_u32 v4, v1, 4, 1
    v_lshl_add_u32 v3, v4, 8, v3
    v_bfe_u32 v4, v1, 2, 2
    v_lshl_add_u32 v3, v4, 6, v3
    v_bfe_u32 v4, v1, 0, 2
    v_lshl_add_u32 v3, v4, 3, v3
    v_add_u32 v3, s38, v3
    s_add_u32 m0, s38, 0
    s_add_u32 s35, s44, 0
    buffer_load_dwordx4 v2, s[12:15], s35 offen lds
    s_add_u32 m0, s38, 1024
    s_add_u32 s35, s44, 18432
    buffer_load_dwordx4 v2, s[12:15], s35 offen lds
    s_add_u32 m0, s38, 2048
    s_add_u32 s35, s44, 36864
    buffer_load_dwordx4 v2, s[12:15], s35 offen lds
    s_add_u32 m0, s38, 3072
    s_add_u32 s35, s44, 55296
    buffer_load_dwordx4 v2, s[12:15], s35 offen lds
    s_add_u32 m0, s38, 4096
    s_add_u32 s35, s44, 73728
    buffer_load_dwordx4 v2, s[12:15], s35 offen lds
    s_add_u32 m0, s38, 5120
    s_add_u32 s35, s44, 92160
    buffer_load_dwordx4 v2, s[12:15], s35 offen lds
    s_add_u32 m0, s38, 6144
    s_add_u32 s35, s44, 110592
    buffer_load_dwordx4 v2, s[12:15], s35 offen lds
    s_add_u32 m0, s38, 7168
    s_add_u32 s35, s44, 129024
    buffer_load_dwordx4 v2, s[12:15], s35 offen lds
    s_add_u32 m0, s38, 8192
    s_add_u32 s35, s44, 147456
    buffer_load_dwordx4 v2, s[12:15], s35 offen lds
    s_add_u32 m0, s38, 9216
    s_add_u32 s35, s44, 165888
    buffer_load_dwordx4 v2, s[12:15], s35 offen lds
    s_add_u32 m0, s38, 10240
    s_add_u32 s35, s44, 184320
    buffer_load_dwordx4 v2, s[12:15], s35 offen lds
    s_add_u32 m0, s38, 11264
    s_add_u32 s35, s44, 202752
    buffer_load_dwordx4 v2, s[12:15], s35 offen lds
    s_add_u32 m0, s38, 12288
    s_add_u32 s35, s44, 221184
    buffer_load_dwordx4 v2, s[12:15], s35 offen lds
    s_add_u32 m0, s38, 13312
    s_add_u32 s35, s44, 239616
    buffer_load_dwordx4 v2, s[12:15], s35 offen lds
    s_add_u32 m0, s38, 14336
    s_add_u32 s35, s44, 258048
    buffer_load_dwordx4 v2, s[12:15], s35 offen lds
    s_add_u32 m0, s38, 15360
    s_add_u32 s35, s44, 276480
    buffer_load_dwordx4 v2, s[12:15], s35 offen lds
    s_waitcnt vmcnt(12)
    ds_read_b64_tr_b16 a[0:1], v3 offset:0
    ds_read_b64_tr_b16 a[2:3], v3 offset:512
    ds_read_b64_tr_b16 a[4:5], v3 offset:32
    ds_read_b64_tr_b16 a[6:7], v3 offset:544
    ds_read_b64_tr_b16 a[8:9], v3 offset:2048
    ds_read_b64_tr_b16 a[10:11], v3 offset:2560
    ds_read_b64_tr_b16 a[12:13], v3 offset:2080
    ds_read_b64_tr_b16 a[14:15], v3 offset:2592
    s_waitcnt lgkmcnt(0)
    s_add_u32 m0, s38, 16384
    s_add_u32 s35, s44, 294912
    buffer_load_dwordx4 v2, s[12:15], s35 offen lds
    s_add_u32 m0, s38, 17408
    s_add_u32 s35, s44, 313344
    buffer_load_dwordx4 v2, s[12:15], s35 offen lds
    s_add_u32 m0, s38, 18432
    s_add_u32 s35, s44, 331776
    buffer_load_dwordx4 v2, s[12:15], s35 offen lds
    s_add_u32 m0, s38, 19456
    s_add_u32 s35, s44, 350208
    buffer_load_dwordx4 v2, s[12:15], s35 offen lds
    s_waitcnt vmcnt(12)
    ds_read_b64_tr_b16 a[16:17], v3 offset:4096
    ds_read_b64_tr_b16 a[18:19], v3 offset:4608
    ds_read_b64_tr_b16 a[20:21], v3 offset:4128
    ds_read_b64_tr_b16 a[22:23], v3 offset:4640
    ds_read_b64_tr_b16 a[24:25], v3 offset:6144
    ds_read_b64_tr_b16 a[26:27], v3 offset:6656
    ds_read_b64_tr_b16 a[28:29], v3 offset:6176
    ds_read_b64_tr_b16 a[30:31], v3 offset:6688
    s_waitcnt lgkmcnt(0)
    s_add_u32 m0, s38, 20480
    s_add_u32 s35, s44, 368640
    buffer_load_dwordx4 v2, s[12:15], s35 offen lds
    s_add_u32 m0, s38, 21504
    s_add_u32 s35, s44, 387072
    buffer_load_dwordx4 v2, s[12:15], s35 offen lds
    s_add_u32 m0, s38, 22528
    s_add_u32 s35, s44, 405504
    buffer_load_dwordx4 v2, s[12:15], s35 offen lds
    s_add_u32 m0, s38, 23552
    s_add_u32 s35, s44, 423936
    buffer_load_dwordx4 v2, s[12:15], s35 offen lds
    s_waitcnt vmcnt(12)
    ds_read_b64_tr_b16 a[32:33], v3 offset:8192
    ds_read_b64_tr_b16 a[34:35], v3 offset:8704
    ds_read_b64_tr_b16 a[36:37], v3 offset:8224
    ds_read_b64_tr_b16 a[38:39], v3 offset:8736
    ds_read_b64_tr_b16 a[40:41], v3 offset:10240
    ds_read_b64_tr_b16 a[42:43], v3 offset:10752
    ds_read_b64_tr_b16 a[44:45], v3 offset:10272
    ds_read_b64_tr_b16 a[46:47], v3 offset:10784
    s_waitcnt lgkmcnt(0)
    s_add_u32 m0, s38, 24576
    s_add_u32 s35, s44, 442368
    buffer_load_dwordx4 v2, s[12:15], s35 offen lds
    s_add_u32 m0, s38, 25600
    s_add_u32 s35, s44, 460800
    buffer_load_dwordx4 v2, s[12:15], s35 offen lds
    s_add_u32 m0, s38, 26624
    s_add_u32 s35, s44, 479232
    buffer_load_dwordx4 v2, s[12:15], s35 offen lds
    s_add_u32 m0, s38, 27648
    s_add_u32 s35, s44, 497664
    buffer_load_dwordx4 v2, s[12:15], s35 offen lds
    s_waitcnt vmcnt(12)
    ds_read_b64_tr_b16 a[48:49], v3 offset:12288
    ds_read_b64_tr_b16 a[50:51], v3 offset:12800
    ds_read_b64_tr_b16 a[52:53], v3 offset:12320
    ds_read_b64_tr_b16 a[54:55], v3 offset:12832
    ds_read_b64_tr_b16 a[56:57], v3 offset:14336
    ds_read_b64_tr_b16 a[58:59], v3 offset:14848
    ds_read_b64_tr_b16 a[60:61], v3 offset:14368
    ds_read_b64_tr_b16 a[62:63], v3 offset:14880
    s_waitcnt lgkmcnt(0)
    s_add_u32 m0, s38, 28672
    s_add_u32 s35, s44, 516096
    buffer_load_dwordx4 v2, s[12:15], s35 offen lds
    s_add_u32 m0, s38, 29696
    s_add_u32 s35, s44, 534528
    buffer_load_dwordx4 v2, s[12:15], s35 offen lds
    s_add_u32 m0, s38, 30720
    s_add_u32 s35, s44, 552960
    buffer_load_dwordx4 v2, s[12:15], s35 offen lds
    s_add_u32 m0, s38, 31744
    s_add_u32 s35, s44, 571392
    buffer_load_dwordx4 v2, s[12:15], s35 offen lds
    s_waitcnt vmcnt(12)
    ds_read_b64_tr_b16 a[64:65], v3 offset:16384
    ds_read_b64_tr_b16 a[66:67], v3 offset:16896
    ds_read_b64_tr_b16 a[68:69], v3 offset:16416
    ds_read_b64_tr_b16 a[70:71], v3 offset:16928
    ds_read_b64_tr_b16 a[72:73], v3 offset:18432
    ds_read_b64_tr_b16 a[74:75], v3 offset:18944
    ds_read_b64_tr_b16 a[76:77], v3 offset:18464
    ds_read_b64_tr_b16 a[78:79], v3 offset:18976
    s_waitcnt lgkmcnt(0)
    s_add_u32 m0, s38, 0
    s_add_u32 s35, s44, 589824
    buffer_load_dwordx4 v2, s[12:15], s35 offen lds
    s_add_u32 m0, s38, 1024
    s_add_u32 s35, s44, 608256
    buffer_load_dwordx4 v2, s[12:15], s35 offen lds
    s_add_u32 m0, s38, 2048
    s_add_u32 s35, s44, 626688
    buffer_load_dwordx4 v2, s[12:15], s35 offen lds
    s_add_u32 m0, s38, 3072
    s_add_u32 s35, s44, 645120
    buffer_load_dwordx4 v2, s[12:15], s35 offen lds
    s_waitcnt vmcnt(12)
    ds_read_b64_tr_b16 a[80:81], v3 offset:20480
    ds_read_b64_tr_b16 a[82:83], v3 offset:20992
    ds_read_b64_tr_b16 a[84:85], v3 offset:20512
    ds_read_b64_tr_b16 a[86:87], v3 offset:21024
    ds_read_b64_tr_b16 a[88:89], v3 offset:22528
    ds_read_b64_tr_b16 a[90:91], v3 offset:23040
    ds_read_b64_tr_b16 a[92:93], v3 offset:22560
    ds_read_b64_tr_b16 a[94:95], v3 offset:23072
    s_waitcnt lgkmcnt(0)
    s_add_u32 m0, s38, 4096
    s_add_u32 s35, s44, 663552
    buffer_load_dwordx4 v2, s[12:15], s35 offen lds
    s_add_u32 m0, s38, 5120
    s_add_u32 s35, s44, 681984
    buffer_load_dwordx4 v2, s[12:15], s35 offen lds
    s_add_u32 m0, s38, 6144
    s_add_u32 s35, s44, 700416
    buffer_load_dwordx4 v2, s[12:15], s35 offen lds
    s_add_u32 m0, s38, 7168
    s_add_u32 s35, s44, 718848
    buffer_load_dwordx4 v2, s[12:15], s35 offen lds
    s_waitcnt vmcnt(12)
    ds_read_b64_tr_b16 a[96:97], v3 offset:24576
    ds_read_b64_tr_b16 a[98:99], v3 offset:25088
    ds_read_b64_tr_b16 a[100:101], v3 offset:24608
    ds_read_b64_tr_b16 a[102:103], v3 offset:25120
    ds_read_b64_tr_b16 a[104:105], v3 offset:26624
    ds_read_b64_tr_b16 a[106:107], v3 offset:27136
    ds_read_b64_tr_b16 a[108:109], v3 offset:26656
    ds_read_b64_tr_b16 a[110:111], v3 offset:27168
    s_waitcnt lgkmcnt(0)
    s_add_u32 m0, s38, 8192
    s_add_u32 s35, s44, 737280
    buffer_load_dwordx4 v2, s[12:15], s35 offen lds
    s_add_u32 m0, s38, 9216
    s_add_u32 s35, s44, 755712
    buffer_load_dwordx4 v2, s[12:15], s35 offen lds
    s_add_u32 m0, s38, 10240
    s_add_u32 s35, s44, 774144
    buffer_load_dwordx4 v2, s[12:15], s35 offen lds
    s_add_u32 m0, s38, 11264
    s_add_u32 s35, s44, 792576
    buffer_load_dwordx4 v2, s[12:15], s35 offen lds
    s_waitcnt vmcnt(12)
    ds_read_b64_tr_b16 a[112:113], v3 offset:28672
    ds_read_b64_tr_b16 a[114:115], v3 offset:29184
    ds_read_b64_tr_b16 a[116:117], v3 offset:28704
    ds_read_b64_tr_b16 a[118:119], v3 offset:29216
    ds_read_b64_tr_b16 a[120:121], v3 offset:30720
    ds_read_b64_tr_b16 a[122:123], v3 offset:31232
    ds_read_b64_tr_b16 a[124:125], v3 offset:30752
    ds_read_b64_tr_b16 a[126:127], v3 offset:31264
    s_waitcnt lgkmcnt(0)
    s_add_u32 m0, s38, 12288
    s_add_u32 s35, s44, 811008
    buffer_load_dwordx4 v2, s[12:15], s35 offen lds
    s_add_u32 m0, s38, 13312
    s_add_u32 s35, s44, 829440
    buffer_load_dwordx4 v2, s[12:15], s35 offen lds
    s_add_u32 m0, s38, 14336
    s_add_u32 s35, s44, 847872
    buffer_load_dwordx4 v2, s[12:15], s35 offen lds
    s_add_u32 m0, s38, 15360
    s_add_u32 s35, s44, 866304
    buffer_load_dwordx4 v2, s[12:15], s35 offen lds
    s_waitcnt vmcnt(12)
    ds_read_b64_tr_b16 a[128:129], v3 offset:0
    ds_read_b64_tr_b16 a[130:131], v3 offset:512
    ds_read_b64_tr_b16 a[132:133], v3 offset:32
    ds_read_b64_tr_b16 a[134:135], v3 offset:544
    ds_read_b64_tr_b16 a[136:137], v3 offset:2048
    ds_read_b64_tr_b16 a[138:139], v3 offset:2560
    ds_read_b64_tr_b16 a[140:141], v3 offset:2080
    ds_read_b64_tr_b16 a[142:143], v3 offset:2592
    s_waitcnt lgkmcnt(0)
    s_add_u32 m0, s38, 16384
    s_add_u32 s35, s44, 884736
    buffer_load_dwordx4 v2, s[12:15], s35 offen lds
    s_add_u32 m0, s38, 17408
    s_add_u32 s35, s44, 903168
    buffer_load_dwordx4 v2, s[12:15], s35 offen lds
    s_add_u32 m0, s38, 18432
    s_add_u32 s35, s44, 921600
    buffer_load_dwordx4 v2, s[12:15], s35 offen lds
    s_add_u32 m0, s38, 19456
    s_add_u32 s35, s44, 940032
    buffer_load_dwordx4 v2, s[12:15], s35 offen lds
    s_waitcnt vmcnt(12)
    ds_read_b64_tr_b16 a[144:145], v3 offset:4096
    ds_read_b64_tr_b16 a[146:147], v3 offset:4608
    ds_read_b64_tr_b16 a[148:149], v3 offset:4128
    ds_read_b64_tr_b16 a[150:151], v3 offset:4640
    ds_read_b64_tr_b16 a[152:153], v3 offset:6144
    ds_read_b64_tr_b16 a[154:155], v3 offset:6656
    ds_read_b64_tr_b16 a[156:157], v3 offset:6176
    ds_read_b64_tr_b16 a[158:159], v3 offset:6688
    s_waitcnt lgkmcnt(0)
    s_add_u32 m0, s38, 20480
    s_add_u32 s35, s44, 958464
    buffer_load_dwordx4 v2, s[12:15], s35 offen lds
    s_add_u32 m0, s38, 21504
    s_add_u32 s35, s44, 976896
    buffer_load_dwordx4 v2, s[12:15], s35 offen lds
    s_add_u32 m0, s38, 22528
    s_add_u32 s35, s44, 995328
    buffer_load_dwordx4 v2, s[12:15], s35 offen lds
    s_add_u32 m0, s38, 23552
    s_add_u32 s35, s44, 1013760
    buffer_load_dwordx4 v2, s[12:15], s35 offen lds
    s_waitcnt vmcnt(12)
    ds_read_b64_tr_b16 a[160:161], v3 offset:8192
    ds_read_b64_tr_b16 a[162:163], v3 offset:8704
    ds_read_b64_tr_b16 a[164:165], v3 offset:8224
    ds_read_b64_tr_b16 a[166:167], v3 offset:8736
    ds_read_b64_tr_b16 a[168:169], v3 offset:10240
    ds_read_b64_tr_b16 a[170:171], v3 offset:10752
    ds_read_b64_tr_b16 a[172:173], v3 offset:10272
    ds_read_b64_tr_b16 a[174:175], v3 offset:10784
    s_waitcnt lgkmcnt(0)
    s_add_u32 m0, s38, 24576
    s_add_u32 s35, s44, 1032192
    buffer_load_dwordx4 v2, s[12:15], s35 offen lds
    s_add_u32 m0, s38, 25600
    s_add_u32 s35, s44, 1050624
    buffer_load_dwordx4 v2, s[12:15], s35 offen lds
    s_add_u32 m0, s38, 26624
    s_add_u32 s35, s44, 1069056
    buffer_load_dwordx4 v2, s[12:15], s35 offen lds
    s_add_u32 m0, s38, 27648
    s_add_u32 s35, s44, 1087488
    buffer_load_dwordx4 v2, s[12:15], s35 offen lds
    s_waitcnt vmcnt(12)
    ds_read_b64_tr_b16 a[176:177], v3 offset:12288
    ds_read_b64_tr_b16 a[178:179], v3 offset:12800
    ds_read_b64_tr_b16 a[180:181], v3 offset:12320
    ds_read_b64_tr_b16 a[182:183], v3 offset:12832
    ds_read_b64_tr_b16 a[184:185], v3 offset:14336
    ds_read_b64_tr_b16 a[186:187], v3 offset:14848
    ds_read_b64_tr_b16 a[188:189], v3 offset:14368
    ds_read_b64_tr_b16 a[190:191], v3 offset:14880
    s_waitcnt lgkmcnt(0)
    s_add_u32 m0, s38, 28672
    s_add_u32 s35, s44, 1105920
    buffer_load_dwordx4 v2, s[12:15], s35 offen lds
    s_add_u32 m0, s38, 29696
    s_add_u32 s35, s44, 1124352
    buffer_load_dwordx4 v2, s[12:15], s35 offen lds
    s_add_u32 m0, s38, 30720
    s_add_u32 s35, s44, 1142784
    buffer_load_dwordx4 v2, s[12:15], s35 offen lds
    s_add_u32 m0, s38, 31744
    s_add_u32 s35, s44, 1161216
    buffer_load_dwordx4 v2, s[12:15], s35 offen lds
    s_waitcnt vmcnt(12)
    ds_read_b64_tr_b16 a[192:193], v3 offset:16384
    ds_read_b64_tr_b16 a[194:195], v3 offset:16896
    ds_read_b64_tr_b16 a[196:197], v3 offset:16416
    ds_read_b64_tr_b16 a[198:199], v3 offset:16928
    ds_read_b64_tr_b16 a[200:201], v3 offset:18432
    ds_read_b64_tr_b16 a[202:203], v3 offset:18944
    ds_read_b64_tr_b16 a[204:205], v3 offset:18464
    ds_read_b64_tr_b16 a[206:207], v3 offset:18976
    s_waitcnt lgkmcnt(0)
    s_add_u32 m0, s38, 0
    s_add_u32 s35, s44, 1179648
    buffer_load_dwordx4 v2, s[12:15], s35 offen lds
    s_add_u32 m0, s38, 1024
    s_add_u32 s35, s44, 1198080
    buffer_load_dwordx4 v2, s[12:15], s35 offen lds
    s_add_u32 m0, s38, 2048
    s_add_u32 s35, s44, 1216512
    buffer_load_dwordx4 v2, s[12:15], s35 offen lds
    s_add_u32 m0, s38, 3072
    s_add_u32 s35, s44, 1234944
    buffer_load_dwordx4 v2, s[12:15], s35 offen lds
    s_waitcnt vmcnt(12)
    ds_read_b64_tr_b16 a[208:209], v3 offset:20480
    ds_read_b64_tr_b16 a[210:211], v3 offset:20992
    ds_read_b64_tr_b16 a[212:213], v3 offset:20512
    ds_read_b64_tr_b16 a[214:215], v3 offset:21024
    ds_read_b64_tr_b16 a[216:217], v3 offset:22528
    ds_read_b64_tr_b16 a[218:219], v3 offset:23040
    ds_read_b64_tr_b16 a[220:221], v3 offset:22560
    ds_read_b64_tr_b16 a[222:223], v3 offset:23072
    s_waitcnt lgkmcnt(0)
    s_add_u32 m0, s38, 4096
    s_add_u32 s35, s44, 1253376
    buffer_load_dwordx4 v2, s[12:15], s35 offen lds
    s_add_u32 m0, s38, 5120
    s_add_u32 s35, s44, 1271808
    buffer_load_dwordx4 v2, s[12:15], s35 offen lds
    s_add_u32 m0, s38, 6144
    s_add_u32 s35, s44, 1290240
    buffer_load_dwordx4 v2, s[12:15], s35 offen lds
    s_add_u32 m0, s38, 7168
    s_add_u32 s35, s44, 1308672
    buffer_load_dwordx4 v2, s[12:15], s35 offen lds
    s_waitcnt vmcnt(12)
    ds_read_b64_tr_b16 a[224:225], v3 offset:24576
    ds_read_b64_tr_b16 a[226:227], v3 offset:25088
    ds_read_b64_tr_b16 a[228:229], v3 offset:24608
    ds_read_b64_tr_b16 a[230:231], v3 offset:25120
    ds_read_b64_tr_b16 a[232:233], v3 offset:26624
    ds_read_b64_tr_b16 a[234:235], v3 offset:27136
    ds_read_b64_tr_b16 a[236:237], v3 offset:26656
    ds_read_b64_tr_b16 a[238:239], v3 offset:27168
    s_waitcnt lgkmcnt(0)
    s_waitcnt vmcnt(8)
    ds_read_b64_tr_b16 a[240:241], v3 offset:28672
    ds_read_b64_tr_b16 a[242:243], v3 offset:29184
    ds_read_b64_tr_b16 a[244:245], v3 offset:28704
    ds_read_b64_tr_b16 a[246:247], v3 offset:29216
    ds_read_b64_tr_b16 a[248:249], v3 offset:30720
    ds_read_b64_tr_b16 a[250:251], v3 offset:31232
    ds_read_b64_tr_b16 a[252:253], v3 offset:30752
    ds_read_b64_tr_b16 a[254:255], v3 offset:31264
    s_waitcnt lgkmcnt(0)
    s_waitcnt vmcnt(4)
    ds_read_b64_tr_b16 v[252:253], v3 offset:0
    ds_read_b64_tr_b16 v[254:255], v3 offset:512
    ds_read_b64_tr_b16 v[248:249], v3 offset:32
    ds_read_b64_tr_b16 v[250:251], v3 offset:544
    ds_read_b64_tr_b16 v[244:245], v3 offset:2048
    ds_read_b64_tr_b16 v[246:247], v3 offset:2560
    ds_read_b64_tr_b16 v[240:241], v3 offset:2080
    ds_read_b64_tr_b16 v[242:243], v3 offset:2592
    s_waitcnt lgkmcnt(0)
    s_waitcnt vmcnt(0)
    ds_read_b64_tr_b16 v[236:237], v3 offset:4096
    ds_read_b64_tr_b16 v[238:239], v3 offset:4608
    ds_read_b64_tr_b16 v[232:233], v3 offset:4128
    ds_read_b64_tr_b16 v[234:235], v3 offset:4640
    ds_read_b64_tr_b16 v[228:229], v3 offset:6144
    ds_read_b64_tr_b16 v[230:231], v3 offset:6656
    ds_read_b64_tr_b16 v[224:225], v3 offset:6176
    ds_read_b64_tr_b16 v[226:227], v3 offset:6688
    s_waitcnt lgkmcnt(0)
    s_barrier
    v_mul_u32_u24 v5, 384, v1
    v_bfe_u32 v4, v1, 4, 2
    v_lshlrev_b32 v15, 9, v4
    v_bfe_u32 v4, v1, 0, 4
    v_lshl_add_u32 v15, v4, 4, v15
    s_lshl_b32 s35, s29, 11
    v_add_u32 v6, s35, v0
    s_lshr_b32 s35, s29, 1
    s_lshl_b32 s35, s35, 10
    s_and_b32 s36, s29, 1
    s_lshl_b32 s36, s36, 3
    s_add_u32 s35, s35, s36
    v_add_u32 v7, s35, v0
    s_lshl_b32 s35, s29, 8
    s_add_u32 s35, s35, 131072
    v_lshlrev_b32 v8, 2, v1
    v_add_u32 v8, s35, v8
    s_mov_b32 s41, s30
    s_mov_b32 s42, 0
LgbF_loop:
    s_nop 15
    s_nop 3
    s_lshr_b32 s32, s41, 1
    s_cmp_lg_u32 s42, 0
    s_cbranch_scc1 LgbF_go
    s_mul_hi_u32 s36, s32, 0x55555556
    s_mul_i32 s35, s36, 3
    s_sub_u32 s35, s32, s35
    s_lshl_b32 s35, s35, 7
    s_add_u32 s35, s35, 102768640
    s_add_u32 s36, s36, 1
    s_mov_b64 exec, 0x3ffff
Lpoll11:
    buffer_load_dword v4, v5, s[8:11], s35 offen sc1
    s_sub_u32 s39, s39, 1
    s_cbranch_scc1 Lbail
    s_waitcnt vmcnt(0)
    v_cmp_gt_u32 vcc, s36, v4
    s_nop 0
    s_cbranch_vccz Lpoll11d
    s_sleep 32
    s_branch Lpoll11
Lpoll11d:
    s_mov_b64 exec, -1
    v_min_u32 v10, 53, v1
    v_lshlrev_b32 v10, 7, v10
    s_mov_b32 s35, 102768640
    buffer_load_dword v4, v10, s[8:11], s35 offen sc1
    s_waitcnt vmcnt(0)
    v_cmp_gt_u32 vcc, 64, v4
    s_nop 0
    s_cmp_eq_u64 vcc, 0
    s_cselect_b32 s42, 1, 0
LgbF_go:
    s_mul_i32 s35, s32, 294912
    s_mul_i32 s36, s29, 73728
    s_add_u32 s35, s35, s36
    s_add_u32 s35, s35, 71303168
    s_and_b32 s36, s41, 1
    s_lshl_b32 s36, s36, 8
    s_add_u32 s35, s35, s36
    buffer_load_dwordx4 v[40:43], v15, s[8:11], s35 offen offset:0 sc1
    buffer_load_dwordx4 v[44:47], v15, s[8:11], s35 offen offset:2048 sc1
    s_add_u32 s35, s35, 4096
    buffer_load_dwordx4 v[48:51], v15, s[8:11], s35 offen offset:0 sc1
    buffer_load_dwordx4 v[52:55], v15, s[8:11], s35 offen offset:2048 sc1
    s_add_u32 s35, s35, 4096
    buffer_load_dwordx4 v[56:59], v15, s[8:11], s35 offen offset:0 sc1
    buffer_load_dwordx4 v[60:63], v15, s[8:11], s35 offen offset:2048 sc1
    s_add_u32 s35, s35, 4096
    buffer_load_dwordx4 v[64:67], v15, s[8:11], s35 offen offset:0 sc1
    buffer_load_dwordx4 v[68:71], v15, s[8:11], s35 offen offset:2048 sc1
    s_add_u32 s35, s35, 4096
    buffer_load_dwordx4 v[72:75], v15, s[8:11], s35 offen offset:0 sc1
    buffer_load_dwordx4 v[76:79], v15, s[8:11], s35 offen offset:2048 sc1
    s_add_u32 s35, s35, 4096
    buffer_load_dwordx4 v[80:83], v15, s[8:11], s35 offen offset:0 sc1
    buffer_load_dwordx4 v[84:87], v15, s[8:11], s35 offen offset:2048 sc1
    s_add_u32 s35, s35, 4096
    buffer_load_dwordx4 v[88:91], v15, s[8:11], s35 offen offset:0 sc1
    buffer_load_dwordx4 v[92:95], v15, s[8:11], s35 offen offset:2048 sc1
    s_add_u32 s35, s35, 4096
    buffer_load_dwordx4 v[96:99], v15, s[8:11], s35 offen offset:0 sc1
    buffer_load_dwordx4 v[100:103], v15, s[8:11], s35 offen offset:2048 sc1
    s_add_u32 s35, s35, 4096
    buffer_load_dwordx4 v[104:107], v15, s[8:11], s35 offen offset:0 sc1
    buffer_load_dwordx4 v[108:111], v15, s[8:11], s35 offen offset:2048 sc1
    s_add_u32 s35, s35, 4096
    buffer_load_dwordx4 v[112:115], v15, s[8:11], s35 offen offset:0 sc1
    buffer_load_dwordx4 v[116:119], v15, s[8:11], s35 offen offset:2048 sc1
    s_add_u32 s35, s35, 4096
    buffer_load_dwordx4 v[120:123], v15, s[8:11], s35 offen offset:0 sc1
    buffer_load_dwordx4 v[124:127], v15, s[8:11], s35 offen offset:2048 sc1
    s_add_u32 s35, s35, 4096
    buffer_load_dwordx4 v[128:131], v15, s[8:11], s35 offen offset:0 sc1
    buffer_load_dwordx4 v[132:135], v15, s[8:11], s35 offen offset:2048 sc1
    s_add_u32 s35, s35, 4096
    buffer_load_dwordx4 v[136:139], v15, s[8:11], s35 offen offset:0 sc1
    buffer_load_dwordx4 v[140:143], v15, s[8:11], s35 offen offset:2048 sc1
    s_add_u32 s35, s35, 4096
    buffer_load_dwordx4 v[144:147], v15, s[8:11], s35 offen offset:0 sc1
    buffer_load_dwordx4 v[148:151], v15, s[8:11], s35 offen offset:2048 sc1
    s_add_u32 s35, s35, 4096
    buffer_load_dwordx4 v[152:155], v15, s[8:11], s35 offen offset:0 sc1
    buffer_load_dwordx4 v[156:159], v15, s[8:11], s35 offen offset:2048 sc1
    s_add_u32 s35, s35, 4096
    buffer_load_dwordx4 v[160:163], v15, s[8:11], s35 offen offset:0 sc1
    buffer_load_dwordx4 v[164:167], v15, s[8:11], s35 offen offset:2048 sc1
    s_add_u32 s35, s35, 4096
    buffer_load_dwordx4 v[168:171], v15, s[8:11], s35 offen offset:0 sc1
    buffer_load_dwordx4 v[172:175], v15, s[8:11], s35 offen offset:2048 sc1
    s_add_u32 s35, s35, 4096
    buffer_load_dwordx4 v[176:179], v15, s[8:11], s35 offen offset:0 sc1
    buffer_load_dwordx4 v[180:183], v15, s[8:11], s35 offen offset:2048 sc1
    s_waitcnt vmcnt(35)
    v_mfma_f32_16x16x32_bf16 v[16:19], a[0:3], v[40:43], 0
    v_mfma_f32_16x16x32_bf16 v[20:23], a[4:7], v[40:43], 0
    s_waitcnt vmcnt(34)
    v_mfma_f32_16x16x32_bf16 v[16:19], a[8:11], v[44:47], v[16:19]
    v_mfma_f32_16x16x32_bf16 v[20:23], a[12:15], v[44:47], v[20:23]
    s_waitcnt vmcnt(33)
    v_mfma_f32_16x16x32_bf16 v[16:19], a[16:19], v[48:51], v[16:19]
    v_mfma_f32_16x16x32_bf16 v[20:23], a[20:23], v[48:51], v[20:23]
    s_waitcnt vmcnt(32)
    v_mfma_f32_16x16x32_bf16 v[16:19], a[24:27], v[52:55], v[16:19]
    v_mfma_f32_16x16x32_bf16 v[20:23], a[28:31], v[52:55], v[20:23]
    s_waitcnt vmcnt(31)
    v_mfma_f32_16x16x32_bf16 v[16:19], a[32:35], v[56:59], v[16:19]
    v_mfma_f32_16x16x32_bf16 v[20:23], a[36:39], v[56:59], v[20:23]
    s_waitcnt vmcnt(30)
    v_mfma_f32_16x16x32_bf16 v[16:19], a[40:43], v[60:63], v[16:19]
    v_mfma_f32_16x16x32_bf16 v[20:23], a[44:47], v[60:63], v[20:23]
    s_waitcnt vmcnt(29)
    v_mfma_f32_16x16x32_bf16 v[16:19], a[48:51], v[64:67], v[16:19]
    v_mfma_f32_16x16x32_bf16 v[20:23], a[52:55], v[64:67], v[20:23]
    s_waitcnt vmcnt(28)
    v_mfma_f32_16x16x32_bf16 v[16:19], a[56:59], v[68:71], v[16:19]
    v_mfma_f32_16x16x32_bf16 v[20:23], a[60:63], v[68:71], v[20:23]
    s_waitcnt vmcnt(27)
    v_mfma_f32_16x16x32_bf16 v[16:19], a[64:67], v[72:75], v[16:19]
    v_mfma_f32_16x16x32_bf16 v[20:23], a[68:71], v[72:75], v[20:23]
    s_waitcnt vmcnt(26)
    v_mfma_f32_16x16x32_bf16 v[16:19], a[72:75], v[76:79], v[16:19]
    v_mfma_f32_16x16x32_bf16 v[20:23], a[76:79], v[76:79], v[20:23]
    s_waitcnt vmcnt(25)
    v_mfma_f32_16x16x32_bf16 v[16:19], a[80:83], v[80:83], v[16:19]
    v_mfma_f32_16x16x32_bf16 v[20:23], a[84:87], v[80:83], v[20:23]
    s_waitcnt vmcnt(24)
    v_mfma_f32_16x16x32_bf16 v[16:19], a[88:91], v[84:87], v[16:19]
    v_mfma_f32_16x16x32_bf16 v[20:23], a[92:95], v[84:87], v[20:23]
    s_waitcnt vmcnt(23)
    v_mfma_f32_16x16x32_bf16 v[16:19], a[96:99], v[88:91], v[16:19]
    v_mfma_f32_16x16x32_bf16 v[20:23], a[100:103], v[88:91], v[20:23]
    s_waitcnt vmcnt(22)
    v_mfma_f32_16x16x32_bf16 v[16:19], a[104:107], v[92:95], v[16:19]
    v_mfma_f32_16x16x32_bf16 v[20:23], a[108:111], v[92:95], v[20:23]
    s_waitcnt vmcnt(21)
    v_mfma_f32_16x16x32_bf16 v[16:19], a[112:115], v[96:99], v[16:19]
    v_mfma_f32_16x16x32_bf16 v[20:23], a[116:119], v[96:99], v[20:23]
    s_waitcnt vmcnt(20)
    v_mfma_f32_16x16x32_bf16 v[16:19], a[120:123], v[100:103], v[16:19]
    v_mfma_f32_16x16x32_bf16 v[20:23], a[124:127], v[100:103], v[20:23]
    s_waitcnt vmcnt(19)
    v_mfma_f32_16x16x32_bf16 v[16:19], a[128:131], v[104:107], v[16:19]
    v_mfma_f32_16x16x32_bf16 v[20:23], a[132:135], v[104:107], v[20:23]
    s_waitcnt vmcnt(18)
    v_mfma_f32_16x16x32_bf16 v[16:19], a[136:139], v[108:111], v[16:19]
    v_mfma_f32_16x16x32_bf16 v[20:23], a[140:143], v[108:111], v[20:23]
    s_waitcnt vmcnt(17)
    v_mfma_f32_16x16x32_bf16 v[16:19], a[144:147], v[112:115], v[16:19]
    v_mfma_f32_16x16x32_bf16 v[20:23], a[148:151], v[112:115], v[20:23]
    s_waitcnt vmcnt(16)
    v_mfma_f32_16x16x32_bf16 v[16:19], a[152:155], v[116:119], v[16:19]
    v_mfma_f32_16x16x32_bf16 v[20:23], a[156:159], v[116:119], v[20:23]
    s_waitcnt vmcnt(15)
    v_mfma_f32_16x16x32_bf16 v[16:19], a[160:163], v[120:123], v[16:19]
    v_mfma_f32_16x16x32_bf16 v[20:23], a[164:167], v[120:123], v[20:23]
    s_waitcnt vmcnt(14)
    v_mfma_f32_16x16x32_bf16 v[16:19], a[168:171], v[124:127], v[16:19]
    v_mfma_f32_16x16x32_bf16 v[20:23], a[172:175], v[124:127], v[20:23]
    s_waitcnt vmcnt(13)
    v_mfma_f32_16x16x32_bf16 v[16:19], a[176:179], v[128:131], v[16:19]
    v_mfma_f32_16x16x32_bf16 v[20:23], a[180:183], v[128:131], v[20:23]
    s_waitcnt vmcnt(12)
    v_mfma_f32_16x16x32_bf16 v[16:19], a[184:187], v[132:135], v[16:19]
    v_mfma_f32_16x16x32_bf16 v[20:23], a[188:191], v[132:135], v[20:23]
    s_waitcnt vmcnt(11)
    v_mfma_f32_16x16x32_bf16 v[16:19], a[192:195], v[136:139], v[16:19]
    v_mfma_f32_16x16x32_bf16 v[20:23], a[196:199], v[136:139], v[20:23]
    s_waitcnt vmcnt(10)
    v_mfma_f32_16x16x32_bf16 v[16:19], a[200:203], v[140:143], v[16:19]
    v_mfma_f32_16x16x32_bf16 v[20:23], a[204:207], v[140:143], v[20:23]
    s_waitcnt vmcnt(9)
    v_mfma_f32_16x16x32_bf16 v[16:19], a[208:211], v[144:147], v[16:19]
    v_mfma_f32_16x16x32_bf16 v[20:23], a[212:215], v[144:147], v[20:23]
    s_waitcnt vmcnt(8)
    v_mfma_f32_16x16x32_bf16 v[16:19], a[216:219], v[148:151], v[16:19]
    v_mfma_f32_16x16x32_bf16 v[20:23], a[220:223], v[148:151], v[20:23]
    s_waitcnt vmcnt(7)
    v_mfma_f32_16x16x32_bf16 v[16:19], a[224:227], v[152:155], v[16:19]
    v_mfma_f32_16x16x32_bf16 v[20:23], a[228:231], v[152:155], v[20:23]
    s_waitcnt vmcnt(6)
    v_mfma_f32_16x16x32_bf16 v[16:19], a[232:235], v[156:159], v[16:19]
    v_mfma_f32_16x16x32_bf16 v[20:23], a[236:239], v[156:159], v[20:23]
    s_waitcnt vmcnt(5)
    v_mfma_f32_16x16x32_bf16 v[16:19], a[240:243], v[160:163], v[16:19]
    v_mfma_f32_16x16x32_bf16 v[20:23], a[244:247], v[160:163], v[20:23]
    s_waitcnt vmcnt(4)
    v_mfma_f32_16x16x32_bf16 v[16:19], a[248:251], v[164:167], v[16:19]
    v_mfma_f32_16x16x32_bf16 v[20:23], a[252:255], v[164:167], v[20:23]
    s_waitcnt vmcnt(3)
    v_mfma_f32_16x16x32_bf16 v[16:19], v[252:255], v[168:171], v[16:19]
    v_mfma_f32_16x16x32_bf16 v[20:23], v[248:251], v[168:171], v[20:23]
    s_waitcnt vmcnt(2)
    v_mfma_f32_16x16x32_bf16 v[16:19], v[244:247], v[172:175], v[16:19]
    v_mfma_f32_16x16x32_bf16 v[20:23], v[240:243], v[172:175], v[20:23]
    s_waitcnt vmcnt(1)
    v_mfma_f32_16x16x32_bf16 v[16:19], v[236:239], v[176:179], v[16:19]
    v_mfma_f32_16x16x32_bf16 v[20:23], v[232:235], v[176:179], v[20:23]
    s_waitcnt vmcnt(0)
    v_mfma_f32_16x16x32_bf16 v[16:19], v[228:231], v[180:183], v[16:19]
    v_mfma_f32_16x16x32_bf16 v[20:23], v[224:227], v[180:183], v[20:23]
    s_barrier
    s_nop 2
    ds_write_b128 v6, v[16:19] offset:0
    s_nop 2
    ds_write_b128 v6, v[20:23] offset:1024
    s_waitcnt lgkmcnt(0)
    s_barrier
    ds_read_b64 v[16:17], v7 offset:0
    ds_read_b64 v[18:19], v7 offset:2048
    ds_read_b64 v[20:21], v7 offset:4096
    ds_read_b64 v[22:23], v7 offset:6144
    s_waitcnt lgkmcnt(2)
    v_add_f32 v16, v16, v18
    v_add_f32 v17, v17, v19
    s_waitcnt lgkmcnt(0)
    v_add_f32 v20, v20, v22
    v_add_f32 v21, v21, v23
    v_add_f32 v16, v16, v20
    v_add_f32 v17, v17, v21
    v_cvt_pk_bf16_f32 v17, v16, v17
    v_lshlrev_b32 v16, 16, v17
    v_and_b32 v17, 0xffff0000, v17
    v_mul_f32 v20, 0xbfb8aa3b, v16
    v_mul_f32 v21, 0xbfb8aa3b, v17
    v_exp_f32 v20, v20
    v_exp_f32 v21, v21
    v_add_f32 v20, 1.0, v20
    v_add_f32 v21, 1.0, v21
    v_rcp_f32 v20, v20
    v_rcp_f32 v21, v21
    v_mul_f32 v16, v16, v20
    v_mul_f32 v17, v17, v21
    v_cvt_pk_bf16_f32 v12, v16, v17
    ds_write_b32 v8, v12
    v_add_u32 v8, 1024, v8
    s_waitcnt lgkmcnt(0)
    s_add_u32 s41, s41, 11
    s_cmp_lt_u32 s41, 128
    s_cbranch_scc1 LgbF_loop
    s_load_dwordx2 s[12:13], s[0:1], 40
    s_mov_b32 s14, 4718592
    s_mov_b32 s15, 0x20000
    s_waitcnt lgkmcnt(0)
    s_mul_i32 s44, s29, 1179648
    s_lshl_b32 s35, s31, 6
    s_add_u32 s44, s44, s35
    s_barrier
    v_lshrrev_b32 v4, 2, v1
    s_mov_b32 s35, 1152
    v_mul_lo_u32 v2, v4, s35
    v_and_b32 v4, 3, v1
    v_lshl_add_u32 v2, v4, 4, v2
    v_bfe_u32 v4, v1, 5, 1
    v_lshlrev_b32 v3, 10, v4
    v_bfe_u32 v4, v1, 4, 1
    v_lshl_add_u32 v3, v4, 8, v3
    v_bfe_u32 v4, v1, 2, 2
    v_lshl_add_u32 v3, v4, 6, v3
    v_bfe_u32 v4, v1, 0, 2
    v_lshl_add_u32 v3, v4, 3, v3
    v_add_u32 v3, s38, v3
    s_add_u32 m0, s38, 0
    s_add_u32 s35, s44, 0
    buffer_load_dwordx4 v2, s[12:15], s35 offen lds
    s_add_u32 m0, s38, 1024
    s_add_u32 s35, s44, 18432
    buffer_load_dwordx4 v2, s[12:15], s35 offen lds
    s_add_u32 m0, s38, 2048
    s_add_u32 s35, s44, 36864
    buffer_load_dwordx4 v2, s[12:15], s35 offen lds
    s_add_u32 m0, s38, 3072
    s_add_u32 s35, s44, 55296
    buffer_load_dwordx4 v2, s[12:15], s35 offen lds
    s_add_u32 m0, s38, 4096
    s_add_u32 s35, s44, 73728
    buffer_load_dwordx4 v2, s[12:15], s35 offen lds
    s_add_u32 m0, s38, 5120
    s_add_u32 s35, s44, 92160
    buffer_load_dwordx4 v2, s[12:15], s35 offen lds
    s_add_u32 m0, s38, 6144
    s_add_u32 s35, s44, 110592
    buffer_load_dwordx4 v2, s[12:15], s35 offen lds
    s_add_u32 m0, s38, 7168
    s_add_u32 s35, s44, 129024
    buffer_load_dwordx4 v2, s[12:15], s35 offen lds
    s_add_u32 m0, s38, 8192
    s_add_u32 s35, s44, 147456
    buffer_load_dwordx4 v2, s[12:15], s35 offen lds
    s_add_u32 m0, s38, 9216
    s_add_u32 s35, s44, 165888
    buffer_load_dwordx4 v2, s[12:15], s35 offen lds
    s_add_u32 m0, s38, 10240
    s_add_u32 s35, s44, 184320
    buffer_load_dwordx4 v2, s[12:15], s35 offen lds
    s_add_u32 m0, s38, 11264
    s_add_u32 s35, s44, 202752
    buffer_load_dwordx4 v2, s[12:15], s35 offen lds
    s_add_u32 m0, s38, 12288
    s_add_u32 s35, s44, 221184
    buffer_load_dwordx4 v2, s[12:15], s35 offen lds
    s_add_u32 m0, s38, 13312
    s_add_u32 s35, s44, 239616
    buffer_load_dwordx4 v2, s[12:15], s35 offen lds
    s_add_u32 m0, s38, 14336
    s_add_u32 s35, s44, 258048
    buffer_load_dwordx4 v2, s[12:15], s35 offen lds
    s_add_u32 m0, s38, 15360
    s_add_u32 s35, s44, 276480
    buffer_load_dwordx4 v2, s[12:15], s35 offen lds
    s_waitcnt vmcnt(12)
    ds_read_b64_tr_b16 a[0:1], v3 offset:0
    ds_read_b64_tr_b16 a[2:3], v3 offset:512
    ds_read_b64_tr_b16 a[4:5], v3 offset:32
    ds_read_b64_tr_b16 a[6:7], v3 offset:544
    ds_read_b64_tr_b16 a[8:9], v3 offset:2048
    ds_read_b64_tr_b16 a[10:11], v3 offset:2560
    ds_read_b64_tr_b16 a[12:13], v3 offset:2080
    ds_read_b64_tr_b16 a[14:15], v3 offset:2592
    s_waitcnt lgkmcnt(0)
    s_add_u32 m0, s38, 16384
    s_add_u32 s35, s44, 294912
    buffer_load_dwordx4 v2, s[12:15], s35 offen lds
    s_add_u32 m0, s38, 17408
    s_add_u32 s35, s44, 313344
    buffer_load_dwordx4 v2, s[12:15], s35 offen lds
    s_add_u32 m0, s38, 18432
    s_add_u32 s35, s44, 331776
    buffer_load_dwordx4 v2, s[12:15], s35 offen lds
    s_add_u32 m0, s38, 19456
    s_add_u32 s35, s44, 350208
    buffer_load_dwordx4 v2, s[12:15], s35 offen lds
    s_waitcnt vmcnt(12)
    ds_read_b64_tr_b16 a[16:17], v3 offset:4096
    ds_read_b64_tr_b16 a[18:19], v3 offset:4608
    ds_read_b64_tr_b16 a[20:21], v3 offset:4128
    ds_read_b64_tr_b16 a[22:23], v3 offset:4640
    ds_read_b64_tr_b16 a[24:25], v3 offset:6144
    ds_read_b64_tr_b16 a[26:27], v3 offset:6656
    ds_read_b64_tr_b16 a[28:29], v3 offset:6176
    ds_read_b64_tr_b16 a[30:31], v3 offset:6688
    s_waitcnt lgkmcnt(0)
    s_add_u32 m0, s38, 20480
    s_add_u32 s35, s44, 368640
    buffer_load_dwordx4 v2, s[12:15], s35 offen lds
    s_add_u32 m0, s38, 21504
    s_add_u32 s35, s44, 387072
    buffer_load_dwordx4 v2, s[12:15], s35 offen lds
    s_add_u32 m0, s38, 22528
    s_add_u32 s35, s44, 405504
    buffer_load_dwordx4 v2, s[12:15], s35 offen lds
    s_add_u32 m0, s38, 23552
    s_add_u32 s35, s44, 423936
    buffer_load_dwordx4 v2, s[12:15], s35 offen lds
    s_waitcnt vmcnt(12)
    ds_read_b64_tr_b16 a[32:33], v3 offset:8192
    ds_read_b64_tr_b16 a[34:35], v3 offset:8704
    ds_read_b64_tr_b16 a[36:37], v3 offset:8224
    ds_read_b64_tr_b16 a[38:39], v3 offset:8736
    ds_read_b64_tr_b16 a[40:41], v3 offset:10240
    ds_read_b64_tr_b16 a[42:43], v3 offset:10752
    ds_read_b64_tr_b16 a[44:45], v3 offset:10272
    ds_read_b64_tr_b16 a[46:47], v3 offset:10784
    s_waitcnt lgkmcnt(0)
    s_add_u32 m0, s38, 24576
    s_add_u32 s35, s44, 442368
    buffer_load_dwordx4 v2, s[12:15], s35 offen lds
    s_add_u32 m0, s38, 25600
    s_add_u32 s35, s44, 460800
    buffer_load_dwordx4 v2, s[12:15], s35 offen lds
    s_add_u32 m0, s38, 26624
    s_add_u32 s35, s44, 479232
    buffer_load_dwordx4 v2, s[12:15], s35 offen lds
    s_add_u32 m0, s38, 27648
    s_add_u32 s35, s44, 497664
    buffer_load_dwordx4 v2, s[12:15], s35 offen lds
    s_waitcnt vmcnt(12)
    ds_read_b64_tr_b16 a[48:49], v3 offset:12288
    ds_read_b64_tr_b16 a[50:51], v3 offset:12800
    ds_read_b64_tr_b16 a[52:53], v3 offset:12320
    ds_read_b64_tr_b16 a[54:55], v3 offset:12832
    ds_read_b64_tr_b16 a[56:57], v3 offset:14336
    ds_read_b64_tr_b16 a[58:59], v3 offset:14848
    ds_read_b64_tr_b16 a[60:61], v3 offset:14368
    ds_read_b64_tr_b16 a[62:63], v3 offset:14880
    s_waitcnt lgkmcnt(0)
    s_add_u32 m0, s38, 28672
    s_add_u32 s35, s44, 516096
    buffer_load_dwordx4 v2, s[12:15], s35 offen lds
    s_add_u32 m0, s38, 29696
    s_add_u32 s35, s44, 534528
    buffer_load_dwordx4 v2, s[12:15], s35 offen lds
    s_add_u32 m0, s38, 30720
    s_add_u32 s35, s44, 552960
    buffer_load_dwordx4 v2, s[12:15], s35 offen lds
    s_add_u32 m0, s38, 31744
    s_add_u32 s35, s44, 571392
    buffer_load_dwordx4 v2, s[12:15], s35 offen lds
    s_waitcnt vmcnt(12)
    ds_read_b64_tr_b16 a[64:65], v3 offset:16384
    ds_read_b64_tr_b16 a[66:67], v3 offset:16896
    ds_read_b64_tr_b16 a[68:69], v3 offset:16416
    ds_read_b64_tr_b16 a[70:71], v3 offset:16928
    ds_read_b64_tr_b16 a[72:73], v3 offset:18432
    ds_read_b64_tr_b16 a[74:75], v3 offset:18944
    ds_read_b64_tr_b16 a[76:77], v3 offset:18464
    ds_read_b64_tr_b16 a[78:79], v3 offset:18976
    s_waitcnt lgkmcnt(0)
    s_add_u32 m0, s38, 0
    s_add_u32 s35, s44, 589824
    buffer_load_dwordx4 v2, s[12:15], s35 offen lds
    s_add_u32 m0, s38, 1024
    s_add_u32 s35, s44, 608256
    buffer_load_dwordx4 v2, s[12:15], s35 offen lds
    s_add_u32 m0, s38, 2048
    s_add_u32 s35, s44, 626688
    buffer_load_dwordx4 v2, s[12:15], s35 offen lds
    s_add_u32 m0, s38, 3072
    s_add_u32 s35, s44, 645120
    buffer_load_dwordx4 v2, s[12:15], s35 offen lds
    s_waitcnt vmcnt(12)
    ds_read_b64_tr_b16 a[80:81], v3 offset:20480
    ds_read_b64_tr_b16 a[82:83], v3 offset:20992
    ds_read_b64_tr_b16 a[84:85], v3 offset:20512
    ds_read_b64_tr_b16 a[86:87], v3 offset:21024
    ds_read_b64_tr_b16 a[88:89], v3 offset:22528
    ds_read_b64_tr_b16 a[90:91], v3 offset:23040
    ds_read_b64_tr_b16 a[92:93], v3 offset:22560
    ds_read_b64_tr_b16 a[94:95], v3 offset:23072
    s_waitcnt lgkmcnt(0)
    s_add_u32 m0, s38, 4096
    s_add_u32 s35, s44, 663552
    buffer_load_dwordx4 v2, s[12:15], s35 offen lds
    s_add_u32 m0, s38, 5120
    s_add_u32 s35, s44, 681984
    buffer_load_dwordx4 v2, s[12:15], s35 offen lds
    s_add_u32 m0, s38, 6144
    s_add_u32 s35, s44, 700416
    buffer_load_dwordx4 v2, s[12:15], s35 offen lds
    s_add_u32 m0, s38, 7168
    s_add_u32 s35, s44, 718848
    buffer_load_dwordx4 v2, s[12:15], s35 offen lds
    s_waitcnt vmcnt(12)
    ds_read_b64_tr_b16 a[96:97], v3 offset:24576
    ds_read_b64_tr_b16 a[98:99], v3 offset:25088
    ds_read_b64_tr_b16 a[100:101], v3 offset:24608
    ds_read_b64_tr_b16 a[102:103], v3 offset:25120
    ds_read_b64_tr_b16 a[104:105], v3 offset:26624
    ds_read_b64_tr_b16 a[106:107], v3 offset:27136
    ds_read_b64_tr_b16 a[108:109], v3 offset:26656
    ds_read_b64_tr_b16 a[110:111], v3 offset:27168
    s_waitcnt lgkmcnt(0)
    s_add_u32 m0, s38, 8192
    s_add_u32 s35, s44, 737280
    buffer_load_dwordx4 v2, s[12:15], s35 offen lds
    s_add_u32 m0, s38, 9216
    s_add_u32 s35, s44, 755712
    buffer_load_dwordx4 v2, s[12:15], s35 offen lds
    s_add_u32 m0, s38, 10240
    s_add_u32 s35, s44, 774144
    buffer_load_dwordx4 v2, s[12:15], s35 offen lds
    s_add_u32 m0, s38, 11264
    s_add_u32 s35, s44, 792576
    buffer_load_dwordx4 v2, s[12:15], s35 offen lds
    s_waitcnt vmcnt(12)
    ds_read_b64_tr_b16 a[112:113], v3 offset:28672
    ds_read_b64_tr_b16 a[114:115], v3 offset:29184
    ds_read_b64_tr_b16 a[116:117], v3 offset:28704
    ds_read_b64_tr_b16 a[118:119], v3 offset:29216
    ds_read_b64_tr_b16 a[120:121], v3 offset:30720
    ds_read_b64_tr_b16 a[122:123], v3 offset:31232
    ds_read_b64_tr_b16 a[124:125], v3 offset:30752
    ds_read_b64_tr_b16 a[126:127], v3 offset:31264
    s_waitcnt lgkmcnt(0)
    s_add_u32 m0, s38, 12288
    s_add_u32 s35, s44, 811008
    buffer_load_dwordx4 v2, s[12:15], s35 offen lds
    s_add_u32 m0, s38, 13312
    s_add_u32 s35, s44, 829440
    buffer_load_dwordx4 v2, s[12:15], s35 offen lds
    s_add_u32 m0, s38, 14336
    s_add_u32 s35, s44, 847872
    buffer_load_dwordx4 v2, s[12:15], s35 offen lds
    s_add_u32 m0, s38, 15360
    s_add_u32 s35, s44, 866304
    buffer_load_dwordx4 v2, s[12:15], s35 offen lds
    s_waitcnt vmcnt(12)
    ds_read_b64_tr_b16 a[128:129], v3 offset:0
    ds_read_b64_tr_b16 a[130:131], v3 offset:512
    ds_read_b64_tr_b16 a[132:133], v3 offset:32
    ds_read_b64_tr_b16 a[134:135], v3 offset:544
    ds_read_b64_tr_b16 a[136:137], v3 offset:2048
    ds_read_b64_tr_b16 a[138:139], v3 offset:2560
    ds_read_b64_tr_b16 a[140:141], v3 offset:2080
    ds_read_b64_tr_b16 a[142:143], v3 offset:2592
    s_waitcnt lgkmcnt(0)
    s_add_u32 m0, s38, 16384
    s_add_u32 s35, s44, 884736
    buffer_load_dwordx4 v2, s[12:15], s35 offen lds
    s_add_u32 m0, s38, 17408
    s_add_u32 s35, s44, 903168
    buffer_load_dwordx4 v2, s[12:15], s35 offen lds
    s_add_u32 m0, s38, 18432
    s_add_u32 s35, s44, 921600
    buffer_load_dwordx4 v2, s[12:15], s35 offen lds
    s_add_u32 m0, s38, 19456
    s_add_u32 s35, s44, 940032
    buffer_load_dwordx4 v2, s[12:15], s35 offen lds
    s_waitcnt vmcnt(12)
    ds_read_b64_tr_b16 a[144:145], v3 offset:4096
    ds_read_b64_tr_b16 a[146:147], v3 offset:4608
    ds_read_b64_tr_b16 a[148:149], v3 offset:4128
    ds_read_b64_tr_b16 a[150:151], v3 offset:4640
    ds_read_b64_tr_b16 a[152:153], v3 offset:6144
    ds_read_b64_tr_b16 a[154:155], v3 offset:6656
    ds_read_b64_tr_b16 a[156:157], v3 offset:6176
    ds_read_b64_tr_b16 a[158:159], v3 offset:6688
    s_waitcnt lgkmcnt(0)
    s_add_u32 m0, s38, 20480
    s_add_u32 s35, s44, 958464
    buffer_load_dwordx4 v2, s[12:15], s35 offen lds
    s_add_u32 m0, s38, 21504
    s_add_u32 s35, s44, 976896
    buffer_load_dwordx4 v2, s[12:15], s35 offen lds
    s_add_u32 m0, s38, 22528
    s_add_u32 s35, s44, 995328
    buffer_load_dwordx4 v2, s[12:15], s35 offen lds
    s_add_u32 m0, s38, 23552
    s_add_u32 s35, s44, 1013760
    buffer_load_dwordx4 v2, s[12:15], s35 offen lds
    s_waitcnt vmcnt(12)
    ds_read_b64_tr_b16 a[160:161], v3 offset:8192
    ds_read_b64_tr_b16 a[162:163], v3 offset:8704
    ds_read_b64_tr_b16 a[164:165], v3 offset:8224
    ds_read_b64_tr_b16 a[166:167], v3 offset:8736
    ds_read_b64_tr_b16 a[168:169], v3 offset:10240
    ds_read_b64_tr_b16 a[170:171], v3 offset:10752
    ds_read_b64_tr_b16 a[172:173], v3 offset:10272
    ds_read_b64_tr_b16 a[174:175], v3 offset:10784
    s_waitcnt lgkmcnt(0)
    s_add_u32 m0, s38, 24576
    s_add_u32 s35, s44, 1032192
    buffer_load_dwordx4 v2, s[12:15], s35 offen lds
    s_add_u32 m0, s38, 25600
    s_add_u32 s35, s44, 1050624
    buffer_load_dwordx4 v2, s[12:15], s35 offen lds
    s_add_u32 m0, s38, 26624
    s_add_u32 s35, s44, 1069056
    buffer_load_dwordx4 v2, s[12:15], s35 offen lds
    s_add_u32 m0, s38, 27648
    s_add_u32 s35, s44, 1087488
    buffer_load_dwordx4 v2, s[12:15], s35 offen lds
    s_waitcnt vmcnt(12)
    ds_read_b64_tr_b16 a[176:177], v3 offset:12288
    ds_read_b64_tr_b16 a[178:179], v3 offset:12800
    ds_read_b64_tr_b16 a[180:181], v3 offset:12320
    ds_read_b64_tr_b16 a[182:183], v3 offset:12832
    ds_read_b64_tr_b16 a[184:185], v3 offset:14336
    ds_read_b64_tr_b16 a[186:187], v3 offset:14848
    ds_read_b64_tr_b16 a[188:189], v3 offset:14368
    ds_read_b64_tr_b16 a[190:191], v3 offset:14880
    s_waitcnt lgkmcnt(0)
    s_add_u32 m0, s38, 28672
    s_add_u32 s35, s44, 1105920
    buffer_load_dwordx4 v2, s[12:15], s35 offen lds
    s_add_u32 m0, s38, 29696
    s_add_u32 s35, s44, 1124352
    buffer_load_dwordx4 v2, s[12:15], s35 offen lds
    s_add_u32 m0, s38, 30720
    s_add_u32 s35, s44, 1142784
    buffer_load_dwordx4 v2, s[12:15], s35 offen lds
    s_add_u32 m0, s38, 31744
    s_add_u32 s35, s44, 1161216
    buffer_load_dwordx4 v2, s[12:15], s35 offen lds
    s_waitcnt vmcnt(12)
    ds_read_b64_tr_b16 a[192:193], v3 offset:16384
    ds_read_b64_tr_b16 a[194:195], v3 offset:16896
    ds_read_b64_tr_b16 a[196:197], v3 offset:16416
    ds_read_b64_tr_b16 a[198:199], v3 offset:16928
    ds_read_b64_tr_b16 a[200:201], v3 offset:18432
    ds_read_b64_tr_b16 a[202:203], v3 offset:18944
    ds_read_b64_tr_b16 a[204:205], v3 offset:18464
    ds_read_b64_tr_b16 a[206:207], v3 offset:18976
    s_waitcnt lgkmcnt(0)
    s_waitcnt vmcnt(8)
    ds_read_b64_tr_b16 a[208:209], v3 offset:20480
    ds_read_b64_tr_b16 a[210:211], v3 offset:20992
    ds_read_b64_tr_b16 a[212:213], v3 offset:20512
    ds_read_b64_tr_b16 a[214:215], v3 offset:21024
    ds_read_b64_tr_b16 a[216:217], v3 offset:22528
    ds_read_b64_tr_b16 a[218:219], v3 offset:23040
    ds_read_b64_tr_b16 a[220:221], v3 offset:22560
    ds_read_b64_tr_b16 a[222:223], v3 offset:23072
    s_waitcnt lgkmcnt(0)
    s_waitcnt vmcnt(4)
    ds_read_b64_tr_b16 a[224:225], v3 offset:24576
    ds_read_b64_tr_b16 a[226:227], v3 offset:25088
    ds_read_b64_tr_b16 a[228:229], v3 offset:24608
    ds_read_b64_tr_b16 a[230:231], v3 offset:25120
    ds_read_b64_tr_b16 a[232:233], v3 offset:26624
    ds_read_b64_tr_b16 a[234:235], v3 offset:27136
    ds_read_b64_tr_b16 a[236:237], v3 offset:26656
    ds_read_b64_tr_b16 a[238:239], v3 offset:27168
    s_waitcnt lgkmcnt(0)
    s_waitcnt vmcnt(0)
    ds_read_b64_tr_b16 a[240:241], v3 offset:28672
    ds_read_b64_tr_b16 a[242:243], v3 offset:29184
    ds_read_b64_tr_b16 a[244:245], v3 offset:28704
    ds_read_b64_tr_b16 a[246:247], v3 offset:29216
    ds_read_b64_tr_b16 a[248:249], v3 offset:30720
    ds_read_b64_tr_b16 a[250:251], v3 offset:31232
    ds_read_b64_tr_b16 a[252:253], v3 offset:30752
    ds_read_b64_tr_b16 a[254:255], v3 offset:31264
    s_waitcnt lgkmcnt(0)
    s_barrier
    v_mul_u32_u24 v5, 384, v1
    v_bfe_u32 v4, v1, 4, 2
    v_lshlrev_b32 v15, 9, v4
    v_bfe_u32 v4, v1, 0, 4
    v_lshl_add_u32 v15, v4, 4, v15
    s_lshl_b32 s35, s29, 11
    v_add_u32 v6, s35, v0
    s_lshr_b32 s35, s29, 1
    s_lshl_b32 s35, s35, 10
    s_and_b32 s36, s29, 1
    s_lshl_b32 s36, s36, 3
    s_add_u32 s35, s35, s36
    v_add_u32 v7, s35, v0
    s_lshl_b32 s35, s29, 8
    s_add_u32 s35, s35, 131072
    v_lshlrev_b32 v8, 2, v1
    v_add_u32 v8, s35, v8
    s_load_dwordx2 s[12:13], s[0:1], 0
    s_mov_b32 s14, 2359296
    s_mov_b32 s15, 0x20000
    s_waitcnt lgkmcnt(0)
    s_load_dwordx2 s[16:17], s[0:1], 80
    s_mov_b32 s18, 2359296
    s_mov_b32 s19, 0x20000
    s_waitcnt lgkmcnt(0)
    v_and_b32 v4, 15, v1
    v_mul_u32_u24 v9, 1152, v4
    v_lshrrev_b32 v4, 4, v1
    v_lshl_add_u32 v9, v4, 3, v9
    s_lshl_b32 s35, s31, 6
    s_lshr_b32 s36, s29, 1
    s_lshl_b32 s36, s36, 5
    s_add_u32 s35, s35, s36
    s_and_b32 s36, s29, 1
    s_lshl_b32 s36, s36, 2
    s_add_u32 s35, s35, s36
    v_add_u32 v9, s35, v9
    v_lshlrev_b32 v13, 2, v1
    s_mov_b32 s35, 102761472
    s_nop 0
Lpoll12:
    buffer_load_dword v4, v13, s[8:11], s35 offen sc1
    s_sub_u32 s39, s39, 1
    s_cbranch_scc1 Lbail
    s_waitcnt vmcnt(0)
    v_cmp_gt_u32 vcc, 1, v4
    s_nop 0
    s_cbranch_vccz Lpoll12d
    s_sleep 24
    s_branch Lpoll12
Lpoll12d:
    s_mov_b32 s35, 102761632
    s_nop 0
Lpoll13:
    buffer_load_dword v4, v13, s[8:11], s35 offen sc1
    s_sub_u32 s39, s39, 1
    s_cbranch_scc1 Lbail
    s_waitcnt vmcnt(0)
    v_cmp_gt_u32 vcc, 1, v4
    s_nop 0
    s_cbranch_vccz Lpoll13d
    s_sleep 24
    s_branch Lpoll13
Lpoll13d:
    s_mov_b32 s41, s30
    s_mov_b32 s42, 0
LgbP_loop:
    s_nop 15
    s_nop 3
    s_lshr_b32 s32, s41, 1
    s_mul_i32 s40, s41, 18432
    buffer_load_dword v10, v9, s[12:15], s40 offen
    ds_read_b32 v12, v8
    s_lshl_b32 s35, s32, 9
    s_lshl_b32 s36, s29, 7
    s_add_u32 s35, s35, s36
    s_add_u32 s35, s35, 102809600
    s_cmp_ge_u32 s32, 61
    s_cbranch_scc1 LgbP_probe
    v_lshlrev_b32 v13, 2, v1
    s_mov_b64 exec, 0xff
Lpoll14:
    buffer_load_dword v4, v13, s[8:11], s35 offen sc1
    s_sub_u32 s39, s39, 1
    s_cbranch_scc1 Lbail
    s_waitcnt vmcnt(0)
    v_cmp_gt_u32 vcc, 1, v4
    s_nop 0
    s_cbranch_vccz Lpoll14d
    s_sleep 24
    s_branch Lpoll14
Lpoll14d:
    s_mov_b64 exec, -1
    s_branch LgbP_go
LgbP_probe:
    s_lshl_b32 s35, s32, 18
    s_lshl_b32 s36, s29, 16
    s_add_u32 s35, s35, s36
    s_add_u32 s35, s35, 54533632
    s_and_b32 s36, s41, 1
    s_lshl_b32 s36, s36, 8
    s_add_u32 s35, s35, s36
    v_lshlrev_b32 v13, 13, v1
    s_mov_b64 exec, 0xff
LgbP_pl:
    buffer_load_dword v4, v13, s[8:11], s35 offen sc1
    s_sub_u32 s39, s39, 1
    s_cbranch_scc1 Lbail
    s_waitcnt vmcnt(0)
    v_cmp_eq_u32 vcc, -1, v4
    s_nop 0
    s_cbranch_vccz LgbP_pd
    s_sleep 3
    s_branch LgbP_pl
LgbP_pd:
    s_mov_b64 exec, -1
LgbP_go:
    s_waitcnt vmcnt(0) lgkmcnt(0)
LgbP_again:
    v_mov_b32 v4, 0
    s_sub_u32 s39, s39, 1
    s_cbranch_scc1 Lbail
    s_mul_i32 s35, s32, 262144
    s_mul_i32 s36, s29, 65536
    s_add_u32 s35, s35, s36
    s_add_u32 s35, s35, 54525952
    s_and_b32 s36, s41, 1
    s_lshl_b32 s36, s36, 8
    s_add_u32 s35, s35, s36
    buffer_load_dwordx4 v[40:43], v15, s[8:11], s35 offen offset:0 sc1
    buffer_load_dwordx4 v[44:47], v15, s[8:11], s35 offen offset:2048 sc1
    s_add_u32 s35, s35, 4096
    buffer_load_dwordx4 v[48:51], v15, s[8:11], s35 offen offset:0 sc1
    buffer_load_dwordx4 v[52:55], v15, s[8:11], s35 offen offset:2048 sc1
    s_add_u32 s35, s35, 4096
    buffer_load_dwordx4 v[56:59], v15, s[8:11], s35 offen offset:0 sc1
    buffer_load_dwordx4 v[60:63], v15, s[8:11], s35 offen offset:2048 sc1
    s_add_u32 s35, s35, 4096
    buffer_load_dwordx4 v[64:67], v15, s[8:11], s35 offen offset:0 sc1
    buffer_load_dwordx4 v[68:71], v15, s[8:11], s35 offen offset:2048 sc1
    s_add_u32 s35, s35, 4096
    buffer_load_dwordx4 v[72:75], v15, s[8:11], s35 offen offset:0 sc1
    buffer_load_dwordx4 v[76:79], v15, s[8:11], s35 offen offset:2048 sc1
    s_add_u32 s35, s35, 4096
    buffer_load_dwordx4 v[80:83], v15, s[8:11], s35 offen offset:0 sc1
    buffer_load_dwordx4 v[84:87], v15, s[8:11], s35 offen offset:2048 sc1
    s_add_u32 s35, s35, 4096
    buffer_load_dwordx4 v[88:91], v15, s[8:11], s35 offen offset:0 sc1
    buffer_load_dwordx4 v[92:95], v15, s[8:11], s35 offen offset:2048 sc1
    s_add_u32 s35, s35, 4096
    buffer_load_dwordx4 v[96:99], v15, s[8:11], s35 offen offset:0 sc1
    buffer_load_dwordx4 v[100:103], v15, s[8:11], s35 offen offset:2048 sc1
    s_add_u32 s35, s35, 4096
    buffer_load_dwordx4 v[104:107], v15, s[8:11], s35 offen offset:0 sc1
    buffer_load_dwordx4 v[108:111], v15, s[8:11], s35 offen offset:2048 sc1
    s_add_u32 s35, s35, 4096
    buffer_load_dwordx4 v[112:115], v15, s[8:11], s35 offen offset:0 sc1
    buffer_load_dwordx4 v[116:119], v15, s[8:11], s35 offen offset:2048 sc1
    s_add_u32 s35, s35, 4096
    buffer_load_dwordx4 v[120:123], v15, s[8:11], s35 offen offset:0 sc1
    buffer_load_dwordx4 v[124:127], v15, s[8:11], s35 offen offset:2048 sc1
    s_add_u32 s35, s35, 4096
    buffer_load_dwordx4 v[128:131], v15, s[8:11], s35 offen offset:0 sc1
    buffer_load_dwordx4 v[132:135], v15, s[8:11], s35 offen offset:2048 sc1
    s_add_u32 s35, s35, 4096
    buffer_load_dwordx4 v[136:139], v15, s[8:11], s35 offen offset:0 sc1
    buffer_load_dwordx4 v[140:143], v15, s[8:11], s35 offen offset:2048 sc1
    s_add_u32 s35, s35, 4096
    buffer_load_dwordx4 v[144:147], v15, s[8:11], s35 offen offset:0 sc1
    buffer_load_dwordx4 v[148:151], v15, s[8:11], s35 offen offset:2048 sc1
    s_add_u32 s35, s35, 4096
    buffer_load_dwordx4 v[152:155], v15, s[8:11], s35 offen offset:0 sc1
    buffer_load_dwordx4 v[156:159], v15, s[8:11], s35 offen offset:2048 sc1
    s_add_u32 s35, s35, 4096
    buffer_load_dwordx4 v[160:163], v15, s[8:11], s35 offen offset:0 sc1
    buffer_load_dwordx4 v[164:167], v15, s[8:11], s35 offen offset:2048 sc1
    s_waitcnt vmcnt(31)
    v_mfma_f32_16x16x32_bf16 v[16:19], a[0:3], v[40:43], 0
    v_max3_u32 v4, v4, v40, v41
    v_mfma_f32_16x16x32_bf16 v[20:23], a[4:7], v[40:43], 0
    s_waitcnt vmcnt(30)
    v_max3_u32 v4, v4, v42, v43
    v_mfma_f32_16x16x32_bf16 v[16:19], a[8:11], v[44:47], v[16:19]
    v_max3_u32 v4, v4, v44, v45
    v_mfma_f32_16x16x32_bf16 v[20:23], a[12:15], v[44:47], v[20:23]
    s_waitcnt vmcnt(29)
    v_max3_u32 v4, v4, v46, v47
    v_mfma_f32_16x16x32_bf16 v[16:19], a[16:19], v[48:51], v[16:19]
    v_max3_u32 v4, v4, v48, v49
    v_mfma_f32_16x16x32_bf16 v[20:23], a[20:23], v[48:51], v[20:23]
    s_waitcnt vmcnt(28)
    v_max3_u32 v4, v4, v50, v51
    v_mfma_f32_16x16x32_bf16 v[16:19], a[24:27], v[52:55], v[16:19]
    v_max3_u32 v4, v4, v52, v53
    v_mfma_f32_16x16x32_bf16 v[20:23], a[28:31], v[52:55], v[20:23]
    s_waitcnt vmcnt(27)
    v_max3_u32 v4, v4, v54, v55
    v_mfma_f32_16x16x32_bf16 v[16:19], a[32:35], v[56:59], v[16:19]
    v_max3_u32 v4, v4, v56, v57
    v_mfma_f32_16x16x32_bf16 v[20:23], a[36:39], v[56:59], v[20:23]
    s_waitcnt vmcnt(26)
    v_max3_u32 v4, v4, v58, v59
    v_mfma_f32_16x16x32_bf16 v[16:19], a[40:43], v[60:63], v[16:19]
    v_max3_u32 v4, v4, v60, v61
    v_mfma_f32_16x16x32_bf16 v[20:23], a[44:47], v[60:63], v[20:23]
    s_waitcnt vmcnt(25)
    v_max3_u32 v4, v4, v62, v63
    v_mfma_f32_16x16x32_bf16 v[16:19], a[48:51], v[64:67], v[16:19]
    v_max3_u32 v4, v4, v64, v65
    v_mfma_f32_16x16x32_bf16 v[20:23], a[52:55], v[64:67], v[20:23]
    s_waitcnt vmcnt(24)
    v_max3_u32 v4, v4, v66, v67
    v_mfma_f32_16x16x32_bf16 v[16:19], a[56:59], v[68:71], v[16:19]
    v_max3_u32 v4, v4, v68, v69
    v_mfma_f32_16x16x32_bf16 v[20:23], a[60:63], v[68:71], v[20:23]
    s_waitcnt vmcnt(23)
    v_max3_u32 v4, v4, v70, v71
    v_mfma_f32_16x16x32_bf16 v[16:19], a[64:67], v[72:75], v[16:19]
    v_max3_u32 v4, v4, v72, v73
    v_mfma_f32_16x16x32_bf16 v[20:23], a[68:71], v[72:75], v[20:23]
    s_waitcnt vmcnt(22)
    v_max3_u32 v4, v4, v74, v75
    v_mfma_f32_16x16x32_bf16 v[16:19], a[72:75], v[76:79], v[16:19]
    v_max3_u32 v4, v4, v76, v77
    v_mfma_f32_16x16x32_bf16 v[20:23], a[76:79], v[76:79], v[20:23]
    s_waitcnt vmcnt(21)
    v_max3_u32 v4, v4, v78, v79
    v_mfma_f32_16x16x32_bf16 v[16:19], a[80:83], v[80:83], v[16:19]
    v_max3_u32 v4, v4, v80, v81
    v_mfma_f32_16x16x32_bf16 v[20:23], a[84:87], v[80:83], v[20:23]
    s_waitcnt vmcnt(20)
    v_max3_u32 v4, v4, v82, v83
    v_mfma_f32_16x16x32_bf16 v[16:19], a[88:91], v[84:87], v[16:19]
    v_max3_u32 v4, v4, v84, v85
    v_mfma_f32_16x16x32_bf16 v[20:23], a[92:95], v[84:87], v[20:23]
    s_waitcnt vmcnt(19)
    v_max3_u32 v4, v4, v86, v87
    v_mfma_f32_16x16x32_bf16 v[16:19], a[96:99], v[88:91], v[16:19]
    v_max3_u32 v4, v4, v88, v89
    v_mfma_f32_16x16x32_bf16 v[20:23], a[100:103], v[88:91], v[20:23]
    s_waitcnt vmcnt(18)
    v_max3_u32 v4, v4, v90, v91
    v_mfma_f32_16x16x32_bf16 v[16:19], a[104:107], v[92:95], v[16:19]
    v_max3_u32 v4, v4, v92, v93
    v_mfma_f32_16x16x32_bf16 v[20:23], a[108:111], v[92:95], v[20:23]
    s_waitcnt vmcnt(17)
    v_max3_u32 v4, v4, v94, v95
    v_mfma_f32_16x16x32_bf16 v[16:19], a[112:115], v[96:99], v[16:19]
    v_max3_u32 v4, v4, v96, v97
    v_mfma_f32_16x16x32_bf16 v[20:23], a[116:119], v[96:99], v[20:23]
    s_waitcnt vmcnt(16)
    v_max3_u32 v4, v4, v98, v99
    v_mfma_f32_16x16x32_bf16 v[16:19], a[120:123], v[100:103], v[16:19]
    v_max3_u32 v4, v4, v100, v101
    v_mfma_f32_16x16x32_bf16 v[20:23], a[124:127], v[100:103], v[20:23]
    s_waitcnt vmcnt(15)
    v_max3_u32 v4, v4, v102, v103
    v_mfma_f32_16x16x32_bf16 v[16:19], a[128:131], v[104:107], v[16:19]
    v_max3_u32 v4, v4, v104, v105
    v_mfma_f32_16x16x32_bf16 v[20:23], a[132:135], v[104:107], v[20:23]
    s_waitcnt vmcnt(14)
    v_max3_u32 v4, v4, v106, v107
    v_mfma_f32_16x16x32_bf16 v[16:19], a[136:139], v[108:111], v[16:19]
    v_max3_u32 v4, v4, v108, v109
    v_mfma_f32_16x16x32_bf16 v[20:23], a[140:143], v[108:111], v[20:23]
    s_waitcnt vmcnt(13)
    v_max3_u32 v4, v4, v110, v111
    v_mfma_f32_16x16x32_bf16 v[16:19], a[144:147], v[112:115], v[16:19]
    v_max3_u32 v4, v4, v112, v113
    v_mfma_f32_16x16x32_bf16 v[20:23], a[148:151], v[112:115], v[20:23]
    s_waitcnt vmcnt(12)
    v_max3_u32 v4, v4, v114, v115
    v_mfma_f32_16x16x32_bf16 v[16:19], a[152:155], v[116:119], v[16:19]
    v_max3_u32 v4, v4, v116, v117
    v_mfma_f32_16x16x32_bf16 v[20:23], a[156:159], v[116:119], v[20:23]
    s_waitcnt vmcnt(11)
    v_max3_u32 v4, v4, v118, v119
    v_mfma_f32_16x16x32_bf16 v[16:19], a[160:163], v[120:123], v[16:19]
    v_max3_u32 v4, v4, v120, v121
    v_mfma_f32_16x16x32_bf16 v[20:23], a[164:167], v[120:123], v[20:23]
    s_waitcnt vmcnt(10)
    v_max3_u32 v4, v4, v122, v123
    v_mfma_f32_16x16x32_bf16 v[16:19], a[168:171], v[124:127], v[16:19]
    v_max3_u32 v4, v4, v124, v125
    v_mfma_f32_16x16x32_bf16 v[20:23], a[172:175], v[124:127], v[20:23]
    s_waitcnt vmcnt(9)
    v_max3_u32 v4, v4, v126, v127
    v_mfma_f32_16x16x32_bf16 v[16:19], a[176:179], v[128:131], v[16:19]
    v_max3_u32 v4, v4, v128, v129
    v_mfma_f32_16x16x32_bf16 v[20:23], a[180:183], v[128:131], v[20:23]
    s_waitcnt vmcnt(8)
    v_max3_u32 v4, v4, v130, v131
    v_mfma_f32_16x16x32_bf16 v[16:19], a[184:187], v[132:135], v[16:19]
    v_max3_u32 v4, v4, v132, v133
    v_mfma_f32_16x16x32_bf16 v[20:23], a[188:191], v[132:135], v[20:23]
    s_waitcnt vmcnt(7)
    v_max3_u32 v4, v4, v134, v135
    v_mfma_f32_16x16x32_bf16 v[16:19], a[192:195], v[136:139], v[16:19]
    v_max3_u32 v4, v4, v136, v137
    v_mfma_f32_16x16x32_bf16 v[20:23], a[196:199], v[136:139], v[20:23]
    s_waitcnt vmcnt(6)
    v_max3_u32 v4, v4, v138, v139
    v_mfma_f32_16x16x32_bf16 v[16:19], a[200:203], v[140:143], v[16:19]
    v_max3_u32 v4, v4, v140, v141
    v_mfma_f32_16x16x32_bf16 v[20:23], a[204:207], v[140:143], v[20:23]
    s_waitcnt vmcnt(5)
    v_max3_u32 v4, v4, v142, v143
    v_mfma_f32_16x16x32_bf16 v[16:19], a[208:211], v[144:147], v[16:19]
    v_max3_u32 v4, v4, v144, v145
    v_mfma_f32_16x16x32_bf16 v[20:23], a[212:215], v[144:147], v[20:23]
    s_waitcnt vmcnt(4)
    v_max3_u32 v4, v4, v146, v147
    v_mfma_f32_16x16x32_bf16 v[16:19], a[216:219], v[148:151], v[16:19]
    v_max3_u32 v4, v4, v148, v149
    v_mfma_f32_16x16x32_bf16 v[20:23], a[220:223], v[148:151], v[20:23]
    s_waitcnt vmcnt(3)
    v_max3_u32 v4, v4, v150, v151
    v_mfma_f32_16x16x32_bf16 v[16:19], a[224:227], v[152:155], v[16:19]
    v_max3_u32 v4, v4, v152, v153
    v_mfma_f32_16x16x32_bf16 v[20:23], a[228:231], v[152:155], v[20:23]
    s_waitcnt vmcnt(2)
    v_max3_u32 v4, v4, v154, v155
    v_mfma_f32_16x16x32_bf16 v[16:19], a[232:235], v[156:159], v[16:19]
    v_max3_u32 v4, v4, v156, v157
    v_mfma_f32_16x16x32_bf16 v[20:23], a[236:239], v[156:159], v[20:23]
    s_waitcnt vmcnt(1)
    v_max3_u32 v4, v4, v158, v159
    v_mfma_f32_16x16x32_bf16 v[16:19], a[240:243], v[160:163], v[16:19]
    v_max3_u32 v4, v4, v160, v161
    v_mfma_f32_16x16x32_bf16 v[20:23], a[244:247], v[160:163], v[20:23]
    s_waitcnt vmcnt(0)
    v_max3_u32 v4, v4, v162, v163
    v_mfma_f32_16x16x32_bf16 v[16:19], a[248:251], v[164:167], v[16:19]
    v_max3_u32 v4, v4, v164, v165
    v_mfma_f32_16x16x32_bf16 v[20:23], a[252:255], v[164:167], v[20:23]
    v_max3_u32 v4, v4, v166, v167
    v_cmp_eq_u32 vcc, -1, v4
    s_nop 7
    s_cbranch_vccnz LgbP_again
    s_barrier
    ds_write_b128 v6, v[16:19] offset:0
    ds_write_b128 v6, v[20:23] offset:1024
    s_waitcnt lgkmcnt(0)
    s_barrier
    ds_read_b64 v[16:17], v7 offset:0
    ds_read_b64 v[18:19], v7 offset:2048
    ds_read_b64 v[20:21], v7 offset:4096
    ds_read_b64 v[22:23], v7 offset:6144
    s_waitcnt lgkmcnt(2)
    v_add_f32 v16, v16, v18
    v_add_f32 v17, v17, v19
    s_waitcnt lgkmcnt(0)
    v_add_f32 v20, v20, v22
    v_add_f32 v21, v21, v23
    v_add_f32 v16, v16, v20
    v_add_f32 v17, v17, v21
    v_cvt_pk_bf16_f32 v17, v16, v17
    v_lshlrev_b32 v16, 16, v17
    v_and_b32 v17, 0xffff0000, v17
    v_lshlrev_b32 v20, 16, v12
    v_and_b32 v21, 0xffff0000, v12
    v_lshlrev_b32 v22, 16, v10
    v_and_b32 v23, 0xffff0000, v10
    v_mul_f32 v20, v20, v16
    v_mul_f32 v21, v21, v17
    v_cvt_pk_bf16_f32 v21, v20, v21
    v_lshlrev_b32 v20, 16, v21
    v_and_b32 v21, 0xffff0000, v21
    v_add_f32 v20, v20, v22
    v_add_f32 v21, v21, v23
    v_cvt_pk_bf16_f32 v14, v20, v21
    buffer_store_dword v14, v9, s[16:19], s40 offen
    v_add_u32 v8, 1024, v8
    s_waitcnt lgkmcnt(0)
    s_add_u32 s41, s41, 11
    s_cmp_lt_u32 s41, 128
    s_cbranch_scc1 LgbP_loop
Lbail:
    s_endpgm
.section .rodata,"a"
.p2align 6
.amdhsa_kernel recurrent_scan__memory_aug_recurrent_mem_tr__dense_activation_silu__prompt_kernel
  .amdhsa_next_free_vgpr 512
  .amdhsa_next_free_sgpr 102
  .amdhsa_accum_offset 256
  .amdhsa_group_segment_fixed_size 0
  .amdhsa_kernarg_size 104
  .amdhsa_user_sgpr_count 2
  .amdhsa_user_sgpr_kernarg_segment_ptr 1
  .amdhsa_system_sgpr_workgroup_id_x 1
.end_amdhsa_kernel
```
